```python
import torch

def _softmax(x, axis=-1):
    return torch.softmax(x, dim=axis)
def _gelu(x):
    return torch.nn.functional.gelu(x, approximate="tanh")
def _silu(x):
    return torch.nn.functional.silu(x)
def _sigmoid(x):
    return torch.sigmoid(x)
def _layernorm(x, axis=-1, eps=1e-5):
    m = x.mean(dim=axis, keepdim=True)
    v = x.var(dim=axis, keepdim=True, unbiased=False)
    return (x - m) / torch.sqrt(v + eps)
def _scatter_add(tgt, idx, src, axis=0):
    return tgt.clone().index_add_(axis, idx, src)
def _segment_sum(src, seg, n):
    out = torch.zeros((n,) + src.shape[1:], dtype=src.dtype)
    return out.index_add_(0, seg, src)
def _pad(x, pw):
    flat = tuple(v for pair in reversed(pw) for v in pair)
    return torch.nn.functional.pad(x, flat)

kernel_name = 'recurrent_scan__linear_attn_block__glu_gated_glu__prompt'

def setup_inputs():

    _w = (lambda a: (lambda t: t.to(torch.bfloat16) if t.is_floating_point() else t)(torch.as_tensor(a)))
    def _A_setup():
        B, S, D = 1, 2048, 640
        return {
            "x": _w((lambda *s: torch.randn(*s, dtype=torch.bfloat16) * 0.05)(B, S, D)),
            "wqkv": _w((lambda *s: torch.randn(*s, dtype=torch.bfloat16) * 0.05)(D, 3 * D)),
            "wo": _w((lambda *s: torch.randn(*s, dtype=torch.bfloat16) * 0.05)(D, D)),
        }
    _A_in = _A_setup()

    def _B_setup():
        B, S, D, F = 1, 2048, 640, 1728
        return {
            "x": _w((lambda *s: torch.randn(*s, dtype=torch.bfloat16) * 0.05)(B, S, D)),
            "w_gate": _w((lambda *s: torch.randn(*s, dtype=torch.bfloat16) * 0.05)(D, F)),
            "w_up": _w((lambda *s: torch.randn(*s, dtype=torch.bfloat16) * 0.05)(D, F)),
            "w_down": _w((lambda *s: torch.randn(*s, dtype=torch.bfloat16) * 0.05)(F, D)),
        }
    _B_in = _B_setup()

    return {
        "A_x": _A_in["x"],
        "A_wqkv": _A_in["wqkv"],
        "A_wo": _A_in["wo"],
        "B_x": _B_in["x"],
        "B_w_gate": _B_in["w_gate"],
        "B_w_up": _B_in["w_up"],
        "B_w_down": _B_in["w_down"],
    }

def reference(A_x, A_wqkv, A_wo, B_x, B_w_gate, B_w_up, B_w_down):
    def _A_ref(x, wqkv, wo):
        B, S, D = x.shape
        H = 32; Dh = D // H
        qkv = (lambda x, *d: x.permute(*d))((x @ wqkv).reshape(B, S, 3, H, Dh), 2, 0, 3, 1, 4)
        q, k, v = qkv[0], qkv[1], qkv[2]
        phi = lambda t: torch.where(t > 0, t + 1, torch.exp(t)) + 1e-6
        pq, pk = phi(q), phi(k)
        kv = torch.einsum("bhsd,bhse->bhde", pk, v)
        z = torch.einsum("bhsd->bhd", pk)
        num = torch.einsum("bhqd,bhde->bhqe", pq, kv)
        den = torch.einsum("bhqd,bhd->bhq", pq, z)[..., None] + 1e-6
        o = num / den
        return (lambda x, *d: x.permute(*d))(o, 0, 2, 1, 3).reshape(B, S, D) @ wo

    def _B_ref(x, w_gate, w_up, w_down):
        g = torch.einsum("bsd,df->bsf", x, w_gate)
        u = torch.einsum("bsd,df->bsf", x, w_up)
        h = _sigmoid(g) * u
        return torch.einsum("bsf,fd->bsd", h, w_down)

    x = A_x
    xn = _layernorm(x, axis=-1)
    s = _A_ref(xn, A_wqkv, A_wo)
    g = _silu(_B_ref(xn, B_w_gate, B_w_up, B_w_down))
    return x + s * g
```

```asm
; @launch kernel=k1_kernel grid=(256,1,1) block=(512,1,1) lds=163840
.amdgcn_target "amdgcn-amd-amdhsa--gfx950"
.text
.globl k1_kernel
.p2align 8
.type k1_kernel,@function
k1_kernel:
    s_cmp_ge_u32 s2, 256
    s_cbranch_scc1 k1_kernel_end
    s_load_dwordx16 s[4:19], s[0:1], 0
    s_load_dwordx4 s[20:23], s[0:1], 64
    v_lshrrev_b32 v1, 6, v0
    v_and_b32 v0, 63, v0
    v_readfirstlane_b32 s44, v1
    s_nop 0
    s_cmp_lg_u32 s44, 7
    s_cbranch_scc1 k1_kernel_ncw
    s_getpc_b64 s[40:41]
k1_kernel_pc:
    s_bfe_u32 s42, s2, 0x30003
    s_lshl_b32 s42, s42, 13
    v_lshl_add_u32 v255, v0, 7, s42
    v_min_u32 v255, k1_kernel_end-k1_kernel_pc, v255
    global_load_dword v255, v255, s[40:41]
k1_kernel_ncw:
    s_lshr_b32 s53, s2, 3
    s_and_b32 s54, s2, 1
    s_bfe_u32 s55, s2, 0x20001
    s_mov_b32 s52, 0x3f803f80
    s_lshl_b32 s45, s54, 5
    s_cmp_lt_u32 s53, 8
    s_cbranch_scc1 k1_kernel_kvmap
    s_sub_u32 s53, s53, 8
    s_and_b32 s56, s53, 7
    s_lshl_b32 s49, s55, 3
    s_add_u32 s49, s49, s56
    s_lshr_b32 s56, s53, 3
    s_lshl_b32 s48, s56, 1
    s_add_u32 s48, s48, s54
    s_mul_i32 s57, s56, 11
    s_add_u32 s45, s45, s57
    s_cmp_eq_u32 s56, 2
    s_cselect_b32 s46, 10, 11
    s_and_b32 s56, s49, 7
    s_mul_i32 s47, s55, 3
    s_add_u32 s47, s47, s56
    s_cmp_lt_u32 s56, 3
    s_cselect_b32 s3, s47, 99
    s_cselect_b32 s57, 0, 3
    s_sub_u32 s47, s47, s57
    s_cmp_lt_u32 s56, 6
    s_cselect_b32 s57, 0, 3
    s_sub_u32 s47, s47, s57
    s_sub_u32 s57, s47, s46
    s_cmp_ge_u32 s47, s46
    s_cselect_b32 s47, s57, s47
    s_mul_i32 s56, s49, 3
    s_and_b32 s56, s56, 7
    s_andn2_b32 s49, s49, 7
    s_or_b32 s49, s49, s56
    s_mov_b32 s58, s48
    s_mov_b32 s48, 0x43210
    s_cmp_eq_u32 s58, 1
    s_cselect_b32 s48, 0x43210, s48
    s_cmp_eq_u32 s58, 2
    s_cselect_b32 s48, 0x14320, s48
    s_cmp_eq_u32 s58, 3
    s_cselect_b32 s48, 0x14320, s48
    s_cmp_eq_u32 s58, 4
    s_cselect_b32 s48, 0x21430, s48
    s_cmp_eq_u32 s58, 5
    s_cselect_b32 s48, 0x21430, s48
    s_cmp_ge_u32 s44, 4
    s_cbranch_scc1 k1_kernel_hn
    s_cmp_ge_u32 s49, 27
    s_cbranch_scc1 k1_kernel_cq
    s_setprio 3
    v_lshrrev_b32 v52, 4, v0
    s_lshl_b32 s53, s44, 3
    v_add_u32 v52, s53, v52
    v_xor_b32 v53, v0, v52
    v_and_b32 v53, 15, v53
    v_mul_u32_u24 v48, 1280, v52
    v_lshl_add_u32 v48, v53, 4, v48
    v_xor_b32 v49, 64, v48
    v_add_u32 v49, 5120, v49
    s_add_u32 s53, s45, s47
    s_mul_i32 s100, s53, 40960
    s_bfe_u32 s53, s48, 0x40000
    s_lshl_b32 s53, s53, 8
    s_add_u32 s60, s53, s100
    s_bfe_u32 s53, s48, 0x40004
    s_lshl_b32 s53, s53, 8
    s_add_u32 s61, s53, s100
    s_bfe_u32 s53, s48, 0x40008
    s_lshl_b32 s53, s53, 8
    s_add_u32 s62, s53, s100
    s_bfe_u32 s53, s48, 0x4000c
    s_lshl_b32 s53, s53, 8
    s_add_u32 s63, s53, s100
    s_bfe_u32 s53, s48, 0x40010
    s_lshl_b32 s53, s53, 8
    s_add_u32 s64, s53, s100
    s_lshl_b32 s68, s44, 11
    s_waitcnt lgkmcnt(0)
    s_mov_b32 s24, s4
    s_and_b32 s25, s5, 0xffff
    s_mov_b32 s26, 2621440
    s_mov_b32 s27, 0x20000
    s_add_u32 m0, s68, 0
    s_nop 0
    buffer_load_dwordx4 v48, s[24:27], s60 offen lds
    s_add_u32 m0, s68, 1024
    s_nop 0
    buffer_load_dwordx4 v49, s[24:27], s60 offen lds
    s_add_u32 m0, s68, 8192
    s_nop 0
    buffer_load_dwordx4 v48, s[24:27], s61 offen lds
    s_add_u32 m0, s68, 9216
    s_nop 0
    buffer_load_dwordx4 v49, s[24:27], s61 offen lds
    s_add_u32 m0, s68, 16384
    s_nop 0
    buffer_load_dwordx4 v48, s[24:27], s62 offen lds
    s_add_u32 m0, s68, 17408
    s_nop 0
    buffer_load_dwordx4 v49, s[24:27], s62 offen lds
    s_add_u32 m0, s68, 24576
    s_nop 0
    buffer_load_dwordx4 v48, s[24:27], s63 offen lds
    s_add_u32 m0, s68, 25600
    s_nop 0
    buffer_load_dwordx4 v49, s[24:27], s63 offen lds
    s_add_u32 m0, s68, 32768
    s_nop 0
    buffer_load_dwordx4 v48, s[24:27], s64 offen lds
    s_add_u32 m0, s68, 33792
    s_nop 0
    buffer_load_dwordx4 v49, s[24:27], s64 offen lds
    s_setprio 0
    v_and_b32 v6, 31, v0
    v_lshrrev_b32 v7, 5, v0
    v_xor_b32 v8, v6, v7
    v_and_b32 v8, 15, v8
    v_lshlrev_b32 v8, 4, v8
    v_lshl_add_u32 v8, v6, 8, v8
    v_xor_b32 v9, 32, v8
    v_xor_b32 v10, 64, v8
    v_xor_b32 v11, 96, v8
    v_xor_b32 v12, 128, v8
    v_xor_b32 v13, 160, v8
    v_xor_b32 v14, 192, v8
    v_xor_b32 v15, 224, v8
    v_lshlrev_b32 v1, 4, v0
    v_bfe_u32 v16, v0, 2, 2
    v_and_b32 v17, 3, v0
    v_bfe_u32 v18, v0, 4, 1
    v_lshl_add_u32 v19, v7, 3, v16
    v_lshrrev_b32 v20, 1, v16
    v_lshl_or_b32 v20, v18, 1, v20
    v_xor_b32 v20, s44, v20
    v_and_b32 v21, 1, v17
    v_lshrrev_b32 v22, 1, v17
    v_lshl_or_b32 v21, v21, 1, v22
    v_lshlrev_b32 v3, 13, v18
    v_lshl_add_u32 v3, v19, 7, v3
    v_lshl_add_u32 v3, v20, 5, v3
    v_lshl_add_u32 v3, v21, 3, v3
    v_add_u32 v3, 40960, v3
    v_add_u32 v4, 40960, v3
    v_lshlrev_b32 v2, 4, v6
    v_add_u32 v2, 122880, v2
    s_mov_b32 s60, 0x35c1a2a0
    s_mov_b32 s61, 0x3f317218
    s_mov_b32 s100, 40960
    s_lshl_b32 s62, s49, 2
    s_add_u32 s62, s62, s44
    s_mul_i32 s53, s45, 148
    s_add_u32 s62, s62, s53
    s_lshl_b32 s62, s62, 10
    s_mov_b32 s32, s22
    s_and_b32 s33, s23, 0xffff
    s_mov_b32 s34, 12849152
    s_mov_b32 s35, 0x20000
    s_mov_b32 s36, s20
    s_and_b32 s37, s21, 0xffff
    s_mov_b32 s38, 256
    s_mov_b32 s39, 0x20000
    s_mov_b32 s101, 0
    s_cmp_eq_u32 s44, 0
    s_cselect_b32 s66, 1, 0
    s_lshl_b32 s67, s45, 2
    s_mov_b32 s40, s6
    s_and_b32 s41, s7, 0xffff
    s_mov_b32 s42, 2457600
    s_mov_b32 s43, 0x20000
    s_bfe_u32 s54, s2, 0x20001
    s_mul_i32 s54, s54, 320
    s_andn2_b32 s54, s54, 127
    s_add_u32 s69, s54, 1280
    s_lshr_b32 s53, s2, 6
    s_mul_i32 s53, s53, 5
    s_bfe_u32 s54, s2, 0x30003
    s_add_u32 s53, s53, s54
    s_sub_u32 s53, s53, 8
    s_lshl_b32 s53, s53, 2
    s_add_u32 s53, s53, s44
    s_cmp_lt_u32 s54, 3
    s_cselect_b32 s53, 200, s53
    s_mul_i32 s53, s53, 26
    v_add_u32 v24, s53, v0
    v_mul_u32_u24 v25, 10923, v24
    v_lshrrev_b32 v25, 16, v25
    v_mul_u32_u24 v26, 6, v25
    v_sub_u32 v24, v24, v26
    v_lshlrev_b32 v26, 7, v24
    v_add_u32 v27, 896, v26
    v_cmp_gt_u32 vcc, 3, v24
    s_nop 1
    v_cndmask_b32 v26, v27, v26, vcc
    v_add_u32 v25, 0, v25
    v_mul_u32_u24 v25, 3840, v25
    v_add_u32 v28, v25, v26
    v_mov_b32 v24, 0x40000000
    v_cmp_gt_u32 vcc, 26, v0
    s_nop 1
    v_cndmask_b32 v28, v24, v28, vcc
    s_cmp_lt_u32 s54, 3
    s_cselect_b32 s53, 0x40000000, s69
    buffer_load_dword v5, v28, s[40:43], s53 offen
    s_lshr_b32 s53, s2, 3
    s_lshl_b32 s53, s53, 2
    s_add_u32 s53, s53, s44
    s_sub_u32 s53, s53, 32
    s_mul_i32 s53, s53, 24
    v_add_u32 v24, s53, v0
    v_mul_u32_u24 v25, 10923, v24
    v_lshrrev_b32 v25, 16, v25
    v_mul_u32_u24 v26, 6, v25
    v_sub_u32 v24, v24, v26
    v_lshlrev_b32 v26, 7, v24
    v_add_u32 v27, 896, v26
    v_cmp_gt_u32 vcc, 3, v24
    s_nop 1
    v_cndmask_b32 v26, v27, v26, vcc
    v_add_u32 v25, 256, v25
    v_mul_u32_u24 v25, 3840, v25
    v_add_u32 v29, v25, v26
    v_mov_b32 v24, 0x40000000
    v_cmp_gt_u32 vcc, 24, v0
    s_nop 1
    v_cndmask_b32 v29, v24, v29, vcc
    s_lshr_b32 s14, s2, 5
    s_and_b32 s53, s2, 7
    s_bfe_u32 s54, s2, 0x20003
    s_lshl_b32 s13, s53, 2
    s_add_u32 s13, s13, s54
    s_mul_i32 s8, s13, 303104
    s_mul_i32 s9, s14, 378880
    s_add_u32 s9, s9, 9699328
    s_lshr_b32 s53, s13, 4
    s_mul_i32 s11, s53, 6144
    s_and_b32 s53, s13, 15
    s_lshl_b32 s53, s53, 1
    s_add_u32 s54, s53, 1
    s_cmp_ge_u32 s53, 22
    s_cselect_b32 s55, 2048, 0
    s_cselect_b32 s56, 11, 0
    s_add_u32 s11, s11, s55
    s_sub_u32 s54, s54, s56
    s_cmp_ge_u32 s53, 10
    s_cselect_b32 s55, 2048, 0
    s_cselect_b32 s56, 11, 0
    s_add_u32 s12, s11, s55
    s_sub_u32 s54, s54, s56
    s_cmp_eq_u32 s53, 10
    s_cselect_b32 s11, s11, s12
    s_mul_i32 s55, s54, 11
    s_lshr_b32 s55, s55, 5
    s_mul_i32 s54, s54, 3
    s_sub_u32 s54, s54, s55
    s_add_u32 s54, s54, 11
    s_sub_u32 s55, s54, 27
    s_cmp_ge_u32 s54, 27
    s_cselect_b32 s54, s55, s54
    s_lshl_b32 s10, s54, 1
    s_and_b32 s53, s2, 1
    s_mul_i32 s53, s53, 3
    s_lshr_b32 s54, s2, 6
    s_add_u32 s53, s53, s54
    s_sub_u32 s53, s53, 1
    s_lshl_b32 s53, s53, 5
    s_add_u32 s53, s53, s49
    s_lshl_b32 s15, s53, 6
    s_add_u32 s15, s15, 12821504
    s_mov_b32 s53, 40960
    s_mov_b32 s54, 81920
    s_cmp_eq_u32 s46, 10
    s_cselect_b32 s16, s53, s54
    s_cselect_b32 s17, s54, 0
    s_cselect_b32 s7, 0, s53
    s_lshl_b32 s54, s47, 9
    s_add_u32 s54, s54, 122880
    s_waitcnt vmcnt(1)
    v_lshrrev_b32 v16, 3, v0
    s_lshl_b32 s53, s44, 3
    v_add_u32 v16, s53, v16
    v_and_b32 v17, 7, v0
    v_lshlrev_b32 v18, 4, v17
    v_lshl_add_u32 v18, v16, 8, v18
    v_and_b32 v19, 16, v0
    v_lshl_add_u32 v18, v19, 3, v18
    v_xor_b32 v19, 0x80, v18
    ds_read_b128 v[48:51], v18 offset:0
    ds_read_b128 v[52:55], v19 offset:0
    ds_read_b128 v[56:59], v18 offset:8192
    ds_read_b128 v[60:63], v19 offset:8192
    ds_read_b128 v[64:67], v18 offset:16384
    ds_read_b128 v[68:71], v19 offset:16384
    ds_read_b128 v[72:75], v18 offset:24576
    ds_read_b128 v[76:79], v19 offset:24576
    ds_read_b128 v[80:83], v18 offset:32768
    ds_read_b128 v[84:87], v19 offset:32768
    v_lshlrev_b32 v17, 4, v16
    s_waitcnt lgkmcnt(9)
    v_dot2_f32_bf16 v22, v48, v48, 0
    v_dot2_f32_bf16 v23, v49, v49, 0
    v_dot2_f32_bf16 v22, v50, v50, v22
    v_dot2_f32_bf16 v23, v51, v51, v23
    s_waitcnt lgkmcnt(8)
    v_dot2_f32_bf16 v22, v52, v52, v22
    v_dot2_f32_bf16 v18, v52, s52, 0
    v_dot2_f32_bf16 v23, v53, v53, v23
    v_dot2_f32_bf16 v19, v53, s52, 0
    v_dot2_f32_bf16 v22, v54, v54, v22
    v_dot2_f32_bf16 v18, v54, s52, v18
    v_dot2_f32_bf16 v23, v55, v55, v23
    v_dot2_f32_bf16 v19, v55, s52, v19
    s_waitcnt lgkmcnt(7)
    v_dot2_f32_bf16 v22, v56, v56, v22
    v_dot2_f32_bf16 v18, v56, s52, v18
    v_dot2_f32_bf16 v23, v57, v57, v23
    v_dot2_f32_bf16 v19, v57, s52, v19
    v_dot2_f32_bf16 v22, v58, v58, v22
    v_dot2_f32_bf16 v18, v58, s52, v18
    v_dot2_f32_bf16 v23, v59, v59, v23
    v_dot2_f32_bf16 v19, v59, s52, v19
    s_waitcnt lgkmcnt(6)
    v_dot2_f32_bf16 v22, v60, v60, v22
    v_dot2_f32_bf16 v18, v60, s52, v18
    v_dot2_f32_bf16 v23, v61, v61, v23
    v_dot2_f32_bf16 v19, v61, s52, v19
    v_dot2_f32_bf16 v22, v62, v62, v22
    v_dot2_f32_bf16 v18, v62, s52, v18
    v_dot2_f32_bf16 v23, v63, v63, v23
    v_dot2_f32_bf16 v19, v63, s52, v19
    s_waitcnt lgkmcnt(5)
    v_dot2_f32_bf16 v22, v64, v64, v22
    v_dot2_f32_bf16 v18, v64, s52, v18
    v_dot2_f32_bf16 v23, v65, v65, v23
    v_dot2_f32_bf16 v19, v65, s52, v19
    v_dot2_f32_bf16 v22, v66, v66, v22
    v_dot2_f32_bf16 v18, v66, s52, v18
    v_dot2_f32_bf16 v23, v67, v67, v23
    v_dot2_f32_bf16 v19, v67, s52, v19
    s_waitcnt lgkmcnt(4)
    v_dot2_f32_bf16 v22, v68, v68, v22
    v_dot2_f32_bf16 v18, v68, s52, v18
    v_dot2_f32_bf16 v23, v69, v69, v23
    v_dot2_f32_bf16 v19, v69, s52, v19
    v_dot2_f32_bf16 v22, v70, v70, v22
    v_dot2_f32_bf16 v18, v70, s52, v18
    v_dot2_f32_bf16 v23, v71, v71, v23
    v_dot2_f32_bf16 v19, v71, s52, v19
    s_waitcnt lgkmcnt(3)
    v_dot2_f32_bf16 v22, v72, v72, v22
    v_dot2_f32_bf16 v18, v72, s52, v18
    v_dot2_f32_bf16 v23, v73, v73, v23
    v_dot2_f32_bf16 v19, v73, s52, v19
    v_dot2_f32_bf16 v22, v74, v74, v22
    v_dot2_f32_bf16 v18, v74, s52, v18
    v_dot2_f32_bf16 v23, v75, v75, v23
    v_dot2_f32_bf16 v19, v75, s52, v19
    s_waitcnt lgkmcnt(2)
    v_dot2_f32_bf16 v22, v76, v76, v22
    v_dot2_f32_bf16 v18, v76, s52, v18
    v_dot2_f32_bf16 v23, v77, v77, v23
    v_dot2_f32_bf16 v19, v77, s52, v19
    v_dot2_f32_bf16 v22, v78, v78, v22
    v_dot2_f32_bf16 v18, v78, s52, v18
    v_dot2_f32_bf16 v23, v79, v79, v23
    v_dot2_f32_bf16 v19, v79, s52, v19
    s_waitcnt lgkmcnt(1)
    v_dot2_f32_bf16 v22, v80, v80, v22
    v_dot2_f32_bf16 v18, v80, s52, v18
    v_dot2_f32_bf16 v23, v81, v81, v23
    v_dot2_f32_bf16 v19, v81, s52, v19
    v_dot2_f32_bf16 v22, v82, v82, v22
    v_dot2_f32_bf16 v18, v82, s52, v18
    v_dot2_f32_bf16 v23, v83, v83, v23
    v_dot2_f32_bf16 v19, v83, s52, v19
    s_waitcnt lgkmcnt(0)
    v_dot2_f32_bf16 v22, v84, v84, v22
    v_dot2_f32_bf16 v18, v84, s52, v18
    v_dot2_f32_bf16 v23, v85, v85, v23
    v_dot2_f32_bf16 v19, v85, s52, v19
    v_dot2_f32_bf16 v22, v86, v86, v22
    v_dot2_f32_bf16 v18, v86, s52, v18
    v_dot2_f32_bf16 v23, v87, v87, v23
    v_dot2_f32_bf16 v19, v87, s52, v19
    v_dot2_f32_bf16 v18, v48, s52, v18
    v_dot2_f32_bf16 v19, v49, s52, v19
    v_dot2_f32_bf16 v18, v50, s52, v18
    v_dot2_f32_bf16 v19, v51, s52, v19
    s_nop 2
    v_add_f32 v18, v18, v19
    v_add_f32 v22, v22, v23
    s_nop 0
    v_add_f32_dpp v18, v18, v18 quad_perm:[1,0,3,2] row_mask:0xf bank_mask:0xf
    v_add_f32_dpp v22, v22, v22 quad_perm:[1,0,3,2] row_mask:0xf bank_mask:0xf
    s_nop 0
    v_add_f32_dpp v18, v18, v18 quad_perm:[2,3,0,1] row_mask:0xf bank_mask:0xf
    v_add_f32_dpp v22, v22, v22 quad_perm:[2,3,0,1] row_mask:0xf bank_mask:0xf
    s_nop 0
    v_add_f32_dpp v18, v18, v18 row_half_mirror row_mask:0xf bank_mask:0xf
    v_add_f32_dpp v22, v22, v22 row_half_mirror row_mask:0xf bank_mask:0xf
    v_mul_f32 v18, 0x3acccccd, v18
    v_mov_b32 v19, 0x3727c5ac
    v_fmac_f32 v19, 0x3acccccd, v22
    v_fma_f32 v19, -v18, v18, v19
    v_rsq_f32 v23, v19
    v_xor_b32 v20, 0x80000000, v18
    v_add_u32 v18, s54, v17
    s_mov_b32 exec_lo, 0x01010101
    s_mov_b32 exec_hi, 0x01010101
    v_mul_f32 v21, 0x3fb8aa3b, v23
    v_mul_f32 v22, v19, v23
    ds_write_b128 v18, v[20:23]
    s_cmp_ge_u32 s3, s46
    s_cbranch_scc1 k1_kernel_cgu_nopub
    s_add_u32 s53, s45, s47
    s_lshl_b32 s54, s53, 9
    s_add_u32 s54, s54, 12730368
    buffer_store_dwordx4 v[20:23], v17, s[32:35], s54 offen sc1
    s_lshl_b32 s99, s53, 2
    s_add_u32 s54, s99, s44
    s_mul_i32 s54, s54, 320
    s_add_u32 s54, s54, 12767232
    s_mov_b64 exec, 0xfffff
    v_mov_b32 v24, 0
    v_mov_b32 v25, 0
    v_mov_b32 v26, 0
    v_mov_b32 v27, 0
    buffer_store_dwordx4 v[24:27], v1, s[32:35], s54 offen sc1
    s_mov_b32 s101, 1
    s_nop 1
k1_kernel_cgu_nopub:
    s_mov_b64 exec, -1
    buffer_load_dword v5, v29, s[40:43], s69 offen
    s_mov_b32 vcc_lo, 0xf0f00f0f
    s_mov_b32 vcc_hi, 0xf0f00f0f
    v_mov_b32 v47, s52
    s_nop 1
    v_cndmask_b32 v44, 0, v47, vcc
    v_cndmask_b32 v45, 0, v47, vcc
    v_cndmask_b32 v46, 0, v47, vcc
    v_cndmask_b32 v47, 0, v47, vcc
    s_waitcnt lgkmcnt(0)
    s_cmp_eq_u32 s101, 0
    s_cbranch_scc1 k1_kernel_cgu_nfw
    s_waitcnt vmcnt(1)
k1_kernel_cgu_nfw:
    s_barrier
    s_and_b32 s53, s101, s66
    s_cbranch_scc0 k1_kernel_cgu_nof
    v_mov_b32 v7, 1
    s_mov_b64 exec, 1
    buffer_store_dword v7, off, s[36:39], s99 sc1
    s_mov_b64 exec, -1
    s_mov_b32 s101, 0
k1_kernel_cgu_nof:
    ds_read_b64_tr_b16 v[96:97], v4 offset:20480
    ds_read_b64_tr_b16 v[98:99], v4 offset:20992
    ds_read_b64_tr_b16 v[100:101], v4 offset:22528
    ds_read_b64_tr_b16 v[102:103], v4 offset:23040
    ds_read_b64_tr_b16 v[104:105], v4 offset:24576
    ds_read_b64_tr_b16 v[106:107], v4 offset:25088
    ds_read_b64_tr_b16 v[108:109], v4 offset:26624
    ds_read_b64_tr_b16 v[110:111], v4 offset:27136
    ds_read_b128 v[40:43], v8 offset:0
    ds_read_b128 v[16:19], v9 offset:0
    ds_read_b128 v[20:23], v10 offset:0
    ds_read_b128 v[24:27], v11 offset:0
    ds_read_b128 v[28:31], v12 offset:0
    ds_read_b128 v[32:35], v13 offset:0
    ds_read_b128 v[36:39], v14 offset:0
    s_waitcnt lgkmcnt(7)
    s_barrier
    v_mfma_f32_16x16x32_bf16 v[60:63], v[96:99], v[44:47], 0
    ds_read_b64_tr_b16 v[112:113], v4 offset:48128
    ds_read_b64_tr_b16 v[114:115], v4 offset:48640
    v_mfma_f32_16x16x32_bf16 v[60:63], v[100:103], v[44:47], v[60:63]
    ds_read_b64_tr_b16 v[116:117], v4 offset:50176
    ds_read_b64_tr_b16 v[118:119], v4 offset:50688
    v_mfma_f32_16x16x32_bf16 v[60:63], v[104:107], v[44:47], v[60:63]
    ds_read_b64_tr_b16 v[120:121], v4 offset:52224
    ds_read_b64_tr_b16 v[122:123], v4 offset:52736
    v_mfma_f32_16x16x32_bf16 v[60:63], v[108:111], v[44:47], v[60:63]
    ds_read_b64_tr_b16 v[124:125], v4 offset:54272
    ds_read_b64_tr_b16 v[126:127], v4 offset:54784
    s_waitcnt lgkmcnt(14)
    v_mfma_f32_32x32x16_bf16 v[64:79], v[96:99], v[40:43], 0
    ds_read_b128 v[40:43], v15 offset:0
    s_waitcnt lgkmcnt(14)
    v_mfma_f32_32x32x16_bf16 v[64:79], v[100:103], v[16:19], v[64:79]
    s_waitcnt lgkmcnt(13)
    v_mfma_f32_32x32x16_bf16 v[64:79], v[104:107], v[20:23], v[64:79]
    s_waitcnt lgkmcnt(12)
    v_mfma_f32_32x32x16_bf16 v[64:79], v[108:111], v[24:27], v[64:79]
    s_waitcnt lgkmcnt(1)
    s_barrier
    v_mfma_f32_16x16x32_bf16 v[60:63], v[112:115], v[44:47], v[60:63]
    ds_read_b64_tr_b16 v[128:129], v3 offset:24576
    ds_read_b64_tr_b16 v[130:131], v3 offset:25088
    v_mfma_f32_16x16x32_bf16 v[60:63], v[116:119], v[44:47], v[60:63]
    ds_read_b64_tr_b16 v[132:133], v3 offset:26624
    ds_read_b64_tr_b16 v[134:135], v3 offset:27136
    v_mfma_f32_16x16x32_bf16 v[60:63], v[120:123], v[44:47], v[60:63]
    ds_read_b64_tr_b16 v[136:137], v3 offset:28672
    ds_read_b64_tr_b16 v[138:139], v3 offset:29184
    v_mfma_f32_16x16x32_bf16 v[60:63], v[124:127], v[44:47], v[60:63]
    ds_read_b64_tr_b16 v[140:141], v3 offset:30720
    ds_read_b64_tr_b16 v[142:143], v3 offset:31232
    v_mfma_f32_32x32x16_bf16 v[64:79], v[112:115], v[28:31], v[64:79]
    ds_read_b128 v[16:19], v8 offset:40960
    ds_read_b128 v[20:23], v9 offset:40960
    v_mfma_f32_32x32x16_bf16 v[64:79], v[116:119], v[32:35], v[64:79]
    ds_read_b128 v[24:27], v10 offset:40960
    ds_read_b128 v[28:31], v11 offset:40960
    v_mfma_f32_32x32x16_bf16 v[64:79], v[120:123], v[36:39], v[64:79]
    ds_read_b128 v[32:35], v8 offset:8192
    ds_read_b128 v[36:39], v9 offset:8192
    s_waitcnt lgkmcnt(14)
    v_mfma_f32_32x32x16_bf16 v[64:79], v[124:127], v[40:43], v[64:79]
    ds_read_b128 v[40:43], v10 offset:8192
    s_waitcnt lgkmcnt(6)
    v_mfma_f32_32x32x16_bf16 v[80:95], v[96:99], v[16:19], 0
    ds_read_b128 v[16:19], v11 offset:8192
    s_waitcnt lgkmcnt(6)
    v_mfma_f32_32x32x16_bf16 v[80:95], v[100:103], v[20:23], v[80:95]
    ds_read_b128 v[20:23], v12 offset:40960
    s_waitcnt lgkmcnt(6)
    v_mfma_f32_32x32x16_bf16 v[80:95], v[104:107], v[24:27], v[80:95]
    ds_read_b128 v[24:27], v13 offset:40960
    s_waitcnt lgkmcnt(6)
    v_mfma_f32_32x32x16_bf16 v[80:95], v[108:111], v[28:31], v[80:95]
    ds_read_b128 v[28:31], v14 offset:40960
    s_barrier
    v_mfma_f32_16x16x32_bf16 v[60:63], v[128:131], v[44:47], v[60:63]
    ds_read_b64_tr_b16 v[144:145], v4 offset:0
    ds_read_b64_tr_b16 v[146:147], v4 offset:512
    v_mfma_f32_16x16x32_bf16 v[60:63], v[132:135], v[44:47], v[60:63]
    ds_read_b64_tr_b16 v[148:149], v4 offset:2048
    ds_read_b64_tr_b16 v[150:151], v4 offset:2560
    v_mfma_f32_16x16x32_bf16 v[60:63], v[136:139], v[44:47], v[60:63]
    ds_read_b64_tr_b16 v[152:153], v4 offset:4096
    ds_read_b64_tr_b16 v[154:155], v4 offset:4608
    v_mfma_f32_16x16x32_bf16 v[60:63], v[140:143], v[44:47], v[60:63]
    ds_read_b64_tr_b16 v[156:157], v4 offset:6144
    ds_read_b64_tr_b16 v[158:159], v4 offset:6656
    s_waitcnt lgkmcnt(14)
    v_mfma_f32_32x32x16_bf16 v[64:79], v[128:131], v[32:35], v[64:79]
    ds_read_b128 v[32:35], v15 offset:40960
    s_waitcnt lgkmcnt(14)
    v_mfma_f32_32x32x16_bf16 v[64:79], v[132:135], v[36:39], v[64:79]
    ds_read_b128 v[36:39], v12 offset:8192
    s_waitcnt lgkmcnt(14)
    v_mfma_f32_32x32x16_bf16 v[64:79], v[136:139], v[40:43], v[64:79]
    ds_read_b128 v[40:43], v13 offset:8192
    s_waitcnt lgkmcnt(14)
    v_mfma_f32_32x32x16_bf16 v[64:79], v[140:143], v[16:19], v[64:79]
    ds_read_b128 v[16:19], v14 offset:8192
    s_waitcnt lgkmcnt(14)
    v_mfma_f32_32x32x16_bf16 v[80:95], v[112:115], v[20:23], v[80:95]
    ds_read_b128 v[20:23], v15 offset:8192
    s_waitcnt lgkmcnt(14)
    v_mfma_f32_32x32x16_bf16 v[80:95], v[116:119], v[24:27], v[80:95]
    s_waitcnt lgkmcnt(13)
    v_mfma_f32_32x32x16_bf16 v[80:95], v[120:123], v[28:31], v[80:95]
    s_waitcnt lgkmcnt(4)
    v_mfma_f32_32x32x16_bf16 v[80:95], v[124:127], v[32:35], v[80:95]
    s_barrier
    v_mfma_f32_16x16x32_bf16 v[60:63], v[144:147], v[44:47], v[60:63]
    ds_read_b64_tr_b16 v[160:161], v4 offset:20480
    ds_read_b64_tr_b16 v[162:163], v4 offset:20992
    v_mfma_f32_16x16x32_bf16 v[60:63], v[148:151], v[44:47], v[60:63]
    ds_read_b64_tr_b16 v[164:165], v4 offset:22528
    ds_read_b64_tr_b16 v[166:167], v4 offset:23040
    v_mfma_f32_16x16x32_bf16 v[60:63], v[152:155], v[44:47], v[60:63]
    ds_read_b64_tr_b16 v[168:169], v4 offset:24576
    ds_read_b64_tr_b16 v[170:171], v4 offset:25088
    v_mfma_f32_16x16x32_bf16 v[60:63], v[156:159], v[44:47], v[60:63]
    ds_read_b64_tr_b16 v[172:173], v4 offset:26624
    ds_read_b64_tr_b16 v[174:175], v4 offset:27136
    s_waitcnt lgkmcnt(11)
    v_mfma_f32_32x32x16_bf16 v[64:79], v[144:147], v[36:39], v[64:79]
    ds_read_b128 v[24:27], v8 offset:49152
    ds_read_b128 v[28:31], v9 offset:49152
    s_waitcnt lgkmcnt(12)
    v_mfma_f32_32x32x16_bf16 v[64:79], v[148:151], v[40:43], v[64:79]
    ds_read_b128 v[32:35], v10 offset:49152
    ds_read_b128 v[36:39], v11 offset:49152
    s_waitcnt lgkmcnt(13)
    v_mfma_f32_32x32x16_bf16 v[64:79], v[152:155], v[16:19], v[64:79]
    ds_read_b128 v[40:43], v8 offset:16384
    ds_read_b128 v[16:19], v9 offset:16384
    s_waitcnt lgkmcnt(14)
    v_mfma_f32_32x32x16_bf16 v[64:79], v[156:159], v[20:23], v[64:79]
    ds_read_b128 v[20:23], v10 offset:16384
    s_waitcnt lgkmcnt(6)
    v_mfma_f32_32x32x16_bf16 v[80:95], v[128:131], v[24:27], v[80:95]
    ds_read_b128 v[24:27], v11 offset:16384
    s_waitcnt lgkmcnt(6)
    v_mfma_f32_32x32x16_bf16 v[80:95], v[132:135], v[28:31], v[80:95]
    ds_read_b128 v[28:31], v12 offset:49152
    s_waitcnt lgkmcnt(6)
    v_mfma_f32_32x32x16_bf16 v[80:95], v[136:139], v[32:35], v[80:95]
    ds_read_b128 v[32:35], v13 offset:49152
    s_waitcnt lgkmcnt(6)
    v_mfma_f32_32x32x16_bf16 v[80:95], v[140:143], v[36:39], v[80:95]
    ds_read_b128 v[36:39], v14 offset:49152
    s_barrier
    v_mfma_f32_16x16x32_bf16 v[60:63], v[160:163], v[44:47], v[60:63]
    ds_read_b64_tr_b16 v[176:177], v4 offset:48128
    ds_read_b64_tr_b16 v[178:179], v4 offset:48640
    v_mfma_f32_16x16x32_bf16 v[60:63], v[164:167], v[44:47], v[60:63]
    ds_read_b64_tr_b16 v[180:181], v4 offset:50176
    ds_read_b64_tr_b16 v[182:183], v4 offset:50688
    v_mfma_f32_16x16x32_bf16 v[60:63], v[168:171], v[44:47], v[60:63]
    ds_read_b64_tr_b16 v[184:185], v4 offset:52224
    ds_read_b64_tr_b16 v[186:187], v4 offset:52736
    v_mfma_f32_16x16x32_bf16 v[60:63], v[172:175], v[44:47], v[60:63]
    ds_read_b64_tr_b16 v[188:189], v4 offset:54272
    ds_read_b64_tr_b16 v[190:191], v4 offset:54784
    s_waitcnt lgkmcnt(14)
    v_mfma_f32_32x32x16_bf16 v[64:79], v[160:163], v[40:43], v[64:79]
    ds_read_b128 v[40:43], v15 offset:49152
    s_waitcnt lgkmcnt(14)
    v_mfma_f32_32x32x16_bf16 v[64:79], v[164:167], v[16:19], v[64:79]
    ds_read_b128 v[16:19], v12 offset:16384
    s_waitcnt lgkmcnt(14)
    v_mfma_f32_32x32x16_bf16 v[64:79], v[168:171], v[20:23], v[64:79]
    ds_read_b128 v[20:23], v13 offset:16384
    s_waitcnt lgkmcnt(14)
    v_mfma_f32_32x32x16_bf16 v[64:79], v[172:175], v[24:27], v[64:79]
    ds_read_b128 v[24:27], v14 offset:16384
    s_waitcnt lgkmcnt(14)
    v_mfma_f32_32x32x16_bf16 v[80:95], v[144:147], v[28:31], v[80:95]
    ds_read_b128 v[28:31], v15 offset:16384
    s_waitcnt lgkmcnt(14)
    v_mfma_f32_32x32x16_bf16 v[80:95], v[148:151], v[32:35], v[80:95]
    s_waitcnt lgkmcnt(13)
    v_mfma_f32_32x32x16_bf16 v[80:95], v[152:155], v[36:39], v[80:95]
    s_waitcnt lgkmcnt(4)
    v_mfma_f32_32x32x16_bf16 v[80:95], v[156:159], v[40:43], v[80:95]
    s_waitcnt vmcnt(0)
    s_barrier
    v_mfma_f32_16x16x32_bf16 v[60:63], v[176:179], v[44:47], v[60:63]
    ds_read_b64_tr_b16 v[192:193], v3 offset:24576
    ds_read_b64_tr_b16 v[194:195], v3 offset:25088
    v_mfma_f32_16x16x32_bf16 v[60:63], v[180:183], v[44:47], v[60:63]
    ds_read_b64_tr_b16 v[196:197], v3 offset:26624
    ds_read_b64_tr_b16 v[198:199], v3 offset:27136
    v_mfma_f32_16x16x32_bf16 v[60:63], v[184:187], v[44:47], v[60:63]
    ds_read_b64_tr_b16 v[200:201], v3 offset:28672
    ds_read_b64_tr_b16 v[202:203], v3 offset:29184
    v_mfma_f32_16x16x32_bf16 v[60:63], v[188:191], v[44:47], v[60:63]
    ds_read_b64_tr_b16 v[204:205], v3 offset:30720
    ds_read_b64_tr_b16 v[206:207], v3 offset:31232
    s_waitcnt lgkmcnt(11)
    v_mfma_f32_32x32x16_bf16 v[64:79], v[176:179], v[16:19], v[64:79]
    ds_read_b128 v[32:35], v8 offset:57344
    ds_read_b128 v[36:39], v9 offset:57344
    s_waitcnt lgkmcnt(12)
    v_mfma_f32_32x32x16_bf16 v[64:79], v[180:183], v[20:23], v[64:79]
    ds_read_b128 v[40:43], v10 offset:57344
    ds_read_b128 v[16:19], v11 offset:57344
    s_waitcnt lgkmcnt(13)
    v_mfma_f32_32x32x16_bf16 v[64:79], v[184:187], v[24:27], v[64:79]
    ds_read_b128 v[20:23], v8 offset:24576
    ds_read_b128 v[24:27], v9 offset:24576
    s_waitcnt lgkmcnt(14)
    v_mfma_f32_32x32x16_bf16 v[64:79], v[188:191], v[28:31], v[64:79]
    ds_read_b128 v[28:31], v10 offset:24576
    s_waitcnt lgkmcnt(6)
    v_mfma_f32_32x32x16_bf16 v[80:95], v[160:163], v[32:35], v[80:95]
    ds_read_b128 v[32:35], v11 offset:24576
    s_waitcnt lgkmcnt(6)
    v_mfma_f32_32x32x16_bf16 v[80:95], v[164:167], v[36:39], v[80:95]
    ds_read_b128 v[36:39], v12 offset:57344
    s_waitcnt lgkmcnt(6)
    v_mfma_f32_32x32x16_bf16 v[80:95], v[168:171], v[40:43], v[80:95]
    ds_read_b128 v[40:43], v13 offset:57344
    s_waitcnt lgkmcnt(6)
    v_mfma_f32_32x32x16_bf16 v[80:95], v[172:175], v[16:19], v[80:95]
    ds_read_b128 v[16:19], v14 offset:57344
    s_barrier
    v_mfma_f32_16x16x32_bf16 v[60:63], v[192:195], v[44:47], v[60:63]
    ds_read_b64_tr_b16 v[208:209], v4 offset:0
    ds_read_b64_tr_b16 v[210:211], v4 offset:512
    v_mfma_f32_16x16x32_bf16 v[60:63], v[196:199], v[44:47], v[60:63]
    ds_read_b64_tr_b16 v[212:213], v4 offset:2048
    ds_read_b64_tr_b16 v[214:215], v4 offset:2560
    v_mfma_f32_16x16x32_bf16 v[60:63], v[200:203], v[44:47], v[60:63]
    ds_read_b64_tr_b16 v[216:217], v4 offset:4096
    ds_read_b64_tr_b16 v[218:219], v4 offset:4608
    v_mfma_f32_16x16x32_bf16 v[60:63], v[204:207], v[44:47], v[60:63]
    ds_read_b64_tr_b16 v[220:221], v4 offset:6144
    ds_read_b64_tr_b16 v[222:223], v4 offset:6656
    s_cmp_lg_u32 s66, 0
    s_cbranch_scc0 k1_kernel_cgu_k7
    s_call_b64 s[4:5], k1_kernel_cgu_chk
k1_kernel_cgu_k7:
    s_waitcnt lgkmcnt(14)
    v_mfma_f32_32x32x16_bf16 v[64:79], v[192:195], v[20:23], v[64:79]
    ds_read_b128 v[20:23], v15 offset:57344
    s_waitcnt lgkmcnt(14)
    v_mfma_f32_32x32x16_bf16 v[64:79], v[196:199], v[24:27], v[64:79]
    ds_read_b128 v[24:27], v12 offset:24576
    s_waitcnt lgkmcnt(14)
    v_mfma_f32_32x32x16_bf16 v[64:79], v[200:203], v[28:31], v[64:79]
    ds_read_b128 v[28:31], v13 offset:24576
    s_waitcnt lgkmcnt(14)
    v_mfma_f32_32x32x16_bf16 v[64:79], v[204:207], v[32:35], v[64:79]
    ds_read_b128 v[32:35], v14 offset:24576
    s_waitcnt lgkmcnt(14)
    v_mfma_f32_32x32x16_bf16 v[80:95], v[176:179], v[36:39], v[80:95]
    ds_read_b128 v[36:39], v15 offset:24576
    s_waitcnt lgkmcnt(14)
    v_mfma_f32_32x32x16_bf16 v[80:95], v[180:183], v[40:43], v[80:95]
    ds_read_b128 v[40:43], v8 offset:32768
    s_waitcnt lgkmcnt(14)
    v_mfma_f32_32x32x16_bf16 v[80:95], v[184:187], v[16:19], v[80:95]
    ds_read_b128 v[16:19], v9 offset:32768
    s_waitcnt lgkmcnt(6)
    v_mfma_f32_32x32x16_bf16 v[80:95], v[188:191], v[20:23], v[80:95]
    ds_read_b128 v[20:23], v10 offset:32768
    s_barrier
    v_mfma_f32_16x16x32_bf16 v[60:63], v[208:211], v[44:47], v[60:63]
    ds_read_b64_tr_b16 v[224:225], v4 offset:20480
    ds_read_b64_tr_b16 v[226:227], v4 offset:20992
    v_mfma_f32_16x16x32_bf16 v[60:63], v[212:215], v[44:47], v[60:63]
    ds_read_b64_tr_b16 v[228:229], v4 offset:22528
    ds_read_b64_tr_b16 v[230:231], v4 offset:23040
    v_mfma_f32_16x16x32_bf16 v[60:63], v[216:219], v[44:47], v[60:63]
    ds_read_b64_tr_b16 v[232:233], v4 offset:24576
    ds_read_b64_tr_b16 v[234:235], v4 offset:25088
    v_mfma_f32_16x16x32_bf16 v[60:63], v[220:223], v[44:47], v[60:63]
    ds_read_b64_tr_b16 v[236:237], v4 offset:26624
    ds_read_b64_tr_b16 v[238:239], v4 offset:27136
    s_cmp_lg_u32 s66, 0
    s_cbranch_scc0 k1_kernel_cgu_k8
    s_call_b64 s[4:5], k1_kernel_cgu_chk
k1_kernel_cgu_k8:
    s_waitcnt lgkmcnt(14)
    v_mfma_f32_32x32x16_bf16 v[64:79], v[208:211], v[24:27], v[64:79]
    ds_read_b128 v[24:27], v11 offset:32768
    s_waitcnt lgkmcnt(14)
    v_mfma_f32_32x32x16_bf16 v[64:79], v[212:215], v[28:31], v[64:79]
    ds_read_b128 v[28:31], v12 offset:32768
    s_waitcnt lgkmcnt(14)
    v_mfma_f32_32x32x16_bf16 v[64:79], v[216:219], v[32:35], v[64:79]
    ds_read_b128 v[32:35], v13 offset:32768
    s_waitcnt lgkmcnt(14)
    v_mfma_f32_32x32x16_bf16 v[64:79], v[220:223], v[36:39], v[64:79]
    ds_read_b128 v[36:39], v14 offset:32768
    s_waitcnt lgkmcnt(4)
    s_barrier
    v_mfma_f32_16x16x32_bf16 v[60:63], v[224:227], v[44:47], v[60:63]
    ds_read_b64_tr_b16 v[240:241], v4 offset:48128
    ds_read_b64_tr_b16 v[242:243], v4 offset:48640
    v_mfma_f32_16x16x32_bf16 v[60:63], v[228:231], v[44:47], v[60:63]
    ds_read_b64_tr_b16 v[244:245], v4 offset:50176
    ds_read_b64_tr_b16 v[246:247], v4 offset:50688
    v_mfma_f32_16x16x32_bf16 v[60:63], v[232:235], v[44:47], v[60:63]
    ds_read_b64_tr_b16 v[248:249], v4 offset:52224
    ds_read_b64_tr_b16 v[250:251], v4 offset:52736
    v_mfma_f32_16x16x32_bf16 v[60:63], v[236:239], v[44:47], v[60:63]
    ds_read_b64_tr_b16 v[252:253], v4 offset:54272
    ds_read_b64_tr_b16 v[254:255], v4 offset:54784
    s_cmp_lg_u32 s66, 0
    s_cbranch_scc0 k1_kernel_cgu_k9
    s_call_b64 s[4:5], k1_kernel_cgu_chk
k1_kernel_cgu_k9:
    v_mfma_f32_32x32x16_bf16 v[64:79], v[224:227], v[40:43], v[64:79]
    ds_read_b128 v[40:43], v15 offset:32768
    v_mfma_f32_32x32x16_bf16 v[64:79], v[228:231], v[16:19], v[64:79]
    v_mfma_f32_32x32x16_bf16 v[64:79], v[232:235], v[20:23], v[64:79]
    s_waitcnt lgkmcnt(12)
    v_mfma_f32_32x32x16_bf16 v[64:79], v[236:239], v[24:27], v[64:79]
    s_waitcnt lgkmcnt(1)
    s_waitcnt lgkmcnt(0)
    s_barrier
    v_add_u32 v8, 40960, v8
    v_add_u32 v9, 40960, v9
    v_add_u32 v10, 40960, v10
    v_add_u32 v11, 40960, v11
    v_add_u32 v12, 40960, v12
    v_add_u32 v13, 40960, v13
    v_add_u32 v14, 40960, v14
    v_add_u32 v15, 40960, v15
    v_mfma_f32_16x16x32_bf16 v[60:63], v[240:243], v[44:47], v[60:63]
    ds_read_b128 v[16:19], v8 offset:24576
    ds_read_b128 v[20:23], v9 offset:24576
    v_mfma_f32_16x16x32_bf16 v[60:63], v[244:247], v[44:47], v[60:63]
    ds_read_b128 v[24:27], v10 offset:24576
    v_mfma_f32_16x16x32_bf16 v[60:63], v[248:251], v[44:47], v[60:63]
    v_mfma_f32_16x16x32_bf16 v[60:63], v[252:255], v[44:47], v[60:63]
    s_cmp_lg_u32 s66, 0
    s_cbranch_scc0 k1_kernel_cgu_k10
    s_call_b64 s[4:5], k1_kernel_cgu_chk
k1_kernel_cgu_k10:
    v_mfma_f32_32x32x16_bf16 v[64:79], v[240:243], v[28:31], v[64:79]
    ds_read_b128 v[28:31], v11 offset:24576
    v_mfma_f32_32x32x16_bf16 v[64:79], v[244:247], v[32:35], v[64:79]
    ds_read_b128 v[32:35], v12 offset:24576
    v_mfma_f32_32x32x16_bf16 v[64:79], v[248:251], v[36:39], v[64:79]
    ds_read_b128 v[36:39], v13 offset:24576
    v_mfma_f32_32x32x16_bf16 v[64:79], v[252:255], v[40:43], v[64:79]
    ds_read_b128 v[40:43], v14 offset:24576
    ds_read_b128 v[44:47], v15 offset:24576
    s_mov_b32 s51, 1
    s_mov_b32 s65, 1
    s_waitcnt lgkmcnt(7)
    v_mfma_f32_32x32x16_bf16 v[80:95], v[192:195], v[16:19], v[80:95]
    s_add_u32 s65, s65, 1
    s_add_u32 s51, s51, 1
    s_cmp_eq_u32 s51, 3
    s_cselect_b32 s51, 0, s51
    s_cselect_b32 s68, 0xfffec000, s100
    ds_read_b128 v[16:19], v8 offset:32768
    v_mbcnt_lo_u32_b32 v3, -1, 0
    v_and_b32 v3, 32, v3
    v_lshlrev_b32 v3, 1, v3
    ds_bpermute_b32 v48, v3, v60 offset:0
    ds_bpermute_b32 v49, v3, v61 offset:0
    ds_bpermute_b32 v50, v3, v62 offset:0
    ds_bpermute_b32 v51, v3, v63 offset:0
    ds_bpermute_b32 v52, v3, v60 offset:128
    ds_bpermute_b32 v53, v3, v61 offset:128
    ds_bpermute_b32 v54, v3, v62 offset:128
    ds_bpermute_b32 v55, v3, v63 offset:128
    ds_bpermute_b32 v56, v3, v60 offset:16
    ds_bpermute_b32 v57, v3, v61 offset:16
    ds_bpermute_b32 v58, v3, v62 offset:16
    s_waitcnt lgkmcnt(15)
    v_mfma_f32_32x32x16_bf16 v[80:95], v[196:199], v[20:23], v[80:95]
    ds_read_b128 v[20:23], v9 offset:32768
    v_add_u32 v8, s68, v8
    ds_bpermute_b32 v59, v3, v63 offset:16
    ds_bpermute_b32 v60, v3, v60 offset:144
    ds_bpermute_b32 v61, v3, v61 offset:144
    ds_bpermute_b32 v62, v3, v62 offset:144
    ds_bpermute_b32 v63, v3, v63 offset:144
    s_lshl_b32 s58, s47, 9
    v_add_u32 v3, s58, v2
    ds_read_b96 v[4:6], v3
    s_mul_i32 s57, s47, 151552
    s_add_u32 s57, s57, s62
    v_mfma_f32_32x32x16_bf16 v[80:95], v[200:203], v[24:27], v[80:95]
    s_cmp_lg_u32 s66, 0
    s_cbranch_scc0 k1_kernel_cgu_k22
    s_call_b64 s[4:5], k1_kernel_cgu_chk
k1_kernel_cgu_k22:
    ds_read_b128 v[24:27], v10 offset:32768
    v_add_u32 v9, s68, v9
    v_mfma_f32_32x32x16_bf16 v[80:95], v[204:207], v[28:31], v[80:95]
    ds_read_b128 v[28:31], v11 offset:32768
    v_add_u32 v10, s68, v10
    s_waitcnt lgkmcnt(2)
    v_fma_f32 v64, v4, v48, v64
    v_fma_f32 v65, v4, v49, v65
    v_fma_f32 v66, v4, v50, v66
    v_fma_f32 v67, v4, v51, v67
    v_mul_f32 v64, -v5, v64
    v_mul_f32 v65, -v5, v65
    v_mul_f32 v66, -v5, v66
    v_mul_f32 v67, -v5, v67
    v_exp_f32 v64, v64
    v_fma_f32 v72, v4, v56, v72
    v_exp_f32 v65, v65
    v_mfma_f32_32x32x16_bf16 v[80:95], v[208:211], v[32:35], v[80:95]
    ds_read_b128 v[32:35], v12 offset:32768
    v_add_u32 v11, s68, v11
    v_fma_f32 v73, v4, v57, v73
    v_exp_f32 v66, v66
    v_fma_f32 v74, v4, v58, v74
    v_exp_f32 v67, v67
    v_fma_f32 v75, v4, v59, v75
    v_fma_f32 v64, v64, v6, v6
    v_fma_f32 v65, v65, v6, v6
    v_fma_f32 v66, v66, v6, v6
    v_fma_f32 v67, v67, v6, v6
    v_rcp_f32 v64, v64
    v_mfma_f32_32x32x16_bf16 v[80:95], v[212:215], v[36:39], v[80:95]
    ds_read_b128 v[36:39], v13 offset:32768
    v_add_u32 v12, s68, v12
    v_rcp_f32 v65, v65
    v_rcp_f32 v66, v66
    v_rcp_f32 v67, v67
    v_mul_f32 v72, v64, v72
    v_mul_f32 v73, v65, v73
    v_mul_f32 v74, v66, v74
    v_mul_f32 v75, v67, v75
    v_cvt_pk_bf16_f32 v64, v72, v73
    v_cvt_pk_bf16_f32 v65, v74, v75
    v_fma_f32 v68, v4, v52, v68
    v_mfma_f32_32x32x16_bf16 v[80:95], v[216:219], v[40:43], v[80:95]
    s_cmp_lg_u32 s66, 0
    s_cbranch_scc0 k1_kernel_cgu_k26
    s_call_b64 s[4:5], k1_kernel_cgu_chk
k1_kernel_cgu_k26:
    ds_read_b128 v[40:43], v14 offset:32768
    v_add_u32 v13, s68, v13
    v_fma_f32 v69, v4, v53, v69
    v_fma_f32 v70, v4, v54, v70
    v_fma_f32 v71, v4, v55, v71
    v_mul_f32 v68, -v5, v68
    v_mul_f32 v69, -v5, v69
    v_mul_f32 v70, -v5, v70
    v_mul_f32 v71, -v5, v71
    v_exp_f32 v68, v68
    v_fma_f32 v76, v4, v60, v76
    v_exp_f32 v69, v69
    v_fma_f32 v77, v4, v61, v77
    v_mfma_f32_32x32x16_bf16 v[80:95], v[220:223], v[44:47], v[80:95]
    ds_read_b128 v[44:47], v15 offset:32768
    v_add_u32 v14, s68, v14
    v_exp_f32 v70, v70
    v_fma_f32 v78, v4, v62, v78
    v_exp_f32 v71, v71
    v_fma_f32 v79, v4, v63, v79
    v_fma_f32 v68, v68, v6, v6
    v_fma_f32 v69, v69, v6, v6
    v_fma_f32 v70, v70, v6, v6
    v_fma_f32 v71, v71, v6, v6
    v_rcp_f32 v68, v68
    v_mfma_f32_32x32x16_bf16 v[80:95], v[224:227], v[16:19], v[80:95]
    v_add_u32 v15, s68, v15
    v_rcp_f32 v69, v69
    v_rcp_f32 v70, v70
    v_rcp_f32 v71, v71
    v_mul_f32 v76, v68, v76
    v_mul_f32 v77, v69, v77
    v_mul_f32 v78, v70, v78
    v_mul_f32 v79, v71, v79
    v_cvt_pk_bf16_f32 v66, v76, v77
    v_cvt_pk_bf16_f32 v67, v78, v79
    buffer_store_dwordx4 v[64:67], v1, s[32:35], s57 offen sc1
    s_add_u32 s47, s47, 1
    s_cmp_ge_u32 s47, s46
    s_cselect_b32 s47, 0, s47
    v_mfma_f32_32x32x16_bf16 v[80:95], v[228:231], v[20:23], v[80:95]
    s_waitcnt lgkmcnt(5)
    v_mfma_f32_32x32x16_bf16 v[80:95], v[232:235], v[24:27], v[80:95]
    s_cmp_lg_u32 s66, 0
    s_cbranch_scc1 k1_kernel_cgu_tbs
k1_kernel_cgu_tbd:
    s_waitcnt vmcnt(1)
    s_waitcnt lgkmcnt(0)
    s_barrier
    ds_read_b128 v[16:19], v8 offset:0
    ds_read_b128 v[20:23], v9 offset:0
    ds_read_b128 v[24:27], v10 offset:0
    v_mfma_f32_32x32x16_bf16 v[80:95], v[236:239], v[28:31], v[80:95]
    ds_read_b128 v[28:31], v11 offset:0
    v_mfma_f32_32x32x16_bf16 v[80:95], v[240:243], v[32:35], v[80:95]
    ds_read_b128 v[32:35], v12 offset:0
    v_mfma_f32_32x32x16_bf16 v[80:95], v[244:247], v[36:39], v[80:95]
    ds_read_b128 v[36:39], v13 offset:0
    v_mfma_f32_32x32x16_bf16 v[80:95], v[248:251], v[40:43], v[80:95]
    ds_read_b128 v[40:43], v14 offset:0
    v_mfma_f32_32x32x16_bf16 v[80:95], v[252:255], v[44:47], v[80:95]
    ds_read_b128 v[44:47], v15 offset:0
    s_nop 3
k1_kernel_cgu_loop:
    s_waitcnt lgkmcnt(7)
    v_mfma_f32_32x32x16_bf16 v[64:79], v[96:99], v[16:19], 0
    ds_read_b128 v[16:19], v8 offset:8192
    s_lshl_b32 s58, s47, 9
    v_add_u32 v3, s58, v2
    ds_read_b96 v[4:6], v3
    s_mul_i32 s57, s47, 151552
    s_add_u32 s57, s57, s62
    s_waitcnt lgkmcnt(8)
    v_mfma_f32_32x32x16_bf16 v[64:79], v[100:103], v[20:23], v[64:79]
    s_add_u32 s65, s65, 1
    s_add_u32 s51, s51, 1
    s_cmp_eq_u32 s51, 3
    s_cselect_b32 s51, 0, s51
    s_cselect_b32 s68, 0xfffec000, s100
    ds_read_b128 v[20:23], v9 offset:8192
    s_waitcnt lgkmcnt(8)
    v_mfma_f32_32x32x16_bf16 v[64:79], v[104:107], v[24:27], v[64:79]
    ds_read_b128 v[24:27], v10 offset:8192
    s_waitcnt lgkmcnt(8)
    v_mfma_f32_32x32x16_bf16 v[64:79], v[108:111], v[28:31], v[64:79]
    ds_read_b128 v[28:31], v11 offset:8192
    s_waitcnt lgkmcnt(3)
    v_fma_f32 v80, v4, v48, v80
    v_fma_f32 v81, v4, v49, v81
    v_fma_f32 v82, v4, v50, v82
    v_mfma_f32_32x32x16_bf16 v[64:79], v[112:115], v[32:35], v[64:79]
    ds_read_b128 v[32:35], v12 offset:8192
    v_fma_f32 v83, v4, v51, v83
    v_mul_f32 v80, -v5, v80
    v_mul_f32 v81, -v5, v81
    v_mfma_f32_32x32x16_bf16 v[64:79], v[116:119], v[36:39], v[64:79]
    ds_read_b128 v[36:39], v13 offset:8192
    v_mul_f32 v82, -v5, v82
    v_mul_f32 v83, -v5, v83
    v_mfma_f32_32x32x16_bf16 v[64:79], v[120:123], v[40:43], v[64:79]
    ds_read_b128 v[40:43], v14 offset:8192
    v_exp_f32 v80, v80
    v_fma_f32 v88, v4, v56, v88
    v_mfma_f32_32x32x16_bf16 v[64:79], v[124:127], v[44:47], v[64:79]
    ds_read_b128 v[44:47], v15 offset:8192
    v_exp_f32 v81, v81
    v_fma_f32 v89, v4, v57, v89
    v_mfma_f32_32x32x16_bf16 v[64:79], v[128:131], v[16:19], v[64:79]
    ds_read_b128 v[16:19], v8 offset:16384
    v_exp_f32 v82, v82
    v_fma_f32 v90, v4, v58, v90
    s_waitcnt lgkmcnt(7)
    v_mfma_f32_32x32x16_bf16 v[64:79], v[132:135], v[20:23], v[64:79]
    ds_read_b128 v[20:23], v9 offset:16384
    v_exp_f32 v83, v83
    v_fma_f32 v91, v4, v59, v91
    s_waitcnt lgkmcnt(7)
    v_mfma_f32_32x32x16_bf16 v[64:79], v[136:139], v[24:27], v[64:79]
    ds_read_b128 v[24:27], v10 offset:16384
    v_fma_f32 v80, v80, v6, v6
    v_fma_f32 v81, v81, v6, v6
    v_fma_f32 v82, v82, v6, v6
    s_waitcnt lgkmcnt(7)
    v_mfma_f32_32x32x16_bf16 v[64:79], v[140:143], v[28:31], v[64:79]
    ds_read_b128 v[28:31], v11 offset:16384
    v_fma_f32 v83, v83, v6, v6
    v_rcp_f32 v80, v80
    s_waitcnt lgkmcnt(7)
    v_mfma_f32_32x32x16_bf16 v[64:79], v[144:147], v[32:35], v[64:79]
    ds_read_b128 v[32:35], v12 offset:16384
    v_rcp_f32 v81, v81
    s_waitcnt lgkmcnt(7)
    v_mfma_f32_32x32x16_bf16 v[64:79], v[148:151], v[36:39], v[64:79]
    ds_read_b128 v[36:39], v13 offset:16384
    v_rcp_f32 v82, v82
    s_waitcnt lgkmcnt(7)
    v_mfma_f32_32x32x16_bf16 v[64:79], v[152:155], v[40:43], v[64:79]
    ds_read_b128 v[40:43], v14 offset:16384
    v_rcp_f32 v83, v83
    v_mul_f32 v88, v80, v88
    s_waitcnt lgkmcnt(7)
    v_mfma_f32_32x32x16_bf16 v[64:79], v[156:159], v[44:47], v[64:79]
    ds_read_b128 v[44:47], v15 offset:16384
    v_mul_f32 v89, v81, v89
    v_mul_f32 v90, v82, v90
    v_mul_f32 v91, v83, v91
    s_waitcnt lgkmcnt(7)
    v_mfma_f32_32x32x16_bf16 v[64:79], v[160:163], v[16:19], v[64:79]
    ds_read_b128 v[16:19], v8 offset:24576
    v_cvt_pk_bf16_f32 v80, v88, v89
    v_cvt_pk_bf16_f32 v81, v90, v91
    v_fma_f32 v84, v4, v52, v84
    s_waitcnt lgkmcnt(7)
    v_mfma_f32_32x32x16_bf16 v[64:79], v[164:167], v[20:23], v[64:79]
    ds_read_b128 v[20:23], v9 offset:24576
    v_fma_f32 v85, v4, v53, v85
    v_fma_f32 v86, v4, v54, v86
    v_fma_f32 v87, v4, v55, v87
    s_waitcnt lgkmcnt(7)
    v_mfma_f32_32x32x16_bf16 v[64:79], v[168:171], v[24:27], v[64:79]
    ds_read_b128 v[24:27], v10 offset:24576
    v_mul_f32 v84, -v5, v84
    v_mul_f32 v85, -v5, v85
    v_mul_f32 v86, -v5, v86
    s_waitcnt lgkmcnt(7)
    v_mfma_f32_32x32x16_bf16 v[64:79], v[172:175], v[28:31], v[64:79]
    ds_read_b128 v[28:31], v11 offset:24576
    v_mul_f32 v87, -v5, v87
    v_exp_f32 v84, v84
    s_waitcnt lgkmcnt(7)
    v_mfma_f32_32x32x16_bf16 v[64:79], v[176:179], v[32:35], v[64:79]
    ds_read_b128 v[32:35], v12 offset:24576
    v_fma_f32 v92, v4, v60, v92
    v_exp_f32 v85, v85
    s_waitcnt lgkmcnt(7)
    v_mfma_f32_32x32x16_bf16 v[64:79], v[180:183], v[36:39], v[64:79]
    ds_read_b128 v[36:39], v13 offset:24576
    v_fma_f32 v93, v4, v61, v93
    v_exp_f32 v86, v86
    s_waitcnt lgkmcnt(7)
    v_mfma_f32_32x32x16_bf16 v[64:79], v[184:187], v[40:43], v[64:79]
    ds_read_b128 v[40:43], v14 offset:24576
    v_fma_f32 v94, v4, v62, v94
    v_exp_f32 v87, v87
    s_waitcnt lgkmcnt(7)
    v_mfma_f32_32x32x16_bf16 v[64:79], v[188:191], v[44:47], v[64:79]
    ds_read_b128 v[44:47], v15 offset:24576
    v_fma_f32 v95, v4, v63, v95
    v_fma_f32 v84, v84, v6, v6
    v_fma_f32 v85, v85, v6, v6
    s_waitcnt lgkmcnt(7)
    v_mfma_f32_32x32x16_bf16 v[64:79], v[192:195], v[16:19], v[64:79]
    ds_read_b128 v[16:19], v8 offset:32768
    v_fma_f32 v86, v86, v6, v6
    v_fma_f32 v87, v87, v6, v6
    s_waitcnt lgkmcnt(7)
    v_mfma_f32_32x32x16_bf16 v[64:79], v[196:199], v[20:23], v[64:79]
    ds_read_b128 v[20:23], v9 offset:32768
    v_add_u32 v8, s68, v8
    v_rcp_f32 v84, v84
    s_waitcnt lgkmcnt(7)
    v_mfma_f32_32x32x16_bf16 v[64:79], v[200:203], v[24:27], v[64:79]
    ds_read_b128 v[24:27], v10 offset:32768
    v_add_u32 v9, s68, v9
    v_rcp_f32 v85, v85
    s_waitcnt lgkmcnt(7)
    v_mfma_f32_32x32x16_bf16 v[64:79], v[204:207], v[28:31], v[64:79]
    ds_read_b128 v[28:31], v11 offset:32768
    v_add_u32 v10, s68, v10
    v_rcp_f32 v86, v86
    s_waitcnt lgkmcnt(7)
    v_mfma_f32_32x32x16_bf16 v[64:79], v[208:211], v[32:35], v[64:79]
    ds_read_b128 v[32:35], v12 offset:32768
    v_add_u32 v11, s68, v11
    v_rcp_f32 v87, v87
    s_waitcnt lgkmcnt(7)
    v_mfma_f32_32x32x16_bf16 v[64:79], v[212:215], v[36:39], v[64:79]
    ds_read_b128 v[36:39], v13 offset:32768
    v_add_u32 v12, s68, v12
    v_mul_f32 v92, v84, v92
    v_mul_f32 v93, v85, v93
    s_waitcnt lgkmcnt(7)
    v_mfma_f32_32x32x16_bf16 v[64:79], v[216:219], v[40:43], v[64:79]
    ds_read_b128 v[40:43], v14 offset:32768
    v_add_u32 v13, s68, v13
    v_mul_f32 v94, v86, v94
    v_mul_f32 v95, v87, v95
    s_waitcnt lgkmcnt(7)
    v_mfma_f32_32x32x16_bf16 v[64:79], v[220:223], v[44:47], v[64:79]
    ds_read_b128 v[44:47], v15 offset:32768
    v_add_u32 v14, s68, v14
    v_cvt_pk_bf16_f32 v82, v92, v93
    v_cvt_pk_bf16_f32 v83, v94, v95
    s_waitcnt lgkmcnt(7)
    v_mfma_f32_32x32x16_bf16 v[64:79], v[224:227], v[16:19], v[64:79]
    v_add_u32 v15, s68, v15
    buffer_store_dwordx4 v[80:83], v1, s[32:35], s57 offen sc1
    s_add_u32 s47, s47, 1
    s_cmp_ge_u32 s47, s46
    s_cselect_b32 s47, 0, s47
    s_waitcnt lgkmcnt(6)
    v_mfma_f32_32x32x16_bf16 v[64:79], v[228:231], v[20:23], v[64:79]
    s_waitcnt lgkmcnt(5)
    v_mfma_f32_32x32x16_bf16 v[64:79], v[232:235], v[24:27], v[64:79]
    s_waitcnt vmcnt(1)
    s_waitcnt lgkmcnt(0)
    s_barrier
    ds_read_b128 v[16:19], v8 offset:0
    ds_read_b128 v[20:23], v9 offset:0
    ds_read_b128 v[24:27], v10 offset:0
    v_mfma_f32_32x32x16_bf16 v[64:79], v[236:239], v[28:31], v[64:79]
    ds_read_b128 v[28:31], v11 offset:0
    v_mfma_f32_32x32x16_bf16 v[64:79], v[240:243], v[32:35], v[64:79]
    ds_read_b128 v[32:35], v12 offset:0
    v_mfma_f32_32x32x16_bf16 v[64:79], v[244:247], v[36:39], v[64:79]
    ds_read_b128 v[36:39], v13 offset:0
    v_mfma_f32_32x32x16_bf16 v[64:79], v[248:251], v[40:43], v[64:79]
    ds_read_b128 v[40:43], v14 offset:0
    v_mfma_f32_32x32x16_bf16 v[64:79], v[252:255], v[44:47], v[64:79]
    ds_read_b128 v[44:47], v15 offset:0
    s_cmp_ge_u32 s65, s46
    s_cbranch_scc1 k1_kernel_cgu_fin0
    s_waitcnt lgkmcnt(7)
    v_mfma_f32_32x32x16_bf16 v[80:95], v[96:99], v[16:19], 0
    ds_read_b128 v[16:19], v8 offset:8192
    s_lshl_b32 s58, s47, 9
    v_add_u32 v3, s58, v2
    ds_read_b96 v[4:6], v3
    s_mul_i32 s57, s47, 151552
    s_add_u32 s57, s57, s62
    s_waitcnt lgkmcnt(8)
    v_mfma_f32_32x32x16_bf16 v[80:95], v[100:103], v[20:23], v[80:95]
    s_add_u32 s65, s65, 1
    s_add_u32 s51, s51, 1
    s_cmp_eq_u32 s51, 3
    s_cselect_b32 s51, 0, s51
    s_cselect_b32 s68, 0xfffec000, s100
    ds_read_b128 v[20:23], v9 offset:8192
    s_waitcnt lgkmcnt(8)
    v_mfma_f32_32x32x16_bf16 v[80:95], v[104:107], v[24:27], v[80:95]
    ds_read_b128 v[24:27], v10 offset:8192
    s_waitcnt lgkmcnt(8)
    v_mfma_f32_32x32x16_bf16 v[80:95], v[108:111], v[28:31], v[80:95]
    ds_read_b128 v[28:31], v11 offset:8192
    s_waitcnt lgkmcnt(3)
    v_fma_f32 v64, v4, v48, v64
    v_fma_f32 v65, v4, v49, v65
    v_fma_f32 v66, v4, v50, v66
    v_mfma_f32_32x32x16_bf16 v[80:95], v[112:115], v[32:35], v[80:95]
    ds_read_b128 v[32:35], v12 offset:8192
    v_fma_f32 v67, v4, v51, v67
    v_mul_f32 v64, -v5, v64
    v_mul_f32 v65, -v5, v65
    v_mfma_f32_32x32x16_bf16 v[80:95], v[116:119], v[36:39], v[80:95]
    ds_read_b128 v[36:39], v13 offset:8192
    v_mul_f32 v66, -v5, v66
    v_mul_f32 v67, -v5, v67
    v_mfma_f32_32x32x16_bf16 v[80:95], v[120:123], v[40:43], v[80:95]
    ds_read_b128 v[40:43], v14 offset:8192
    v_exp_f32 v64, v64
    v_fma_f32 v72, v4, v56, v72
    v_mfma_f32_32x32x16_bf16 v[80:95], v[124:127], v[44:47], v[80:95]
    ds_read_b128 v[44:47], v15 offset:8192
    v_exp_f32 v65, v65
    v_fma_f32 v73, v4, v57, v73
    v_mfma_f32_32x32x16_bf16 v[80:95], v[128:131], v[16:19], v[80:95]
    ds_read_b128 v[16:19], v8 offset:16384
    v_exp_f32 v66, v66
    v_fma_f32 v74, v4, v58, v74
    s_waitcnt lgkmcnt(7)
    v_mfma_f32_32x32x16_bf16 v[80:95], v[132:135], v[20:23], v[80:95]
    ds_read_b128 v[20:23], v9 offset:16384
    v_exp_f32 v67, v67
    v_fma_f32 v75, v4, v59, v75
    s_waitcnt lgkmcnt(7)
    v_mfma_f32_32x32x16_bf16 v[80:95], v[136:139], v[24:27], v[80:95]
    ds_read_b128 v[24:27], v10 offset:16384
    v_fma_f32 v64, v64, v6, v6
    v_fma_f32 v65, v65, v6, v6
    v_fma_f32 v66, v66, v6, v6
    s_waitcnt lgkmcnt(7)
    v_mfma_f32_32x32x16_bf16 v[80:95], v[140:143], v[28:31], v[80:95]
    ds_read_b128 v[28:31], v11 offset:16384
    v_fma_f32 v67, v67, v6, v6
    v_rcp_f32 v64, v64
    s_waitcnt lgkmcnt(7)
    v_mfma_f32_32x32x16_bf16 v[80:95], v[144:147], v[32:35], v[80:95]
    ds_read_b128 v[32:35], v12 offset:16384
    v_rcp_f32 v65, v65
    s_waitcnt lgkmcnt(7)
    v_mfma_f32_32x32x16_bf16 v[80:95], v[148:151], v[36:39], v[80:95]
    ds_read_b128 v[36:39], v13 offset:16384
    v_rcp_f32 v66, v66
    s_waitcnt lgkmcnt(7)
    v_mfma_f32_32x32x16_bf16 v[80:95], v[152:155], v[40:43], v[80:95]
    ds_read_b128 v[40:43], v14 offset:16384
    v_rcp_f32 v67, v67
    v_mul_f32 v72, v64, v72
    s_waitcnt lgkmcnt(7)
    v_mfma_f32_32x32x16_bf16 v[80:95], v[156:159], v[44:47], v[80:95]
    ds_read_b128 v[44:47], v15 offset:16384
    v_mul_f32 v73, v65, v73
    v_mul_f32 v74, v66, v74
    v_mul_f32 v75, v67, v75
    s_waitcnt lgkmcnt(7)
    v_mfma_f32_32x32x16_bf16 v[80:95], v[160:163], v[16:19], v[80:95]
    ds_read_b128 v[16:19], v8 offset:24576
    v_cvt_pk_bf16_f32 v64, v72, v73
    v_cvt_pk_bf16_f32 v65, v74, v75
    v_fma_f32 v68, v4, v52, v68
    s_waitcnt lgkmcnt(7)
    v_mfma_f32_32x32x16_bf16 v[80:95], v[164:167], v[20:23], v[80:95]
    ds_read_b128 v[20:23], v9 offset:24576
    v_fma_f32 v69, v4, v53, v69
    v_fma_f32 v70, v4, v54, v70
    v_fma_f32 v71, v4, v55, v71
    s_waitcnt lgkmcnt(7)
    v_mfma_f32_32x32x16_bf16 v[80:95], v[168:171], v[24:27], v[80:95]
    ds_read_b128 v[24:27], v10 offset:24576
    v_mul_f32 v68, -v5, v68
    v_mul_f32 v69, -v5, v69
    v_mul_f32 v70, -v5, v70
    s_waitcnt lgkmcnt(7)
    v_mfma_f32_32x32x16_bf16 v[80:95], v[172:175], v[28:31], v[80:95]
    ds_read_b128 v[28:31], v11 offset:24576
    v_mul_f32 v71, -v5, v71
    v_exp_f32 v68, v68
    s_waitcnt lgkmcnt(7)
    v_mfma_f32_32x32x16_bf16 v[80:95], v[176:179], v[32:35], v[80:95]
    ds_read_b128 v[32:35], v12 offset:24576
    v_fma_f32 v76, v4, v60, v76
    v_exp_f32 v69, v69
    s_waitcnt lgkmcnt(7)
    v_mfma_f32_32x32x16_bf16 v[80:95], v[180:183], v[36:39], v[80:95]
    ds_read_b128 v[36:39], v13 offset:24576
    v_fma_f32 v77, v4, v61, v77
    v_exp_f32 v70, v70
    s_waitcnt lgkmcnt(7)
    v_mfma_f32_32x32x16_bf16 v[80:95], v[184:187], v[40:43], v[80:95]
    ds_read_b128 v[40:43], v14 offset:24576
    v_fma_f32 v78, v4, v62, v78
    v_exp_f32 v71, v71
    s_waitcnt lgkmcnt(7)
    v_mfma_f32_32x32x16_bf16 v[80:95], v[188:191], v[44:47], v[80:95]
    ds_read_b128 v[44:47], v15 offset:24576
    v_fma_f32 v79, v4, v63, v79
    v_fma_f32 v68, v68, v6, v6
    v_fma_f32 v69, v69, v6, v6
    s_waitcnt lgkmcnt(7)
    v_mfma_f32_32x32x16_bf16 v[80:95], v[192:195], v[16:19], v[80:95]
    ds_read_b128 v[16:19], v8 offset:32768
    v_fma_f32 v70, v70, v6, v6
    v_fma_f32 v71, v71, v6, v6
    s_waitcnt lgkmcnt(7)
    v_mfma_f32_32x32x16_bf16 v[80:95], v[196:199], v[20:23], v[80:95]
    ds_read_b128 v[20:23], v9 offset:32768
    v_add_u32 v8, s68, v8
    v_rcp_f32 v68, v68
    s_waitcnt lgkmcnt(7)
    v_mfma_f32_32x32x16_bf16 v[80:95], v[200:203], v[24:27], v[80:95]
    ds_read_b128 v[24:27], v10 offset:32768
    v_add_u32 v9, s68, v9
    v_rcp_f32 v69, v69
    s_waitcnt lgkmcnt(7)
    v_mfma_f32_32x32x16_bf16 v[80:95], v[204:207], v[28:31], v[80:95]
    ds_read_b128 v[28:31], v11 offset:32768
    v_add_u32 v10, s68, v10
    v_rcp_f32 v70, v70
    s_waitcnt lgkmcnt(7)
    v_mfma_f32_32x32x16_bf16 v[80:95], v[208:211], v[32:35], v[80:95]
    ds_read_b128 v[32:35], v12 offset:32768
    v_add_u32 v11, s68, v11
    v_rcp_f32 v71, v71
    s_waitcnt lgkmcnt(7)
    v_mfma_f32_32x32x16_bf16 v[80:95], v[212:215], v[36:39], v[80:95]
    ds_read_b128 v[36:39], v13 offset:32768
    v_add_u32 v12, s68, v12
    v_mul_f32 v76, v68, v76
    v_mul_f32 v77, v69, v77
    s_waitcnt lgkmcnt(7)
    v_mfma_f32_32x32x16_bf16 v[80:95], v[216:219], v[40:43], v[80:95]
    ds_read_b128 v[40:43], v14 offset:32768
    v_add_u32 v13, s68, v13
    v_mul_f32 v78, v70, v78
    v_mul_f32 v79, v71, v79
    s_waitcnt lgkmcnt(7)
    v_mfma_f32_32x32x16_bf16 v[80:95], v[220:223], v[44:47], v[80:95]
    ds_read_b128 v[44:47], v15 offset:32768
    v_add_u32 v14, s68, v14
    v_cvt_pk_bf16_f32 v66, v76, v77
    v_cvt_pk_bf16_f32 v67, v78, v79
    s_waitcnt lgkmcnt(7)
    v_mfma_f32_32x32x16_bf16 v[80:95], v[224:227], v[16:19], v[80:95]
    v_add_u32 v15, s68, v15
    buffer_store_dwordx4 v[64:67], v1, s[32:35], s57 offen sc1
    s_add_u32 s47, s47, 1
    s_cmp_ge_u32 s47, s46
    s_cselect_b32 s47, 0, s47
    s_waitcnt lgkmcnt(6)
    v_mfma_f32_32x32x16_bf16 v[80:95], v[228:231], v[20:23], v[80:95]
    s_waitcnt lgkmcnt(5)
    v_mfma_f32_32x32x16_bf16 v[80:95], v[232:235], v[24:27], v[80:95]
    s_waitcnt vmcnt(1)
    s_waitcnt lgkmcnt(0)
    s_barrier
    ds_read_b128 v[16:19], v8 offset:0
    ds_read_b128 v[20:23], v9 offset:0
    ds_read_b128 v[24:27], v10 offset:0
    v_mfma_f32_32x32x16_bf16 v[80:95], v[236:239], v[28:31], v[80:95]
    ds_read_b128 v[28:31], v11 offset:0
    v_mfma_f32_32x32x16_bf16 v[80:95], v[240:243], v[32:35], v[80:95]
    ds_read_b128 v[32:35], v12 offset:0
    v_mfma_f32_32x32x16_bf16 v[80:95], v[244:247], v[36:39], v[80:95]
    ds_read_b128 v[36:39], v13 offset:0
    v_mfma_f32_32x32x16_bf16 v[80:95], v[248:251], v[40:43], v[80:95]
    ds_read_b128 v[40:43], v14 offset:0
    v_mfma_f32_32x32x16_bf16 v[80:95], v[252:255], v[44:47], v[80:95]
    ds_read_b128 v[44:47], v15 offset:0
    s_cmp_lt_u32 s65, s46
    s_cbranch_scc1 k1_kernel_cgu_loop
    s_nop 7
    s_waitcnt lgkmcnt(0)
    s_lshl_b32 s58, s47, 9
    v_add_u32 v3, s58, v2
    ds_read_b96 v[4:6], v3
    s_mul_i32 s57, s47, 151552
    s_add_u32 s57, s57, s62
    s_waitcnt lgkmcnt(0)
    v_fma_f32 v80, v4, v48, v80
    v_fma_f32 v81, v4, v49, v81
    v_fma_f32 v82, v4, v50, v82
    v_fma_f32 v83, v4, v51, v83
    v_mul_f32 v80, -v5, v80
    v_mul_f32 v81, -v5, v81
    v_mul_f32 v82, -v5, v82
    v_mul_f32 v83, -v5, v83
    v_exp_f32 v80, v80
    v_fma_f32 v88, v4, v56, v88
    v_exp_f32 v81, v81
    v_fma_f32 v89, v4, v57, v89
    v_exp_f32 v82, v82
    v_fma_f32 v90, v4, v58, v90
    v_exp_f32 v83, v83
    v_fma_f32 v91, v4, v59, v91
    v_fma_f32 v80, v80, v6, v6
    v_fma_f32 v81, v81, v6, v6
    v_fma_f32 v82, v82, v6, v6
    v_fma_f32 v83, v83, v6, v6
    v_rcp_f32 v80, v80
    v_rcp_f32 v81, v81
    v_rcp_f32 v82, v82
    v_rcp_f32 v83, v83
    v_mul_f32 v88, v80, v88
    v_mul_f32 v89, v81, v89
    v_mul_f32 v90, v82, v90
    v_mul_f32 v91, v83, v91
    v_cvt_pk_bf16_f32 v80, v88, v89
    v_cvt_pk_bf16_f32 v81, v90, v91
    v_fma_f32 v84, v4, v52, v84
    v_fma_f32 v85, v4, v53, v85
    v_fma_f32 v86, v4, v54, v86
    v_fma_f32 v87, v4, v55, v87
    v_mul_f32 v84, -v5, v84
    v_mul_f32 v85, -v5, v85
    v_mul_f32 v86, -v5, v86
    v_mul_f32 v87, -v5, v87
    v_exp_f32 v84, v84
    v_fma_f32 v92, v4, v60, v92
    v_exp_f32 v85, v85
    v_fma_f32 v93, v4, v61, v93
    v_exp_f32 v86, v86
    v_fma_f32 v94, v4, v62, v94
    v_exp_f32 v87, v87
    v_fma_f32 v95, v4, v63, v95
    v_fma_f32 v84, v84, v6, v6
    v_fma_f32 v85, v85, v6, v6
    v_fma_f32 v86, v86, v6, v6
    v_fma_f32 v87, v87, v6, v6
    v_rcp_f32 v84, v84
    v_rcp_f32 v85, v85
    v_rcp_f32 v86, v86
    v_rcp_f32 v87, v87
    v_mul_f32 v92, v84, v92
    v_mul_f32 v93, v85, v93
    v_mul_f32 v94, v86, v94
    v_mul_f32 v95, v87, v95
    v_cvt_pk_bf16_f32 v82, v92, v93
    v_cvt_pk_bf16_f32 v83, v94, v95
    buffer_store_dwordx4 v[80:83], v1, s[32:35], s57 offen sc1
    s_add_u32 s47, s47, 1
    s_cmp_ge_u32 s47, s46
    s_cselect_b32 s47, 0, s47
    s_mov_b32 s37, 0
    s_nop 1
    s_branch k1_kernel_y
k1_kernel_cgu_fin0:
    s_nop 7
    s_waitcnt lgkmcnt(0)
    s_lshl_b32 s58, s47, 9
    v_add_u32 v3, s58, v2
    ds_read_b96 v[4:6], v3
    s_mul_i32 s57, s47, 151552
    s_add_u32 s57, s57, s62
    s_waitcnt lgkmcnt(0)
    v_fma_f32 v64, v4, v48, v64
    v_fma_f32 v65, v4, v49, v65
    v_fma_f32 v66, v4, v50, v66
    v_fma_f32 v67, v4, v51, v67
    v_mul_f32 v64, -v5, v64
    v_mul_f32 v65, -v5, v65
    v_mul_f32 v66, -v5, v66
    v_mul_f32 v67, -v5, v67
    v_exp_f32 v64, v64
    v_fma_f32 v72, v4, v56, v72
    v_exp_f32 v65, v65
    v_fma_f32 v73, v4, v57, v73
    v_exp_f32 v66, v66
    v_fma_f32 v74, v4, v58, v74
    v_exp_f32 v67, v67
    v_fma_f32 v75, v4, v59, v75
    v_fma_f32 v64, v64, v6, v6
    v_fma_f32 v65, v65, v6, v6
    v_fma_f32 v66, v66, v6, v6
    v_fma_f32 v67, v67, v6, v6
    v_rcp_f32 v64, v64
    v_rcp_f32 v65, v65
    v_rcp_f32 v66, v66
    v_rcp_f32 v67, v67
    v_mul_f32 v72, v64, v72
    v_mul_f32 v73, v65, v73
    v_mul_f32 v74, v66, v74
    v_mul_f32 v75, v67, v75
    v_cvt_pk_bf16_f32 v64, v72, v73
    v_cvt_pk_bf16_f32 v65, v74, v75
    v_fma_f32 v68, v4, v52, v68
    v_fma_f32 v69, v4, v53, v69
    v_fma_f32 v70, v4, v54, v70
    v_fma_f32 v71, v4, v55, v71
    v_mul_f32 v68, -v5, v68
    v_mul_f32 v69, -v5, v69
    v_mul_f32 v70, -v5, v70
    v_mul_f32 v71, -v5, v71
    v_exp_f32 v68, v68
    v_fma_f32 v76, v4, v60, v76
    v_exp_f32 v69, v69
    v_fma_f32 v77, v4, v61, v77
    v_exp_f32 v70, v70
    v_fma_f32 v78, v4, v62, v78
    v_exp_f32 v71, v71
    v_fma_f32 v79, v4, v63, v79
    v_fma_f32 v68, v68, v6, v6
    v_fma_f32 v69, v69, v6, v6
    v_fma_f32 v70, v70, v6, v6
    v_fma_f32 v71, v71, v6, v6
    v_rcp_f32 v68, v68
    v_rcp_f32 v69, v69
    v_rcp_f32 v70, v70
    v_rcp_f32 v71, v71
    v_mul_f32 v76, v68, v76
    v_mul_f32 v77, v69, v77
    v_mul_f32 v78, v70, v78
    v_mul_f32 v79, v71, v79
    v_cvt_pk_bf16_f32 v66, v76, v77
    v_cvt_pk_bf16_f32 v67, v78, v79
    buffer_store_dwordx4 v[64:67], v1, s[32:35], s57 offen sc1
    s_add_u32 s47, s47, 1
    s_cmp_ge_u32 s47, s46
    s_cselect_b32 s47, 0, s47
    s_mov_b32 s37, 0
    s_nop 1
    s_branch k1_kernel_y
k1_kernel_cgu_chk:
    s_getreg_b32 s53, hwreg(HW_REG_IB_STS, 0, 4)
    s_cmp_lg_u32 s53, 0
    s_cbranch_scc1 k1_kernel_cgu_chkr
    s_waitcnt vmcnt(0)
    s_cmp_lt_u32 s66, 2
    s_cbranch_scc1 k1_kernel_cgu_chki
k1_kernel_cgu_chkd:
    v_cmp_ne_u32 vcc, 1, v0
    s_nop 1
    s_cbranch_vccnz k1_kernel_cgu_chki
    v_mbcnt_lo_u32_b32 v0, -1, 0
    v_mbcnt_hi_u32_b32 v0, -1, v0
    s_lshl_b32 s53, s45, 9
    s_add_u32 s53, s53, 12730368
    v_lshlrev_b32 v0, 4, v0
    s_mov_b32 s66, 0
    s_mov_b32 m0, 122880
    s_nop 0
    buffer_load_dwordx4 v0, s[32:35], s53 offen sc1 lds
    s_add_u32 s53, s53, 1024
    s_mov_b32 m0, 123904
    s_nop 0
    buffer_load_dwordx4 v0, s[32:35], s53 offen sc1 lds
    s_add_u32 s53, s53, 1024
    s_mov_b32 m0, 124928
    s_nop 0
    buffer_load_dwordx4 v0, s[32:35], s53 offen sc1 lds
    s_add_u32 s53, s53, 1024
    s_mov_b32 m0, 125952
    s_nop 0
    buffer_load_dwordx4 v0, s[32:35], s53 offen sc1 lds
    s_add_u32 s53, s53, 1024
    s_mov_b32 m0, 126976
    s_nop 0
    buffer_load_dwordx4 v0, s[32:35], s53 offen sc1 lds
    s_add_u32 s53, s53, 1024
    s_mov_b32 m0, 128000
    s_nop 0
    buffer_load_dwordx4 v0, s[32:35], s53 offen sc1 lds
    s_setpc_b64 s[4:5]
k1_kernel_cgu_chki:
    v_mbcnt_lo_u32_b32 v0, -1, 0
    v_mbcnt_hi_u32_b32 v0, -1, v0
    v_lshlrev_b32 v0, 2, v0
    s_mov_b32 s66, 2
    buffer_load_dword v0, v0, s[36:39], 0 offen sc1
k1_kernel_cgu_chkr:
    s_setpc_b64 s[4:5]
k1_kernel_cgu_tbs:
    s_mov_b32 s54, 20000
    s_cmp_eq_u32 s66, 2
    s_cbranch_scc1 k1_kernel_cgu_tbw
k1_kernel_cgu_tbi:
    v_mbcnt_lo_u32_b32 v0, -1, 0
    v_mbcnt_hi_u32_b32 v0, -1, v0
    v_lshlrev_b32 v0, 2, v0
    s_mov_b32 s66, 2
    buffer_load_dword v0, v0, s[36:39], 0 offen sc1
k1_kernel_cgu_tbw:
    s_sub_u32 s54, s54, 1
    s_waitcnt vmcnt(0)
    v_cmp_ne_u32 vcc, 1, v0
    s_cmp_eq_u32 s54, 0
    s_cbranch_scc1 k1_kernel_cgu_tbx
    s_nop 1
    s_cbranch_vccnz k1_kernel_cgu_tbi
k1_kernel_cgu_tbx:
    v_mbcnt_lo_u32_b32 v0, -1, 0
    v_mbcnt_hi_u32_b32 v0, -1, v0
    s_lshl_b32 s53, s45, 9
    s_add_u32 s53, s53, 12730368
    v_lshlrev_b32 v0, 4, v0
    s_mov_b32 s66, 0
    s_mov_b32 m0, 122880
    s_nop 0
    buffer_load_dwordx4 v0, s[32:35], s53 offen sc1 lds
    s_add_u32 s53, s53, 1024
    s_mov_b32 m0, 123904
    s_nop 0
    buffer_load_dwordx4 v0, s[32:35], s53 offen sc1 lds
    s_add_u32 s53, s53, 1024
    s_mov_b32 m0, 124928
    s_nop 0
    buffer_load_dwordx4 v0, s[32:35], s53 offen sc1 lds
    s_add_u32 s53, s53, 1024
    s_mov_b32 m0, 125952
    s_nop 0
    buffer_load_dwordx4 v0, s[32:35], s53 offen sc1 lds
    s_add_u32 s53, s53, 1024
    s_mov_b32 m0, 126976
    s_nop 0
    buffer_load_dwordx4 v0, s[32:35], s53 offen sc1 lds
    s_add_u32 s53, s53, 1024
    s_mov_b32 m0, 128000
    s_nop 0
    buffer_load_dwordx4 v0, s[32:35], s53 offen sc1 lds
    s_waitcnt vmcnt(0)
    s_branch k1_kernel_cgu_tbd
k1_kernel_cq:
    s_setprio 3
    v_lshrrev_b32 v52, 4, v0
    s_lshl_b32 s53, s44, 3
    v_add_u32 v52, s53, v52
    v_xor_b32 v53, v0, v52
    v_and_b32 v53, 15, v53
    v_mul_u32_u24 v48, 1280, v52
    v_lshl_add_u32 v48, v53, 4, v48
    v_xor_b32 v49, 64, v48
    v_add_u32 v49, 5120, v49
    s_add_u32 s53, s45, s47
    s_mul_i32 s100, s53, 40960
    s_bfe_u32 s53, s48, 0x40000
    s_lshl_b32 s53, s53, 8
    s_add_u32 s60, s53, s100
    s_bfe_u32 s53, s48, 0x40004
    s_lshl_b32 s53, s53, 8
    s_add_u32 s61, s53, s100
    s_bfe_u32 s53, s48, 0x40008
    s_lshl_b32 s53, s53, 8
    s_add_u32 s62, s53, s100
    s_bfe_u32 s53, s48, 0x4000c
    s_lshl_b32 s53, s53, 8
    s_add_u32 s63, s53, s100
    s_bfe_u32 s53, s48, 0x40010
    s_lshl_b32 s53, s53, 8
    s_add_u32 s64, s53, s100
    s_lshl_b32 s68, s44, 11
    s_waitcnt lgkmcnt(0)
    s_mov_b32 s24, s4
    s_and_b32 s25, s5, 0xffff
    s_mov_b32 s26, 2621440
    s_mov_b32 s27, 0x20000
    s_add_u32 m0, s68, 0
    s_nop 0
    buffer_load_dwordx4 v48, s[24:27], s60 offen lds
    s_add_u32 m0, s68, 1024
    s_nop 0
    buffer_load_dwordx4 v49, s[24:27], s60 offen lds
    s_add_u32 m0, s68, 8192
    s_nop 0
    buffer_load_dwordx4 v48, s[24:27], s61 offen lds
    s_add_u32 m0, s68, 9216
    s_nop 0
    buffer_load_dwordx4 v49, s[24:27], s61 offen lds
    s_add_u32 m0, s68, 16384
    s_nop 0
    buffer_load_dwordx4 v48, s[24:27], s62 offen lds
    s_add_u32 m0, s68, 17408
    s_nop 0
    buffer_load_dwordx4 v49, s[24:27], s62 offen lds
    s_add_u32 m0, s68, 24576
    s_nop 0
    buffer_load_dwordx4 v48, s[24:27], s63 offen lds
    s_add_u32 m0, s68, 25600
    s_nop 0
    buffer_load_dwordx4 v49, s[24:27], s63 offen lds
    s_add_u32 m0, s68, 32768
    s_nop 0
    buffer_load_dwordx4 v48, s[24:27], s64 offen lds
    s_add_u32 m0, s68, 33792
    s_nop 0
    buffer_load_dwordx4 v49, s[24:27], s64 offen lds
    s_setprio 0
    v_and_b32 v6, 31, v0
    v_lshrrev_b32 v7, 5, v0
    v_xor_b32 v8, v6, v7
    v_and_b32 v8, 15, v8
    v_lshlrev_b32 v8, 4, v8
    v_lshl_add_u32 v8, v6, 8, v8
    v_xor_b32 v9, 32, v8
    v_xor_b32 v10, 64, v8
    v_xor_b32 v11, 96, v8
    v_xor_b32 v12, 128, v8
    v_xor_b32 v13, 160, v8
    v_xor_b32 v14, 192, v8
    v_xor_b32 v15, 224, v8
    v_lshlrev_b32 v1, 4, v0
    v_bfe_u32 v16, v0, 2, 2
    v_and_b32 v17, 3, v0
    v_bfe_u32 v18, v0, 4, 1
    v_lshl_add_u32 v19, v7, 3, v16
    v_lshrrev_b32 v20, 1, v16
    v_lshl_or_b32 v20, v18, 1, v20
    v_xor_b32 v20, s44, v20
    v_and_b32 v21, 1, v17
    v_lshrrev_b32 v22, 1, v17
    v_lshl_or_b32 v21, v21, 1, v22
    v_lshlrev_b32 v3, 13, v18
    v_lshl_add_u32 v3, v19, 7, v3
    v_lshl_add_u32 v3, v20, 5, v3
    v_lshl_add_u32 v3, v21, 3, v3
    v_add_u32 v3, 40960, v3
    v_add_u32 v4, 40960, v3
    v_lshlrev_b32 v2, 4, v6
    v_add_u32 v2, 122880, v2
    s_mov_b32 s60, 0x35c1a2a0
    s_mov_b32 s61, 0x3f317218
    s_mov_b32 s100, 40960
    s_lshl_b32 s62, s49, 3
    s_sub_u32 s62, s62, 108
    s_add_u32 s62, s62, s44
    s_mul_i32 s53, s45, 148
    s_add_u32 s62, s62, s53
    s_lshl_b32 s62, s62, 10
    s_mov_b32 s32, s22
    s_and_b32 s33, s23, 0xffff
    s_mov_b32 s34, 12849152
    s_mov_b32 s35, 0x20000
    s_mov_b32 s36, s20
    s_and_b32 s37, s21, 0xffff
    s_mov_b32 s38, 256
    s_mov_b32 s39, 0x20000
    s_mov_b32 s101, 0
    s_cmp_eq_u32 s44, 0
    s_cselect_b32 s66, 1, 0
    s_lshl_b32 s67, s45, 2
    s_mov_b32 s40, s6
    s_and_b32 s41, s7, 0xffff
    s_mov_b32 s42, 2457600
    s_mov_b32 s43, 0x20000
    s_bfe_u32 s54, s2, 0x20001
    s_mul_i32 s54, s54, 320
    s_andn2_b32 s54, s54, 127
    s_add_u32 s69, s54, 1280
    s_lshr_b32 s53, s2, 6
    s_mul_i32 s53, s53, 5
    s_bfe_u32 s54, s2, 0x30003
    s_add_u32 s53, s53, s54
    s_sub_u32 s53, s53, 8
    s_lshl_b32 s53, s53, 2
    s_add_u32 s53, s53, s44
    s_cmp_lt_u32 s54, 3
    s_cselect_b32 s53, 200, s53
    s_mul_i32 s53, s53, 26
    v_add_u32 v24, s53, v0
    v_mul_u32_u24 v25, 10923, v24
    v_lshrrev_b32 v25, 16, v25
    v_mul_u32_u24 v26, 6, v25
    v_sub_u32 v24, v24, v26
    v_lshlrev_b32 v26, 7, v24
    v_add_u32 v27, 896, v26
    v_cmp_gt_u32 vcc, 3, v24
    s_nop 1
    v_cndmask_b32 v26, v27, v26, vcc
    v_add_u32 v25, 0, v25
    v_mul_u32_u24 v25, 3840, v25
    v_add_u32 v28, v25, v26
    v_mov_b32 v24, 0x40000000
    v_cmp_gt_u32 vcc, 26, v0
    s_nop 1
    v_cndmask_b32 v28, v24, v28, vcc
    s_cmp_lt_u32 s54, 3
    s_cselect_b32 s53, 0x40000000, s69
    buffer_load_dword v5, v28, s[40:43], s53 offen
    s_lshr_b32 s53, s2, 3
    s_lshl_b32 s53, s53, 2
    s_add_u32 s53, s53, s44
    s_sub_u32 s53, s53, 32
    s_mul_i32 s53, s53, 24
    v_add_u32 v24, s53, v0
    v_mul_u32_u24 v25, 10923, v24
    v_lshrrev_b32 v25, 16, v25
    v_mul_u32_u24 v26, 6, v25
    v_sub_u32 v24, v24, v26
    v_lshlrev_b32 v26, 7, v24
    v_add_u32 v27, 896, v26
    v_cmp_gt_u32 vcc, 3, v24
    s_nop 1
    v_cndmask_b32 v26, v27, v26, vcc
    v_add_u32 v25, 256, v25
    v_mul_u32_u24 v25, 3840, v25
    v_add_u32 v29, v25, v26
    v_mov_b32 v24, 0x40000000
    v_cmp_gt_u32 vcc, 24, v0
    s_nop 1
    v_cndmask_b32 v29, v24, v29, vcc
    s_lshr_b32 s14, s2, 5
    s_and_b32 s53, s2, 7
    s_bfe_u32 s54, s2, 0x20003
    s_lshl_b32 s13, s53, 2
    s_add_u32 s13, s13, s54
    s_mul_i32 s8, s13, 303104
    s_mul_i32 s9, s14, 378880
    s_add_u32 s9, s9, 9699328
    s_lshr_b32 s53, s13, 4
    s_mul_i32 s11, s53, 6144
    s_and_b32 s53, s13, 15
    s_lshl_b32 s53, s53, 1
    s_add_u32 s54, s53, 1
    s_cmp_ge_u32 s53, 22
    s_cselect_b32 s55, 2048, 0
    s_cselect_b32 s56, 11, 0
    s_add_u32 s11, s11, s55
    s_sub_u32 s54, s54, s56
    s_cmp_ge_u32 s53, 10
    s_cselect_b32 s55, 2048, 0
    s_cselect_b32 s56, 11, 0
    s_add_u32 s12, s11, s55
    s_sub_u32 s54, s54, s56
    s_cmp_eq_u32 s53, 10
    s_cselect_b32 s11, s11, s12
    s_mul_i32 s55, s54, 11
    s_lshr_b32 s55, s55, 5
    s_mul_i32 s54, s54, 3
    s_sub_u32 s54, s54, s55
    s_add_u32 s54, s54, 11
    s_sub_u32 s55, s54, 27
    s_cmp_ge_u32 s54, 27
    s_cselect_b32 s54, s55, s54
    s_lshl_b32 s10, s54, 1
    s_and_b32 s53, s2, 1
    s_mul_i32 s53, s53, 3
    s_lshr_b32 s54, s2, 6
    s_add_u32 s53, s53, s54
    s_sub_u32 s53, s53, 1
    s_lshl_b32 s53, s53, 5
    s_add_u32 s53, s53, s49
    s_lshl_b32 s15, s53, 6
    s_add_u32 s15, s15, 12821504
    s_mov_b32 s53, 40960
    s_mov_b32 s54, 81920
    s_cmp_eq_u32 s46, 10
    s_cselect_b32 s16, s53, s54
    s_cselect_b32 s17, s54, 0
    s_cselect_b32 s7, 0, s53
    s_lshl_b32 s54, s47, 9
    s_add_u32 s54, s54, 122880
    s_waitcnt vmcnt(1)
    v_lshrrev_b32 v16, 3, v0
    s_lshl_b32 s53, s44, 3
    v_add_u32 v16, s53, v16
    v_and_b32 v17, 7, v0
    v_lshlrev_b32 v18, 4, v17
    v_lshl_add_u32 v18, v16, 8, v18
    v_and_b32 v19, 16, v0
    v_lshl_add_u32 v18, v19, 3, v18
    v_xor_b32 v19, 0x80, v18
    ds_read_b128 v[48:51], v18 offset:0
    ds_read_b128 v[52:55], v19 offset:0
    ds_read_b128 v[56:59], v18 offset:8192
    ds_read_b128 v[60:63], v19 offset:8192
    ds_read_b128 v[64:67], v18 offset:16384
    ds_read_b128 v[68:71], v19 offset:16384
    ds_read_b128 v[72:75], v18 offset:24576
    ds_read_b128 v[76:79], v19 offset:24576
    ds_read_b128 v[80:83], v18 offset:32768
    ds_read_b128 v[84:87], v19 offset:32768
    v_lshlrev_b32 v17, 4, v16
    s_waitcnt lgkmcnt(9)
    v_dot2_f32_bf16 v22, v48, v48, 0
    v_dot2_f32_bf16 v23, v49, v49, 0
    v_dot2_f32_bf16 v22, v50, v50, v22
    v_dot2_f32_bf16 v23, v51, v51, v23
    s_waitcnt lgkmcnt(8)
    v_dot2_f32_bf16 v22, v52, v52, v22
    v_dot2_f32_bf16 v18, v52, s52, 0
    v_dot2_f32_bf16 v23, v53, v53, v23
    v_dot2_f32_bf16 v19, v53, s52, 0
    v_dot2_f32_bf16 v22, v54, v54, v22
    v_dot2_f32_bf16 v18, v54, s52, v18
    v_dot2_f32_bf16 v23, v55, v55, v23
    v_dot2_f32_bf16 v19, v55, s52, v19
    s_waitcnt lgkmcnt(7)
    v_dot2_f32_bf16 v22, v56, v56, v22
    v_dot2_f32_bf16 v18, v56, s52, v18
    v_dot2_f32_bf16 v23, v57, v57, v23
    v_dot2_f32_bf16 v19, v57, s52, v19
    v_dot2_f32_bf16 v22, v58, v58, v22
    v_dot2_f32_bf16 v18, v58, s52, v18
    v_dot2_f32_bf16 v23, v59, v59, v23
    v_dot2_f32_bf16 v19, v59, s52, v19
    s_waitcnt lgkmcnt(6)
    v_dot2_f32_bf16 v22, v60, v60, v22
    v_dot2_f32_bf16 v18, v60, s52, v18
    v_dot2_f32_bf16 v23, v61, v61, v23
    v_dot2_f32_bf16 v19, v61, s52, v19
    v_dot2_f32_bf16 v22, v62, v62, v22
    v_dot2_f32_bf16 v18, v62, s52, v18
    v_dot2_f32_bf16 v23, v63, v63, v23
    v_dot2_f32_bf16 v19, v63, s52, v19
    s_waitcnt lgkmcnt(5)
    v_dot2_f32_bf16 v22, v64, v64, v22
    v_dot2_f32_bf16 v18, v64, s52, v18
    v_dot2_f32_bf16 v23, v65, v65, v23
    v_dot2_f32_bf16 v19, v65, s52, v19
    v_dot2_f32_bf16 v22, v66, v66, v22
    v_dot2_f32_bf16 v18, v66, s52, v18
    v_dot2_f32_bf16 v23, v67, v67, v23
    v_dot2_f32_bf16 v19, v67, s52, v19
    s_waitcnt lgkmcnt(4)
    v_dot2_f32_bf16 v22, v68, v68, v22
    v_dot2_f32_bf16 v18, v68, s52, v18
    v_dot2_f32_bf16 v23, v69, v69, v23
    v_dot2_f32_bf16 v19, v69, s52, v19
    v_dot2_f32_bf16 v22, v70, v70, v22
    v_dot2_f32_bf16 v18, v70, s52, v18
    v_dot2_f32_bf16 v23, v71, v71, v23
    v_dot2_f32_bf16 v19, v71, s52, v19
    s_waitcnt lgkmcnt(3)
    v_dot2_f32_bf16 v22, v72, v72, v22
    v_dot2_f32_bf16 v18, v72, s52, v18
    v_dot2_f32_bf16 v23, v73, v73, v23
    v_dot2_f32_bf16 v19, v73, s52, v19
    v_dot2_f32_bf16 v22, v74, v74, v22
    v_dot2_f32_bf16 v18, v74, s52, v18
    v_dot2_f32_bf16 v23, v75, v75, v23
    v_dot2_f32_bf16 v19, v75, s52, v19
    s_waitcnt lgkmcnt(2)
    v_dot2_f32_bf16 v22, v76, v76, v22
    v_dot2_f32_bf16 v18, v76, s52, v18
    v_dot2_f32_bf16 v23, v77, v77, v23
    v_dot2_f32_bf16 v19, v77, s52, v19
    v_dot2_f32_bf16 v22, v78, v78, v22
    v_dot2_f32_bf16 v18, v78, s52, v18
    v_dot2_f32_bf16 v23, v79, v79, v23
    v_dot2_f32_bf16 v19, v79, s52, v19
    s_waitcnt lgkmcnt(1)
    v_dot2_f32_bf16 v22, v80, v80, v22
    v_dot2_f32_bf16 v18, v80, s52, v18
    v_dot2_f32_bf16 v23, v81, v81, v23
    v_dot2_f32_bf16 v19, v81, s52, v19
    v_dot2_f32_bf16 v22, v82, v82, v22
    v_dot2_f32_bf16 v18, v82, s52, v18
    v_dot2_f32_bf16 v23, v83, v83, v23
    v_dot2_f32_bf16 v19, v83, s52, v19
    s_waitcnt lgkmcnt(0)
    v_dot2_f32_bf16 v22, v84, v84, v22
    v_dot2_f32_bf16 v18, v84, s52, v18
    v_dot2_f32_bf16 v23, v85, v85, v23
    v_dot2_f32_bf16 v19, v85, s52, v19
    v_dot2_f32_bf16 v22, v86, v86, v22
    v_dot2_f32_bf16 v18, v86, s52, v18
    v_dot2_f32_bf16 v23, v87, v87, v23
    v_dot2_f32_bf16 v19, v87, s52, v19
    v_dot2_f32_bf16 v18, v48, s52, v18
    v_dot2_f32_bf16 v19, v49, s52, v19
    v_dot2_f32_bf16 v18, v50, s52, v18
    v_dot2_f32_bf16 v19, v51, s52, v19
    s_nop 2
    v_add_f32 v18, v18, v19
    v_add_f32 v22, v22, v23
    s_nop 0
    v_add_f32_dpp v18, v18, v18 quad_perm:[1,0,3,2] row_mask:0xf bank_mask:0xf
    v_add_f32_dpp v22, v22, v22 quad_perm:[1,0,3,2] row_mask:0xf bank_mask:0xf
    s_nop 0
    v_add_f32_dpp v18, v18, v18 quad_perm:[2,3,0,1] row_mask:0xf bank_mask:0xf
    v_add_f32_dpp v22, v22, v22 quad_perm:[2,3,0,1] row_mask:0xf bank_mask:0xf
    s_nop 0
    v_add_f32_dpp v18, v18, v18 row_half_mirror row_mask:0xf bank_mask:0xf
    v_add_f32_dpp v22, v22, v22 row_half_mirror row_mask:0xf bank_mask:0xf
    v_mul_f32 v18, 0x3acccccd, v18
    v_mov_b32 v19, 0x3727c5ac
    v_fmac_f32 v19, 0x3acccccd, v22
    v_fma_f32 v19, -v18, v18, v19
    v_rsq_f32 v23, v19
    v_xor_b32 v20, 0x80000000, v18
    v_add_u32 v18, s54, v17
    s_mov_b32 exec_lo, 0x01010101
    s_mov_b32 exec_hi, 0x01010101
    v_mul_f32 v21, 0x3fb8aa3b, v23
    v_mul_f32 v22, v19, v23
    ds_write_b128 v18, v[20:23]
    s_cmp_ge_u32 s3, s46
    s_cbranch_scc1 k1_kernel_cq_nopub
    s_add_u32 s53, s45, s47
    s_lshl_b32 s54, s53, 9
    s_add_u32 s54, s54, 12730368
    buffer_store_dwordx4 v[20:23], v17, s[32:35], s54 offen sc1
    s_lshl_b32 s99, s53, 2
    s_add_u32 s54, s99, s44
    s_mul_i32 s54, s54, 320
    s_add_u32 s54, s54, 12767232
    s_mov_b64 exec, 0xfffff
    v_mov_b32 v24, 0
    v_mov_b32 v25, 0
    v_mov_b32 v26, 0
    v_mov_b32 v27, 0
    buffer_store_dwordx4 v[24:27], v1, s[32:35], s54 offen sc1
    s_mov_b32 s101, 1
    s_nop 1
k1_kernel_cq_nopub:
    s_mov_b64 exec, -1
    buffer_load_dword v5, v29, s[40:43], s69 offen
    s_mov_b32 vcc_lo, 0xf0f00f0f
    s_mov_b32 vcc_hi, 0xf0f00f0f
    v_mov_b32 v47, s52
    s_nop 1
    v_cndmask_b32 v44, 0, v47, vcc
    v_cndmask_b32 v45, 0, v47, vcc
    v_cndmask_b32 v46, 0, v47, vcc
    v_cndmask_b32 v47, 0, v47, vcc
    s_waitcnt lgkmcnt(0)
    s_cmp_eq_u32 s101, 0
    s_cbranch_scc1 k1_kernel_cq_nfw
    s_waitcnt vmcnt(1)
k1_kernel_cq_nfw:
    s_barrier
    s_and_b32 s53, s101, s66
    s_cbranch_scc0 k1_kernel_cq_nof
    v_mov_b32 v7, 1
    s_mov_b64 exec, 1
    buffer_store_dword v7, off, s[36:39], s99 sc1
    s_mov_b64 exec, -1
    s_mov_b32 s101, 0
k1_kernel_cq_nof:
    ds_read_b64_tr_b16 v[96:97], v4 offset:20480
    ds_read_b64_tr_b16 v[98:99], v4 offset:20992
    ds_read_b64_tr_b16 v[100:101], v4 offset:22528
    ds_read_b64_tr_b16 v[102:103], v4 offset:23040
    ds_read_b64_tr_b16 v[104:105], v4 offset:24576
    ds_read_b64_tr_b16 v[106:107], v4 offset:25088
    ds_read_b64_tr_b16 v[108:109], v4 offset:26624
    ds_read_b64_tr_b16 v[110:111], v4 offset:27136
    ds_read_b128 v[40:43], v8 offset:0
    ds_read_b128 v[16:19], v9 offset:0
    ds_read_b128 v[20:23], v10 offset:0
    ds_read_b128 v[24:27], v11 offset:0
    ds_read_b128 v[28:31], v12 offset:0
    ds_read_b128 v[32:35], v13 offset:0
    ds_read_b128 v[36:39], v14 offset:0
    s_waitcnt lgkmcnt(7)
    s_barrier
    v_mfma_f32_16x16x32_bf16 v[60:63], v[96:99], v[44:47], 0
    ds_read_b64_tr_b16 v[112:113], v4 offset:48128
    ds_read_b64_tr_b16 v[114:115], v4 offset:48640
    v_mfma_f32_16x16x32_bf16 v[60:63], v[100:103], v[44:47], v[60:63]
    ds_read_b64_tr_b16 v[116:117], v4 offset:50176
    ds_read_b64_tr_b16 v[118:119], v4 offset:50688
    v_mfma_f32_16x16x32_bf16 v[60:63], v[104:107], v[44:47], v[60:63]
    ds_read_b64_tr_b16 v[120:121], v4 offset:52224
    ds_read_b64_tr_b16 v[122:123], v4 offset:52736
    v_mfma_f32_16x16x32_bf16 v[60:63], v[108:111], v[44:47], v[60:63]
    ds_read_b64_tr_b16 v[124:125], v4 offset:54272
    ds_read_b64_tr_b16 v[126:127], v4 offset:54784
    s_waitcnt lgkmcnt(14)
    v_mfma_f32_32x32x16_bf16 v[64:79], v[96:99], v[40:43], 0
    ds_read_b128 v[40:43], v15 offset:0
    s_waitcnt lgkmcnt(14)
    v_mfma_f32_32x32x16_bf16 v[64:79], v[100:103], v[16:19], v[64:79]
    s_waitcnt lgkmcnt(13)
    v_mfma_f32_32x32x16_bf16 v[64:79], v[104:107], v[20:23], v[64:79]
    s_waitcnt lgkmcnt(12)
    v_mfma_f32_32x32x16_bf16 v[64:79], v[108:111], v[24:27], v[64:79]
    s_waitcnt lgkmcnt(1)
    s_barrier
    v_mfma_f32_16x16x32_bf16 v[60:63], v[112:115], v[44:47], v[60:63]
    ds_read_b64_tr_b16 v[128:129], v3 offset:24576
    ds_read_b64_tr_b16 v[130:131], v3 offset:25088
    v_mfma_f32_16x16x32_bf16 v[60:63], v[116:119], v[44:47], v[60:63]
    ds_read_b64_tr_b16 v[132:133], v3 offset:26624
    ds_read_b64_tr_b16 v[134:135], v3 offset:27136
    v_mfma_f32_16x16x32_bf16 v[60:63], v[120:123], v[44:47], v[60:63]
    ds_read_b64_tr_b16 v[136:137], v3 offset:28672
    ds_read_b64_tr_b16 v[138:139], v3 offset:29184
    v_mfma_f32_16x16x32_bf16 v[60:63], v[124:127], v[44:47], v[60:63]
    ds_read_b64_tr_b16 v[140:141], v3 offset:30720
    ds_read_b64_tr_b16 v[142:143], v3 offset:31232
    v_mfma_f32_32x32x16_bf16 v[64:79], v[112:115], v[28:31], v[64:79]
    ds_read_b128 v[16:19], v8 offset:40960
    ds_read_b128 v[20:23], v9 offset:40960
    v_mfma_f32_32x32x16_bf16 v[64:79], v[116:119], v[32:35], v[64:79]
    ds_read_b128 v[24:27], v10 offset:40960
    ds_read_b128 v[28:31], v11 offset:40960
    v_mfma_f32_32x32x16_bf16 v[64:79], v[120:123], v[36:39], v[64:79]
    ds_read_b128 v[32:35], v8 offset:8192
    ds_read_b128 v[36:39], v9 offset:8192
    s_waitcnt lgkmcnt(14)
    v_mfma_f32_32x32x16_bf16 v[64:79], v[124:127], v[40:43], v[64:79]
    ds_read_b128 v[40:43], v10 offset:8192
    s_waitcnt lgkmcnt(6)
    v_mfma_f32_32x32x16_bf16 v[80:95], v[96:99], v[16:19], 0
    ds_read_b128 v[16:19], v11 offset:8192
    s_waitcnt lgkmcnt(6)
    v_mfma_f32_32x32x16_bf16 v[80:95], v[100:103], v[20:23], v[80:95]
    ds_read_b128 v[20:23], v12 offset:40960
    s_waitcnt lgkmcnt(6)
    v_mfma_f32_32x32x16_bf16 v[80:95], v[104:107], v[24:27], v[80:95]
    ds_read_b128 v[24:27], v13 offset:40960
    s_waitcnt lgkmcnt(6)
    v_mfma_f32_32x32x16_bf16 v[80:95], v[108:111], v[28:31], v[80:95]
    ds_read_b128 v[28:31], v14 offset:40960
    s_barrier
    v_mfma_f32_16x16x32_bf16 v[60:63], v[128:131], v[44:47], v[60:63]
    ds_read_b64_tr_b16 v[144:145], v4 offset:0
    ds_read_b64_tr_b16 v[146:147], v4 offset:512
    v_mfma_f32_16x16x32_bf16 v[60:63], v[132:135], v[44:47], v[60:63]
    ds_read_b64_tr_b16 v[148:149], v4 offset:2048
    ds_read_b64_tr_b16 v[150:151], v4 offset:2560
    v_mfma_f32_16x16x32_bf16 v[60:63], v[136:139], v[44:47], v[60:63]
    ds_read_b64_tr_b16 v[152:153], v4 offset:4096
    ds_read_b64_tr_b16 v[154:155], v4 offset:4608
    v_mfma_f32_16x16x32_bf16 v[60:63], v[140:143], v[44:47], v[60:63]
    ds_read_b64_tr_b16 v[156:157], v4 offset:6144
    ds_read_b64_tr_b16 v[158:159], v4 offset:6656
    s_waitcnt lgkmcnt(14)
    v_mfma_f32_32x32x16_bf16 v[64:79], v[128:131], v[32:35], v[64:79]
    ds_read_b128 v[32:35], v15 offset:40960
    s_waitcnt lgkmcnt(14)
    v_mfma_f32_32x32x16_bf16 v[64:79], v[132:135], v[36:39], v[64:79]
    ds_read_b128 v[36:39], v12 offset:8192
    s_waitcnt lgkmcnt(14)
    v_mfma_f32_32x32x16_bf16 v[64:79], v[136:139], v[40:43], v[64:79]
    ds_read_b128 v[40:43], v13 offset:8192
    s_waitcnt lgkmcnt(14)
    v_mfma_f32_32x32x16_bf16 v[64:79], v[140:143], v[16:19], v[64:79]
    ds_read_b128 v[16:19], v14 offset:8192
    s_waitcnt lgkmcnt(14)
    v_mfma_f32_32x32x16_bf16 v[80:95], v[112:115], v[20:23], v[80:95]
    ds_read_b128 v[20:23], v15 offset:8192
    s_waitcnt lgkmcnt(14)
    v_mfma_f32_32x32x16_bf16 v[80:95], v[116:119], v[24:27], v[80:95]
    s_waitcnt lgkmcnt(13)
    v_mfma_f32_32x32x16_bf16 v[80:95], v[120:123], v[28:31], v[80:95]
    s_waitcnt lgkmcnt(4)
    v_mfma_f32_32x32x16_bf16 v[80:95], v[124:127], v[32:35], v[80:95]
    s_barrier
    v_mfma_f32_16x16x32_bf16 v[60:63], v[144:147], v[44:47], v[60:63]
    ds_read_b64_tr_b16 v[160:161], v4 offset:20480
    ds_read_b64_tr_b16 v[162:163], v4 offset:20992
    v_mfma_f32_16x16x32_bf16 v[60:63], v[148:151], v[44:47], v[60:63]
    ds_read_b64_tr_b16 v[164:165], v4 offset:22528
    ds_read_b64_tr_b16 v[166:167], v4 offset:23040
    v_mfma_f32_16x16x32_bf16 v[60:63], v[152:155], v[44:47], v[60:63]
    ds_read_b64_tr_b16 v[168:169], v4 offset:24576
    ds_read_b64_tr_b16 v[170:171], v4 offset:25088
    v_mfma_f32_16x16x32_bf16 v[60:63], v[156:159], v[44:47], v[60:63]
    ds_read_b64_tr_b16 v[172:173], v4 offset:26624
    ds_read_b64_tr_b16 v[174:175], v4 offset:27136
    s_waitcnt lgkmcnt(11)
    v_mfma_f32_32x32x16_bf16 v[64:79], v[144:147], v[36:39], v[64:79]
    ds_read_b128 v[24:27], v8 offset:49152
    ds_read_b128 v[28:31], v9 offset:49152
    s_waitcnt lgkmcnt(12)
    v_mfma_f32_32x32x16_bf16 v[64:79], v[148:151], v[40:43], v[64:79]
    ds_read_b128 v[32:35], v10 offset:49152
    ds_read_b128 v[36:39], v11 offset:49152
    s_waitcnt lgkmcnt(13)
    v_mfma_f32_32x32x16_bf16 v[64:79], v[152:155], v[16:19], v[64:79]
    ds_read_b128 v[40:43], v8 offset:16384
    ds_read_b128 v[16:19], v9 offset:16384
    s_waitcnt lgkmcnt(14)
    v_mfma_f32_32x32x16_bf16 v[64:79], v[156:159], v[20:23], v[64:79]
    ds_read_b128 v[20:23], v10 offset:16384
    s_waitcnt lgkmcnt(6)
    v_mfma_f32_32x32x16_bf16 v[80:95], v[128:131], v[24:27], v[80:95]
    ds_read_b128 v[24:27], v11 offset:16384
    s_waitcnt lgkmcnt(6)
    v_mfma_f32_32x32x16_bf16 v[80:95], v[132:135], v[28:31], v[80:95]
    ds_read_b128 v[28:31], v12 offset:49152
    s_waitcnt lgkmcnt(6)
    v_mfma_f32_32x32x16_bf16 v[80:95], v[136:139], v[32:35], v[80:95]
    ds_read_b128 v[32:35], v13 offset:49152
    s_waitcnt lgkmcnt(6)
    v_mfma_f32_32x32x16_bf16 v[80:95], v[140:143], v[36:39], v[80:95]
    ds_read_b128 v[36:39], v14 offset:49152
    s_barrier
    v_mfma_f32_16x16x32_bf16 v[60:63], v[160:163], v[44:47], v[60:63]
    ds_read_b64_tr_b16 v[176:177], v4 offset:48128
    ds_read_b64_tr_b16 v[178:179], v4 offset:48640
    v_mfma_f32_16x16x32_bf16 v[60:63], v[164:167], v[44:47], v[60:63]
    ds_read_b64_tr_b16 v[180:181], v4 offset:50176
    ds_read_b64_tr_b16 v[182:183], v4 offset:50688
    v_mfma_f32_16x16x32_bf16 v[60:63], v[168:171], v[44:47], v[60:63]
    ds_read_b64_tr_b16 v[184:185], v4 offset:52224
    ds_read_b64_tr_b16 v[186:187], v4 offset:52736
    v_mfma_f32_16x16x32_bf16 v[60:63], v[172:175], v[44:47], v[60:63]
    ds_read_b64_tr_b16 v[188:189], v4 offset:54272
    ds_read_b64_tr_b16 v[190:191], v4 offset:54784
    s_waitcnt lgkmcnt(14)
    v_mfma_f32_32x32x16_bf16 v[64:79], v[160:163], v[40:43], v[64:79]
    ds_read_b128 v[40:43], v15 offset:49152
    s_waitcnt lgkmcnt(14)
    v_mfma_f32_32x32x16_bf16 v[64:79], v[164:167], v[16:19], v[64:79]
    ds_read_b128 v[16:19], v12 offset:16384
    s_waitcnt lgkmcnt(14)
    v_mfma_f32_32x32x16_bf16 v[64:79], v[168:171], v[20:23], v[64:79]
    ds_read_b128 v[20:23], v13 offset:16384
    s_waitcnt lgkmcnt(14)
    v_mfma_f32_32x32x16_bf16 v[64:79], v[172:175], v[24:27], v[64:79]
    ds_read_b128 v[24:27], v14 offset:16384
    s_waitcnt lgkmcnt(14)
    v_mfma_f32_32x32x16_bf16 v[80:95], v[144:147], v[28:31], v[80:95]
    ds_read_b128 v[28:31], v15 offset:16384
    s_waitcnt lgkmcnt(14)
    v_mfma_f32_32x32x16_bf16 v[80:95], v[148:151], v[32:35], v[80:95]
    s_waitcnt lgkmcnt(13)
    v_mfma_f32_32x32x16_bf16 v[80:95], v[152:155], v[36:39], v[80:95]
    s_waitcnt lgkmcnt(4)
    v_mfma_f32_32x32x16_bf16 v[80:95], v[156:159], v[40:43], v[80:95]
    s_waitcnt vmcnt(0)
    s_barrier
    v_mfma_f32_16x16x32_bf16 v[60:63], v[176:179], v[44:47], v[60:63]
    ds_read_b64_tr_b16 v[192:193], v3 offset:24576
    ds_read_b64_tr_b16 v[194:195], v3 offset:25088
    v_mfma_f32_16x16x32_bf16 v[60:63], v[180:183], v[44:47], v[60:63]
    ds_read_b64_tr_b16 v[196:197], v3 offset:26624
    ds_read_b64_tr_b16 v[198:199], v3 offset:27136
    v_mfma_f32_16x16x32_bf16 v[60:63], v[184:187], v[44:47], v[60:63]
    ds_read_b64_tr_b16 v[200:201], v3 offset:28672
    ds_read_b64_tr_b16 v[202:203], v3 offset:29184
    v_mfma_f32_16x16x32_bf16 v[60:63], v[188:191], v[44:47], v[60:63]
    ds_read_b64_tr_b16 v[204:205], v3 offset:30720
    ds_read_b64_tr_b16 v[206:207], v3 offset:31232
    s_waitcnt lgkmcnt(11)
    v_mfma_f32_32x32x16_bf16 v[64:79], v[176:179], v[16:19], v[64:79]
    ds_read_b128 v[32:35], v8 offset:57344
    ds_read_b128 v[36:39], v9 offset:57344
    s_waitcnt lgkmcnt(12)
    v_mfma_f32_32x32x16_bf16 v[64:79], v[180:183], v[20:23], v[64:79]
    ds_read_b128 v[40:43], v10 offset:57344
    ds_read_b128 v[16:19], v11 offset:57344
    s_waitcnt lgkmcnt(13)
    v_mfma_f32_32x32x16_bf16 v[64:79], v[184:187], v[24:27], v[64:79]
    ds_read_b128 v[20:23], v8 offset:24576
    ds_read_b128 v[24:27], v9 offset:24576
    s_waitcnt lgkmcnt(14)
    v_mfma_f32_32x32x16_bf16 v[64:79], v[188:191], v[28:31], v[64:79]
    ds_read_b128 v[28:31], v10 offset:24576
    s_waitcnt lgkmcnt(6)
    v_mfma_f32_32x32x16_bf16 v[80:95], v[160:163], v[32:35], v[80:95]
    ds_read_b128 v[32:35], v11 offset:24576
    s_waitcnt lgkmcnt(6)
    v_mfma_f32_32x32x16_bf16 v[80:95], v[164:167], v[36:39], v[80:95]
    ds_read_b128 v[36:39], v12 offset:57344
    s_waitcnt lgkmcnt(6)
    v_mfma_f32_32x32x16_bf16 v[80:95], v[168:171], v[40:43], v[80:95]
    ds_read_b128 v[40:43], v13 offset:57344
    s_waitcnt lgkmcnt(6)
    v_mfma_f32_32x32x16_bf16 v[80:95], v[172:175], v[16:19], v[80:95]
    ds_read_b128 v[16:19], v14 offset:57344
    s_barrier
    v_mfma_f32_16x16x32_bf16 v[60:63], v[192:195], v[44:47], v[60:63]
    ds_read_b64_tr_b16 v[208:209], v4 offset:0
    ds_read_b64_tr_b16 v[210:211], v4 offset:512
    v_mfma_f32_16x16x32_bf16 v[60:63], v[196:199], v[44:47], v[60:63]
    ds_read_b64_tr_b16 v[212:213], v4 offset:2048
    ds_read_b64_tr_b16 v[214:215], v4 offset:2560
    v_mfma_f32_16x16x32_bf16 v[60:63], v[200:203], v[44:47], v[60:63]
    ds_read_b64_tr_b16 v[216:217], v4 offset:4096
    ds_read_b64_tr_b16 v[218:219], v4 offset:4608
    v_mfma_f32_16x16x32_bf16 v[60:63], v[204:207], v[44:47], v[60:63]
    ds_read_b64_tr_b16 v[220:221], v4 offset:6144
    ds_read_b64_tr_b16 v[222:223], v4 offset:6656
    s_cmp_lg_u32 s66, 0
    s_cbranch_scc0 k1_kernel_cq_k7
    s_call_b64 s[4:5], k1_kernel_cq_chk
k1_kernel_cq_k7:
    s_waitcnt lgkmcnt(14)
    v_mfma_f32_32x32x16_bf16 v[64:79], v[192:195], v[20:23], v[64:79]
    ds_read_b128 v[20:23], v15 offset:57344
    s_waitcnt lgkmcnt(14)
    v_mfma_f32_32x32x16_bf16 v[64:79], v[196:199], v[24:27], v[64:79]
    ds_read_b128 v[24:27], v12 offset:24576
    s_waitcnt lgkmcnt(14)
    v_mfma_f32_32x32x16_bf16 v[64:79], v[200:203], v[28:31], v[64:79]
    ds_read_b128 v[28:31], v13 offset:24576
    s_waitcnt lgkmcnt(14)
    v_mfma_f32_32x32x16_bf16 v[64:79], v[204:207], v[32:35], v[64:79]
    ds_read_b128 v[32:35], v14 offset:24576
    s_waitcnt lgkmcnt(14)
    v_mfma_f32_32x32x16_bf16 v[80:95], v[176:179], v[36:39], v[80:95]
    ds_read_b128 v[36:39], v15 offset:24576
    s_waitcnt lgkmcnt(14)
    v_mfma_f32_32x32x16_bf16 v[80:95], v[180:183], v[40:43], v[80:95]
    ds_read_b128 v[40:43], v8 offset:32768
    s_waitcnt lgkmcnt(14)
    v_mfma_f32_32x32x16_bf16 v[80:95], v[184:187], v[16:19], v[80:95]
    ds_read_b128 v[16:19], v9 offset:32768
    s_waitcnt lgkmcnt(6)
    v_mfma_f32_32x32x16_bf16 v[80:95], v[188:191], v[20:23], v[80:95]
    ds_read_b128 v[20:23], v10 offset:32768
    s_barrier
    v_mfma_f32_16x16x32_bf16 v[60:63], v[208:211], v[44:47], v[60:63]
    ds_read_b64_tr_b16 v[224:225], v4 offset:20480
    ds_read_b64_tr_b16 v[226:227], v4 offset:20992
    v_mfma_f32_16x16x32_bf16 v[60:63], v[212:215], v[44:47], v[60:63]
    ds_read_b64_tr_b16 v[228:229], v4 offset:22528
    ds_read_b64_tr_b16 v[230:231], v4 offset:23040
    v_mfma_f32_16x16x32_bf16 v[60:63], v[216:219], v[44:47], v[60:63]
    ds_read_b64_tr_b16 v[232:233], v4 offset:24576
    ds_read_b64_tr_b16 v[234:235], v4 offset:25088
    v_mfma_f32_16x16x32_bf16 v[60:63], v[220:223], v[44:47], v[60:63]
    ds_read_b64_tr_b16 v[236:237], v4 offset:26624
    ds_read_b64_tr_b16 v[238:239], v4 offset:27136
    s_cmp_lg_u32 s66, 0
    s_cbranch_scc0 k1_kernel_cq_k8
    s_call_b64 s[4:5], k1_kernel_cq_chk
k1_kernel_cq_k8:
    s_waitcnt lgkmcnt(14)
    v_mfma_f32_32x32x16_bf16 v[64:79], v[208:211], v[24:27], v[64:79]
    ds_read_b128 v[24:27], v11 offset:32768
    s_waitcnt lgkmcnt(14)
    v_mfma_f32_32x32x16_bf16 v[64:79], v[212:215], v[28:31], v[64:79]
    ds_read_b128 v[28:31], v12 offset:32768
    s_waitcnt lgkmcnt(14)
    v_mfma_f32_32x32x16_bf16 v[64:79], v[216:219], v[32:35], v[64:79]
    ds_read_b128 v[32:35], v13 offset:32768
    s_waitcnt lgkmcnt(14)
    v_mfma_f32_32x32x16_bf16 v[64:79], v[220:223], v[36:39], v[64:79]
    ds_read_b128 v[36:39], v14 offset:32768
    s_waitcnt lgkmcnt(4)
    s_barrier
    v_mfma_f32_16x16x32_bf16 v[60:63], v[224:227], v[44:47], v[60:63]
    ds_read_b64_tr_b16 v[240:241], v4 offset:48128
    ds_read_b64_tr_b16 v[242:243], v4 offset:48640
    v_mfma_f32_16x16x32_bf16 v[60:63], v[228:231], v[44:47], v[60:63]
    ds_read_b64_tr_b16 v[244:245], v4 offset:50176
    ds_read_b64_tr_b16 v[246:247], v4 offset:50688
    v_mfma_f32_16x16x32_bf16 v[60:63], v[232:235], v[44:47], v[60:63]
    ds_read_b64_tr_b16 v[248:249], v4 offset:52224
    ds_read_b64_tr_b16 v[250:251], v4 offset:52736
    v_mfma_f32_16x16x32_bf16 v[60:63], v[236:239], v[44:47], v[60:63]
    ds_read_b64_tr_b16 v[252:253], v4 offset:54272
    ds_read_b64_tr_b16 v[254:255], v4 offset:54784
    s_cmp_lg_u32 s66, 0
    s_cbranch_scc0 k1_kernel_cq_k9
    s_call_b64 s[4:5], k1_kernel_cq_chk
k1_kernel_cq_k9:
    v_mfma_f32_32x32x16_bf16 v[64:79], v[224:227], v[40:43], v[64:79]
    ds_read_b128 v[40:43], v15 offset:32768
    v_mfma_f32_32x32x16_bf16 v[64:79], v[228:231], v[16:19], v[64:79]
    v_mfma_f32_32x32x16_bf16 v[64:79], v[232:235], v[20:23], v[64:79]
    s_waitcnt lgkmcnt(12)
    v_mfma_f32_32x32x16_bf16 v[64:79], v[236:239], v[24:27], v[64:79]
    s_waitcnt lgkmcnt(1)
    s_waitcnt lgkmcnt(0)
    s_barrier
    v_add_u32 v8, 40960, v8
    v_add_u32 v9, 40960, v9
    v_add_u32 v10, 40960, v10
    v_add_u32 v11, 40960, v11
    v_add_u32 v12, 40960, v12
    v_add_u32 v13, 40960, v13
    v_add_u32 v14, 40960, v14
    v_add_u32 v15, 40960, v15
    v_mfma_f32_16x16x32_bf16 v[60:63], v[240:243], v[44:47], v[60:63]
    ds_read_b128 v[16:19], v8 offset:24576
    ds_read_b128 v[20:23], v9 offset:24576
    v_mfma_f32_16x16x32_bf16 v[60:63], v[244:247], v[44:47], v[60:63]
    ds_read_b128 v[24:27], v10 offset:24576
    v_mfma_f32_16x16x32_bf16 v[60:63], v[248:251], v[44:47], v[60:63]
    v_mfma_f32_16x16x32_bf16 v[60:63], v[252:255], v[44:47], v[60:63]
    s_cmp_lg_u32 s66, 0
    s_cbranch_scc0 k1_kernel_cq_k10
    s_call_b64 s[4:5], k1_kernel_cq_chk
k1_kernel_cq_k10:
    v_mfma_f32_32x32x16_bf16 v[64:79], v[240:243], v[28:31], v[64:79]
    ds_read_b128 v[28:31], v11 offset:24576
    v_mfma_f32_32x32x16_bf16 v[64:79], v[244:247], v[32:35], v[64:79]
    ds_read_b128 v[32:35], v12 offset:24576
    v_mfma_f32_32x32x16_bf16 v[64:79], v[248:251], v[36:39], v[64:79]
    ds_read_b128 v[36:39], v13 offset:24576
    v_mfma_f32_32x32x16_bf16 v[64:79], v[252:255], v[40:43], v[64:79]
    ds_read_b128 v[40:43], v14 offset:24576
    ds_read_b128 v[44:47], v15 offset:24576
    s_mov_b32 s51, 1
    s_mov_b32 s65, 1
    s_waitcnt lgkmcnt(7)
    v_mfma_f32_32x32x16_bf16 v[80:95], v[192:195], v[16:19], v[80:95]
    s_add_u32 s65, s65, 1
    s_add_u32 s51, s51, 1
    s_cmp_eq_u32 s51, 3
    s_cselect_b32 s51, 0, s51
    s_cselect_b32 s68, 0xfffec000, s100
    ds_read_b128 v[16:19], v8 offset:32768
    v_mbcnt_lo_u32_b32 v3, -1, 0
    v_and_b32 v3, 32, v3
    v_lshlrev_b32 v3, 1, v3
    ds_bpermute_b32 v48, v3, v60 offset:0
    ds_bpermute_b32 v49, v3, v61 offset:0
    ds_bpermute_b32 v50, v3, v62 offset:0
    ds_bpermute_b32 v51, v3, v63 offset:0
    ds_bpermute_b32 v52, v3, v60 offset:128
    ds_bpermute_b32 v53, v3, v61 offset:128
    ds_bpermute_b32 v54, v3, v62 offset:128
    ds_bpermute_b32 v55, v3, v63 offset:128
    ds_bpermute_b32 v56, v3, v60 offset:16
    ds_bpermute_b32 v57, v3, v61 offset:16
    ds_bpermute_b32 v58, v3, v62 offset:16
    ds_bpermute_b32 v59, v3, v63 offset:16
    ds_bpermute_b32 v60, v3, v60 offset:144
    ds_bpermute_b32 v61, v3, v61 offset:144
    ds_bpermute_b32 v62, v3, v62 offset:144
    s_waitcnt lgkmcnt(15)
    v_mfma_f32_32x32x16_bf16 v[80:95], v[196:199], v[20:23], v[80:95]
    ds_read_b128 v[20:23], v9 offset:32768
    v_add_u32 v8, s68, v8
    ds_bpermute_b32 v63, v3, v63 offset:144
    s_lshl_b32 s58, s47, 9
    v_add_u32 v3, s58, v2
    ds_read_b64 v[4:5], v3
    s_mul_i32 s57, s47, 151552
    s_add_u32 s57, s57, s62
    v_mfma_f32_32x32x16_bf16 v[80:95], v[200:203], v[24:27], v[80:95]
    s_cmp_lg_u32 s66, 0
    s_cbranch_scc0 k1_kernel_cq_k22
    s_call_b64 s[4:5], k1_kernel_cq_chk
k1_kernel_cq_k22:
    ds_read_b128 v[24:27], v10 offset:32768
    v_add_u32 v9, s68, v9
    v_mfma_f32_32x32x16_bf16 v[80:95], v[204:207], v[28:31], v[80:95]
    ds_read_b128 v[28:31], v11 offset:32768
    v_add_u32 v10, s68, v10
    s_waitcnt lgkmcnt(2)
    v_fma_f32 v64, v4, v48, v64
    v_fma_f32 v65, v4, v49, v65
    v_fma_f32 v66, v4, v50, v66
    v_fma_f32 v67, v4, v51, v67
    v_fma_f32 v64, v5, v64, s60
    v_fma_f32 v65, v5, v65, s60
    v_fma_f32 v66, v5, v66, s60
    v_fma_f32 v67, v5, v67, s60
    v_exp_f32 v3, v64 clamp
    v_max_f32 v64, s60, v64
    v_exp_f32 v6, v65 clamp
    v_max_f32 v65, s60, v65
    v_exp_f32 v7, v66 clamp
    v_max_f32 v66, s60, v66
    v_mfma_f32_32x32x16_bf16 v[80:95], v[208:211], v[32:35], v[80:95]
    ds_read_b128 v[32:35], v12 offset:32768
    v_add_u32 v11, s68, v11
    v_fma_f32 v64, v64, s61, v3
    v_exp_f32 v3, v67 clamp
    v_max_f32 v67, s60, v67
    v_fma_f32 v65, v65, s61, v6
    v_fma_f32 v66, v66, s61, v7
    v_fma_f32 v67, v67, s61, v3
    v_cvt_pk_bf16_f32 v64, v64, v65
    v_cvt_pk_bf16_f32 v65, v66, v67
    v_fma_f32 v68, v4, v52, v68
    v_fma_f32 v69, v4, v53, v69
    v_fma_f32 v70, v4, v54, v70
    v_fma_f32 v71, v4, v55, v71
    v_fma_f32 v68, v5, v68, s60
    v_fma_f32 v69, v5, v69, s60
    v_fma_f32 v70, v5, v70, s60
    v_fma_f32 v71, v5, v71, s60
    v_mfma_f32_32x32x16_bf16 v[80:95], v[212:215], v[36:39], v[80:95]
    ds_read_b128 v[36:39], v13 offset:32768
    v_add_u32 v12, s68, v12
    v_exp_f32 v3, v68 clamp
    v_max_f32 v68, s60, v68
    v_exp_f32 v6, v69 clamp
    v_max_f32 v69, s60, v69
    v_exp_f32 v7, v70 clamp
    v_max_f32 v70, s60, v70
    v_fma_f32 v68, v68, s61, v3
    v_exp_f32 v3, v71 clamp
    v_max_f32 v71, s60, v71
    v_fma_f32 v69, v69, s61, v6
    v_fma_f32 v70, v70, s61, v7
    v_fma_f32 v71, v71, s61, v3
    v_cvt_pk_bf16_f32 v66, v68, v69
    v_mfma_f32_32x32x16_bf16 v[80:95], v[216:219], v[40:43], v[80:95]
    s_cmp_lg_u32 s66, 0
    s_cbranch_scc0 k1_kernel_cq_k26
    s_call_b64 s[4:5], k1_kernel_cq_chk
k1_kernel_cq_k26:
    ds_read_b128 v[40:43], v14 offset:32768
    v_add_u32 v13, s68, v13
    v_cvt_pk_bf16_f32 v67, v70, v71
    buffer_store_dwordx4 v[64:67], v1, s[32:35], s57 offen sc1
    v_fma_f32 v72, v4, v56, v72
    v_fma_f32 v73, v4, v57, v73
    v_fma_f32 v74, v4, v58, v74
    v_fma_f32 v75, v4, v59, v75
    v_fma_f32 v72, v5, v72, s60
    v_fma_f32 v73, v5, v73, s60
    v_fma_f32 v74, v5, v74, s60
    v_fma_f32 v75, v5, v75, s60
    v_exp_f32 v3, v72 clamp
    v_max_f32 v72, s60, v72
    v_exp_f32 v6, v73 clamp
    v_max_f32 v73, s60, v73
    v_mfma_f32_32x32x16_bf16 v[80:95], v[220:223], v[44:47], v[80:95]
    ds_read_b128 v[44:47], v15 offset:32768
    v_add_u32 v14, s68, v14
    v_exp_f32 v7, v74 clamp
    v_max_f32 v74, s60, v74
    v_fma_f32 v72, v72, s61, v3
    v_exp_f32 v3, v75 clamp
    v_max_f32 v75, s60, v75
    v_fma_f32 v73, v73, s61, v6
    v_fma_f32 v74, v74, s61, v7
    v_fma_f32 v75, v75, s61, v3
    v_cvt_pk_bf16_f32 v72, v72, v73
    v_cvt_pk_bf16_f32 v73, v74, v75
    v_fma_f32 v76, v4, v60, v76
    v_fma_f32 v77, v4, v61, v77
    v_fma_f32 v78, v4, v62, v78
    v_fma_f32 v79, v4, v63, v79
    v_fma_f32 v76, v5, v76, s60
    v_mfma_f32_32x32x16_bf16 v[80:95], v[224:227], v[16:19], v[80:95]
    v_add_u32 v15, s68, v15
    v_fma_f32 v77, v5, v77, s60
    v_fma_f32 v78, v5, v78, s60
    v_fma_f32 v79, v5, v79, s60
    v_exp_f32 v3, v76 clamp
    v_max_f32 v76, s60, v76
    v_exp_f32 v6, v77 clamp
    v_max_f32 v77, s60, v77
    v_exp_f32 v7, v78 clamp
    v_max_f32 v78, s60, v78
    v_fma_f32 v76, v76, s61, v3
    v_exp_f32 v3, v79 clamp
    v_max_f32 v79, s60, v79
    v_fma_f32 v77, v77, s61, v6
    v_mfma_f32_32x32x16_bf16 v[80:95], v[228:231], v[20:23], v[80:95]
    v_fma_f32 v78, v78, s61, v7
    v_fma_f32 v79, v79, s61, v3
    v_cvt_pk_bf16_f32 v74, v76, v77
    v_cvt_pk_bf16_f32 v75, v78, v79
    s_add_u32 s57, s57, 4096
    buffer_store_dwordx4 v[72:75], v1, s[32:35], s57 offen sc1
    s_add_u32 s47, s47, 1
    s_cmp_ge_u32 s47, s46
    s_cselect_b32 s47, 0, s47
    s_waitcnt lgkmcnt(5)
    v_mfma_f32_32x32x16_bf16 v[80:95], v[232:235], v[24:27], v[80:95]
    s_cmp_lg_u32 s66, 0
    s_cbranch_scc1 k1_kernel_cq_tbs
k1_kernel_cq_tbd:
    s_waitcnt vmcnt(2)
    s_waitcnt lgkmcnt(0)
    s_barrier
    ds_read_b128 v[16:19], v8 offset:0
    ds_read_b128 v[20:23], v9 offset:0
    ds_read_b128 v[24:27], v10 offset:0
    v_mfma_f32_32x32x16_bf16 v[80:95], v[236:239], v[28:31], v[80:95]
    ds_read_b128 v[28:31], v11 offset:0
    v_mfma_f32_32x32x16_bf16 v[80:95], v[240:243], v[32:35], v[80:95]
    ds_read_b128 v[32:35], v12 offset:0
    v_mfma_f32_32x32x16_bf16 v[80:95], v[244:247], v[36:39], v[80:95]
    ds_read_b128 v[36:39], v13 offset:0
    v_mfma_f32_32x32x16_bf16 v[80:95], v[248:251], v[40:43], v[80:95]
    ds_read_b128 v[40:43], v14 offset:0
    v_mfma_f32_32x32x16_bf16 v[80:95], v[252:255], v[44:47], v[80:95]
    ds_read_b128 v[44:47], v15 offset:0
    s_nop 3
k1_kernel_cq_loop:
    s_waitcnt lgkmcnt(7)
    v_mfma_f32_32x32x16_bf16 v[64:79], v[96:99], v[16:19], 0
    ds_read_b128 v[16:19], v8 offset:8192
    s_lshl_b32 s58, s47, 9
    v_add_u32 v3, s58, v2
    ds_read_b64 v[4:5], v3
    s_mul_i32 s57, s47, 151552
    s_add_u32 s57, s57, s62
    s_waitcnt lgkmcnt(8)
    v_mfma_f32_32x32x16_bf16 v[64:79], v[100:103], v[20:23], v[64:79]
    s_add_u32 s65, s65, 1
    s_add_u32 s51, s51, 1
    s_cmp_eq_u32 s51, 3
    s_cselect_b32 s51, 0, s51
    s_cselect_b32 s68, 0xfffec000, s100
    ds_read_b128 v[20:23], v9 offset:8192
    s_waitcnt lgkmcnt(8)
    v_mfma_f32_32x32x16_bf16 v[64:79], v[104:107], v[24:27], v[64:79]
    ds_read_b128 v[24:27], v10 offset:8192
    s_waitcnt lgkmcnt(8)
    v_mfma_f32_32x32x16_bf16 v[64:79], v[108:111], v[28:31], v[64:79]
    ds_read_b128 v[28:31], v11 offset:8192
    s_waitcnt lgkmcnt(3)
    v_fma_f32 v80, v4, v48, v80
    v_fma_f32 v81, v4, v49, v81
    v_fma_f32 v82, v4, v50, v82
    v_fma_f32 v83, v4, v51, v83
    v_mfma_f32_32x32x16_bf16 v[64:79], v[112:115], v[32:35], v[64:79]
    ds_read_b128 v[32:35], v12 offset:8192
    v_fma_f32 v80, v5, v80, s60
    v_fma_f32 v81, v5, v81, s60
    v_fma_f32 v82, v5, v82, s60
    v_fma_f32 v83, v5, v83, s60
    v_mfma_f32_32x32x16_bf16 v[64:79], v[116:119], v[36:39], v[64:79]
    ds_read_b128 v[36:39], v13 offset:8192
    v_exp_f32 v3, v80 clamp
    v_max_f32 v80, s60, v80
    v_mfma_f32_32x32x16_bf16 v[64:79], v[120:123], v[40:43], v[64:79]
    ds_read_b128 v[40:43], v14 offset:8192
    v_exp_f32 v6, v81 clamp
    v_max_f32 v81, s60, v81
    v_mfma_f32_32x32x16_bf16 v[64:79], v[124:127], v[44:47], v[64:79]
    ds_read_b128 v[44:47], v15 offset:8192
    v_exp_f32 v7, v82 clamp
    v_max_f32 v82, s60, v82
    v_fma_f32 v80, v80, s61, v3
    v_mfma_f32_32x32x16_bf16 v[64:79], v[128:131], v[16:19], v[64:79]
    ds_read_b128 v[16:19], v8 offset:16384
    v_exp_f32 v3, v83 clamp
    v_max_f32 v83, s60, v83
    v_fma_f32 v81, v81, s61, v6
    s_waitcnt lgkmcnt(7)
    v_mfma_f32_32x32x16_bf16 v[64:79], v[132:135], v[20:23], v[64:79]
    ds_read_b128 v[20:23], v9 offset:16384
    v_fma_f32 v82, v82, s61, v7
    v_fma_f32 v83, v83, s61, v3
    v_cvt_pk_bf16_f32 v80, v80, v81
    v_cvt_pk_bf16_f32 v81, v82, v83
    s_waitcnt lgkmcnt(7)
    v_mfma_f32_32x32x16_bf16 v[64:79], v[136:139], v[24:27], v[64:79]
    ds_read_b128 v[24:27], v10 offset:16384
    v_fma_f32 v84, v4, v52, v84
    v_fma_f32 v85, v4, v53, v85
    v_fma_f32 v86, v4, v54, v86
    v_fma_f32 v87, v4, v55, v87
    s_waitcnt lgkmcnt(7)
    v_mfma_f32_32x32x16_bf16 v[64:79], v[140:143], v[28:31], v[64:79]
    ds_read_b128 v[28:31], v11 offset:16384
    v_fma_f32 v84, v5, v84, s60
    v_fma_f32 v85, v5, v85, s60
    v_fma_f32 v86, v5, v86, s60
    v_fma_f32 v87, v5, v87, s60
    s_waitcnt lgkmcnt(7)
    v_mfma_f32_32x32x16_bf16 v[64:79], v[144:147], v[32:35], v[64:79]
    ds_read_b128 v[32:35], v12 offset:16384
    v_exp_f32 v3, v84 clamp
    v_max_f32 v84, s60, v84
    s_waitcnt lgkmcnt(7)
    v_mfma_f32_32x32x16_bf16 v[64:79], v[148:151], v[36:39], v[64:79]
    ds_read_b128 v[36:39], v13 offset:16384
    v_exp_f32 v6, v85 clamp
    v_max_f32 v85, s60, v85
    s_waitcnt lgkmcnt(7)
    v_mfma_f32_32x32x16_bf16 v[64:79], v[152:155], v[40:43], v[64:79]
    ds_read_b128 v[40:43], v14 offset:16384
    v_exp_f32 v7, v86 clamp
    v_max_f32 v86, s60, v86
    v_fma_f32 v84, v84, s61, v3
    s_waitcnt lgkmcnt(7)
    v_mfma_f32_32x32x16_bf16 v[64:79], v[156:159], v[44:47], v[64:79]
    ds_read_b128 v[44:47], v15 offset:16384
    v_exp_f32 v3, v87 clamp
    v_max_f32 v87, s60, v87
    v_fma_f32 v85, v85, s61, v6
    s_waitcnt lgkmcnt(7)
    v_mfma_f32_32x32x16_bf16 v[64:79], v[160:163], v[16:19], v[64:79]
    ds_read_b128 v[16:19], v8 offset:24576
    v_fma_f32 v86, v86, s61, v7
    v_fma_f32 v87, v87, s61, v3
    v_cvt_pk_bf16_f32 v82, v84, v85
    v_cvt_pk_bf16_f32 v83, v86, v87
    s_waitcnt lgkmcnt(7)
    v_mfma_f32_32x32x16_bf16 v[64:79], v[164:167], v[20:23], v[64:79]
    ds_read_b128 v[20:23], v9 offset:24576
    v_fma_f32 v88, v4, v56, v88
    v_fma_f32 v89, v4, v57, v89
    v_fma_f32 v90, v4, v58, v90
    v_fma_f32 v91, v4, v59, v91
    s_waitcnt lgkmcnt(7)
    v_mfma_f32_32x32x16_bf16 v[64:79], v[168:171], v[24:27], v[64:79]
    ds_read_b128 v[24:27], v10 offset:24576
    v_fma_f32 v88, v5, v88, s60
    v_fma_f32 v89, v5, v89, s60
    v_fma_f32 v90, v5, v90, s60
    v_fma_f32 v91, v5, v91, s60
    s_waitcnt lgkmcnt(7)
    v_mfma_f32_32x32x16_bf16 v[64:79], v[172:175], v[28:31], v[64:79]
    ds_read_b128 v[28:31], v11 offset:24576
    v_exp_f32 v3, v88 clamp
    v_max_f32 v88, s60, v88
    s_waitcnt lgkmcnt(7)
    v_mfma_f32_32x32x16_bf16 v[64:79], v[176:179], v[32:35], v[64:79]
    ds_read_b128 v[32:35], v12 offset:24576
    v_exp_f32 v6, v89 clamp
    v_max_f32 v89, s60, v89
    s_waitcnt lgkmcnt(7)
    v_mfma_f32_32x32x16_bf16 v[64:79], v[180:183], v[36:39], v[64:79]
    ds_read_b128 v[36:39], v13 offset:24576
    v_exp_f32 v7, v90 clamp
    v_max_f32 v90, s60, v90
    v_fma_f32 v88, v88, s61, v3
    s_waitcnt lgkmcnt(7)
    v_mfma_f32_32x32x16_bf16 v[64:79], v[184:187], v[40:43], v[64:79]
    ds_read_b128 v[40:43], v14 offset:24576
    v_exp_f32 v3, v91 clamp
    v_max_f32 v91, s60, v91
    v_fma_f32 v89, v89, s61, v6
    s_waitcnt lgkmcnt(7)
    v_mfma_f32_32x32x16_bf16 v[64:79], v[188:191], v[44:47], v[64:79]
    ds_read_b128 v[44:47], v15 offset:24576
    v_fma_f32 v90, v90, s61, v7
    v_fma_f32 v91, v91, s61, v3
    v_cvt_pk_bf16_f32 v88, v88, v89
    v_cvt_pk_bf16_f32 v89, v90, v91
    s_waitcnt lgkmcnt(7)
    v_mfma_f32_32x32x16_bf16 v[64:79], v[192:195], v[16:19], v[64:79]
    ds_read_b128 v[16:19], v8 offset:32768
    buffer_store_dwordx4 v[80:83], v1, s[32:35], s57 offen sc1
    v_fma_f32 v92, v4, v60, v92
    v_fma_f32 v93, v4, v61, v93
    v_fma_f32 v94, v4, v62, v94
    s_waitcnt lgkmcnt(7)
    v_mfma_f32_32x32x16_bf16 v[64:79], v[196:199], v[20:23], v[64:79]
    ds_read_b128 v[20:23], v9 offset:32768
    v_add_u32 v8, s68, v8
    v_fma_f32 v95, v4, v63, v95
    v_fma_f32 v92, v5, v92, s60
    v_fma_f32 v93, v5, v93, s60
    s_waitcnt lgkmcnt(7)
    v_mfma_f32_32x32x16_bf16 v[64:79], v[200:203], v[24:27], v[64:79]
    ds_read_b128 v[24:27], v10 offset:32768
    v_add_u32 v9, s68, v9
    v_fma_f32 v94, v5, v94, s60
    v_fma_f32 v95, v5, v95, s60
    s_waitcnt lgkmcnt(7)
    v_mfma_f32_32x32x16_bf16 v[64:79], v[204:207], v[28:31], v[64:79]
    ds_read_b128 v[28:31], v11 offset:32768
    v_add_u32 v10, s68, v10
    v_exp_f32 v3, v92 clamp
    v_max_f32 v92, s60, v92
    s_waitcnt lgkmcnt(7)
    v_mfma_f32_32x32x16_bf16 v[64:79], v[208:211], v[32:35], v[64:79]
    ds_read_b128 v[32:35], v12 offset:32768
    v_add_u32 v11, s68, v11
    v_exp_f32 v6, v93 clamp
    v_max_f32 v93, s60, v93
    s_waitcnt lgkmcnt(7)
    v_mfma_f32_32x32x16_bf16 v[64:79], v[212:215], v[36:39], v[64:79]
    ds_read_b128 v[36:39], v13 offset:32768
    v_add_u32 v12, s68, v12
    v_exp_f32 v7, v94 clamp
    v_max_f32 v94, s60, v94
    s_waitcnt lgkmcnt(7)
    v_mfma_f32_32x32x16_bf16 v[64:79], v[216:219], v[40:43], v[64:79]
    ds_read_b128 v[40:43], v14 offset:32768
    v_add_u32 v13, s68, v13
    v_fma_f32 v92, v92, s61, v3
    v_exp_f32 v3, v95 clamp
    s_waitcnt lgkmcnt(7)
    v_mfma_f32_32x32x16_bf16 v[64:79], v[220:223], v[44:47], v[64:79]
    ds_read_b128 v[44:47], v15 offset:32768
    v_add_u32 v14, s68, v14
    v_max_f32 v95, s60, v95
    v_fma_f32 v93, v93, s61, v6
    v_fma_f32 v94, v94, s61, v7
    s_waitcnt lgkmcnt(7)
    v_mfma_f32_32x32x16_bf16 v[64:79], v[224:227], v[16:19], v[64:79]
    v_add_u32 v15, s68, v15
    v_fma_f32 v95, v95, s61, v3
    v_cvt_pk_bf16_f32 v90, v92, v93
    v_cvt_pk_bf16_f32 v91, v94, v95
    s_add_u32 s57, s57, 4096
    s_waitcnt lgkmcnt(6)
    v_mfma_f32_32x32x16_bf16 v[64:79], v[228:231], v[20:23], v[64:79]
    buffer_store_dwordx4 v[88:91], v1, s[32:35], s57 offen sc1
    s_add_u32 s47, s47, 1
    s_cmp_ge_u32 s47, s46
    s_cselect_b32 s47, 0, s47
    s_waitcnt lgkmcnt(5)
    v_mfma_f32_32x32x16_bf16 v[64:79], v[232:235], v[24:27], v[64:79]
    s_waitcnt vmcnt(2)
    s_waitcnt lgkmcnt(0)
    s_barrier
    ds_read_b128 v[16:19], v8 offset:0
    ds_read_b128 v[20:23], v9 offset:0
    ds_read_b128 v[24:27], v10 offset:0
    v_mfma_f32_32x32x16_bf16 v[64:79], v[236:239], v[28:31], v[64:79]
    ds_read_b128 v[28:31], v11 offset:0
    v_mfma_f32_32x32x16_bf16 v[64:79], v[240:243], v[32:35], v[64:79]
    ds_read_b128 v[32:35], v12 offset:0
    v_mfma_f32_32x32x16_bf16 v[64:79], v[244:247], v[36:39], v[64:79]
    ds_read_b128 v[36:39], v13 offset:0
    v_mfma_f32_32x32x16_bf16 v[64:79], v[248:251], v[40:43], v[64:79]
    ds_read_b128 v[40:43], v14 offset:0
    v_mfma_f32_32x32x16_bf16 v[64:79], v[252:255], v[44:47], v[64:79]
    ds_read_b128 v[44:47], v15 offset:0
    s_cmp_ge_u32 s65, s46
    s_cbranch_scc1 k1_kernel_cq_fin0
    s_waitcnt lgkmcnt(7)
    v_mfma_f32_32x32x16_bf16 v[80:95], v[96:99], v[16:19], 0
    ds_read_b128 v[16:19], v8 offset:8192
    s_lshl_b32 s58, s47, 9
    v_add_u32 v3, s58, v2
    ds_read_b64 v[4:5], v3
    s_mul_i32 s57, s47, 151552
    s_add_u32 s57, s57, s62
    s_waitcnt lgkmcnt(8)
    v_mfma_f32_32x32x16_bf16 v[80:95], v[100:103], v[20:23], v[80:95]
    s_add_u32 s65, s65, 1
    s_add_u32 s51, s51, 1
    s_cmp_eq_u32 s51, 3
    s_cselect_b32 s51, 0, s51
    s_cselect_b32 s68, 0xfffec000, s100
    ds_read_b128 v[20:23], v9 offset:8192
    s_waitcnt lgkmcnt(8)
    v_mfma_f32_32x32x16_bf16 v[80:95], v[104:107], v[24:27], v[80:95]
    ds_read_b128 v[24:27], v10 offset:8192
    s_waitcnt lgkmcnt(8)
    v_mfma_f32_32x32x16_bf16 v[80:95], v[108:111], v[28:31], v[80:95]
    ds_read_b128 v[28:31], v11 offset:8192
    s_waitcnt lgkmcnt(3)
    v_fma_f32 v64, v4, v48, v64
    v_fma_f32 v65, v4, v49, v65
    v_fma_f32 v66, v4, v50, v66
    v_fma_f32 v67, v4, v51, v67
    v_mfma_f32_32x32x16_bf16 v[80:95], v[112:115], v[32:35], v[80:95]
    ds_read_b128 v[32:35], v12 offset:8192
    v_fma_f32 v64, v5, v64, s60
    v_fma_f32 v65, v5, v65, s60
    v_fma_f32 v66, v5, v66, s60
    v_fma_f32 v67, v5, v67, s60
    v_mfma_f32_32x32x16_bf16 v[80:95], v[116:119], v[36:39], v[80:95]
    ds_read_b128 v[36:39], v13 offset:8192
    v_exp_f32 v3, v64 clamp
    v_max_f32 v64, s60, v64
    v_mfma_f32_32x32x16_bf16 v[80:95], v[120:123], v[40:43], v[80:95]
    ds_read_b128 v[40:43], v14 offset:8192
    v_exp_f32 v6, v65 clamp
    v_max_f32 v65, s60, v65
    v_mfma_f32_32x32x16_bf16 v[80:95], v[124:127], v[44:47], v[80:95]
    ds_read_b128 v[44:47], v15 offset:8192
    v_exp_f32 v7, v66 clamp
    v_max_f32 v66, s60, v66
    v_fma_f32 v64, v64, s61, v3
    v_mfma_f32_32x32x16_bf16 v[80:95], v[128:131], v[16:19], v[80:95]
    ds_read_b128 v[16:19], v8 offset:16384
    v_exp_f32 v3, v67 clamp
    v_max_f32 v67, s60, v67
    v_fma_f32 v65, v65, s61, v6
    s_waitcnt lgkmcnt(7)
    v_mfma_f32_32x32x16_bf16 v[80:95], v[132:135], v[20:23], v[80:95]
    ds_read_b128 v[20:23], v9 offset:16384
    v_fma_f32 v66, v66, s61, v7
    v_fma_f32 v67, v67, s61, v3
    v_cvt_pk_bf16_f32 v64, v64, v65
    v_cvt_pk_bf16_f32 v65, v66, v67
    s_waitcnt lgkmcnt(7)
    v_mfma_f32_32x32x16_bf16 v[80:95], v[136:139], v[24:27], v[80:95]
    ds_read_b128 v[24:27], v10 offset:16384
    v_fma_f32 v68, v4, v52, v68
    v_fma_f32 v69, v4, v53, v69
    v_fma_f32 v70, v4, v54, v70
    v_fma_f32 v71, v4, v55, v71
    s_waitcnt lgkmcnt(7)
    v_mfma_f32_32x32x16_bf16 v[80:95], v[140:143], v[28:31], v[80:95]
    ds_read_b128 v[28:31], v11 offset:16384
    v_fma_f32 v68, v5, v68, s60
    v_fma_f32 v69, v5, v69, s60
    v_fma_f32 v70, v5, v70, s60
    v_fma_f32 v71, v5, v71, s60
    s_waitcnt lgkmcnt(7)
    v_mfma_f32_32x32x16_bf16 v[80:95], v[144:147], v[32:35], v[80:95]
    ds_read_b128 v[32:35], v12 offset:16384
    v_exp_f32 v3, v68 clamp
    v_max_f32 v68, s60, v68
    s_waitcnt lgkmcnt(7)
    v_mfma_f32_32x32x16_bf16 v[80:95], v[148:151], v[36:39], v[80:95]
    ds_read_b128 v[36:39], v13 offset:16384
    v_exp_f32 v6, v69 clamp
    v_max_f32 v69, s60, v69
    s_waitcnt lgkmcnt(7)
    v_mfma_f32_32x32x16_bf16 v[80:95], v[152:155], v[40:43], v[80:95]
    ds_read_b128 v[40:43], v14 offset:16384
    v_exp_f32 v7, v70 clamp
    v_max_f32 v70, s60, v70
    v_fma_f32 v68, v68, s61, v3
    s_waitcnt lgkmcnt(7)
    v_mfma_f32_32x32x16_bf16 v[80:95], v[156:159], v[44:47], v[80:95]
    ds_read_b128 v[44:47], v15 offset:16384
    v_exp_f32 v3, v71 clamp
    v_max_f32 v71, s60, v71
    v_fma_f32 v69, v69, s61, v6
    s_waitcnt lgkmcnt(7)
    v_mfma_f32_32x32x16_bf16 v[80:95], v[160:163], v[16:19], v[80:95]
    ds_read_b128 v[16:19], v8 offset:24576
    v_fma_f32 v70, v70, s61, v7
    v_fma_f32 v71, v71, s61, v3
    v_cvt_pk_bf16_f32 v66, v68, v69
    v_cvt_pk_bf16_f32 v67, v70, v71
    s_waitcnt lgkmcnt(7)
    v_mfma_f32_32x32x16_bf16 v[80:95], v[164:167], v[20:23], v[80:95]
    ds_read_b128 v[20:23], v9 offset:24576
    v_fma_f32 v72, v4, v56, v72
    v_fma_f32 v73, v4, v57, v73
    v_fma_f32 v74, v4, v58, v74
    v_fma_f32 v75, v4, v59, v75
    s_waitcnt lgkmcnt(7)
    v_mfma_f32_32x32x16_bf16 v[80:95], v[168:171], v[24:27], v[80:95]
    ds_read_b128 v[24:27], v10 offset:24576
    v_fma_f32 v72, v5, v72, s60
    v_fma_f32 v73, v5, v73, s60
    v_fma_f32 v74, v5, v74, s60
    v_fma_f32 v75, v5, v75, s60
    s_waitcnt lgkmcnt(7)
    v_mfma_f32_32x32x16_bf16 v[80:95], v[172:175], v[28:31], v[80:95]
    ds_read_b128 v[28:31], v11 offset:24576
    v_exp_f32 v3, v72 clamp
    v_max_f32 v72, s60, v72
    s_waitcnt lgkmcnt(7)
    v_mfma_f32_32x32x16_bf16 v[80:95], v[176:179], v[32:35], v[80:95]
    ds_read_b128 v[32:35], v12 offset:24576
    v_exp_f32 v6, v73 clamp
    v_max_f32 v73, s60, v73
    s_waitcnt lgkmcnt(7)
    v_mfma_f32_32x32x16_bf16 v[80:95], v[180:183], v[36:39], v[80:95]
    ds_read_b128 v[36:39], v13 offset:24576
    v_exp_f32 v7, v74 clamp
    v_max_f32 v74, s60, v74
    v_fma_f32 v72, v72, s61, v3
    s_waitcnt lgkmcnt(7)
    v_mfma_f32_32x32x16_bf16 v[80:95], v[184:187], v[40:43], v[80:95]
    ds_read_b128 v[40:43], v14 offset:24576
    v_exp_f32 v3, v75 clamp
    v_max_f32 v75, s60, v75
    v_fma_f32 v73, v73, s61, v6
    s_waitcnt lgkmcnt(7)
    v_mfma_f32_32x32x16_bf16 v[80:95], v[188:191], v[44:47], v[80:95]
    ds_read_b128 v[44:47], v15 offset:24576
    v_fma_f32 v74, v74, s61, v7
    v_fma_f32 v75, v75, s61, v3
    v_cvt_pk_bf16_f32 v72, v72, v73
    v_cvt_pk_bf16_f32 v73, v74, v75
    s_waitcnt lgkmcnt(7)
    v_mfma_f32_32x32x16_bf16 v[80:95], v[192:195], v[16:19], v[80:95]
    ds_read_b128 v[16:19], v8 offset:32768
    buffer_store_dwordx4 v[64:67], v1, s[32:35], s57 offen sc1
    v_fma_f32 v76, v4, v60, v76
    v_fma_f32 v77, v4, v61, v77
    v_fma_f32 v78, v4, v62, v78
    s_waitcnt lgkmcnt(7)
    v_mfma_f32_32x32x16_bf16 v[80:95], v[196:199], v[20:23], v[80:95]
    ds_read_b128 v[20:23], v9 offset:32768
    v_add_u32 v8, s68, v8
    v_fma_f32 v79, v4, v63, v79
    v_fma_f32 v76, v5, v76, s60
    v_fma_f32 v77, v5, v77, s60
    s_waitcnt lgkmcnt(7)
    v_mfma_f32_32x32x16_bf16 v[80:95], v[200:203], v[24:27], v[80:95]
    ds_read_b128 v[24:27], v10 offset:32768
    v_add_u32 v9, s68, v9
    v_fma_f32 v78, v5, v78, s60
    v_fma_f32 v79, v5, v79, s60
    s_waitcnt lgkmcnt(7)
    v_mfma_f32_32x32x16_bf16 v[80:95], v[204:207], v[28:31], v[80:95]
    ds_read_b128 v[28:31], v11 offset:32768
    v_add_u32 v10, s68, v10
    v_exp_f32 v3, v76 clamp
    v_max_f32 v76, s60, v76
    s_waitcnt lgkmcnt(7)
    v_mfma_f32_32x32x16_bf16 v[80:95], v[208:211], v[32:35], v[80:95]
    ds_read_b128 v[32:35], v12 offset:32768
    v_add_u32 v11, s68, v11
    v_exp_f32 v6, v77 clamp
    v_max_f32 v77, s60, v77
    s_waitcnt lgkmcnt(7)
    v_mfma_f32_32x32x16_bf16 v[80:95], v[212:215], v[36:39], v[80:95]
    ds_read_b128 v[36:39], v13 offset:32768
    v_add_u32 v12, s68, v12
    v_exp_f32 v7, v78 clamp
    v_max_f32 v78, s60, v78
    s_waitcnt lgkmcnt(7)
    v_mfma_f32_32x32x16_bf16 v[80:95], v[216:219], v[40:43], v[80:95]
    ds_read_b128 v[40:43], v14 offset:32768
    v_add_u32 v13, s68, v13
    v_fma_f32 v76, v76, s61, v3
    v_exp_f32 v3, v79 clamp
    s_waitcnt lgkmcnt(7)
    v_mfma_f32_32x32x16_bf16 v[80:95], v[220:223], v[44:47], v[80:95]
    ds_read_b128 v[44:47], v15 offset:32768
    v_add_u32 v14, s68, v14
    v_max_f32 v79, s60, v79
    v_fma_f32 v77, v77, s61, v6
    v_fma_f32 v78, v78, s61, v7
    s_waitcnt lgkmcnt(7)
    v_mfma_f32_32x32x16_bf16 v[80:95], v[224:227], v[16:19], v[80:95]
    v_add_u32 v15, s68, v15
    v_fma_f32 v79, v79, s61, v3
    v_cvt_pk_bf16_f32 v74, v76, v77
    v_cvt_pk_bf16_f32 v75, v78, v79
    s_add_u32 s57, s57, 4096
    s_waitcnt lgkmcnt(6)
    v_mfma_f32_32x32x16_bf16 v[80:95], v[228:231], v[20:23], v[80:95]
    buffer_store_dwordx4 v[72:75], v1, s[32:35], s57 offen sc1
    s_add_u32 s47, s47, 1
    s_cmp_ge_u32 s47, s46
    s_cselect_b32 s47, 0, s47
    s_waitcnt lgkmcnt(5)
    v_mfma_f32_32x32x16_bf16 v[80:95], v[232:235], v[24:27], v[80:95]
    s_waitcnt vmcnt(2)
    s_waitcnt lgkmcnt(0)
    s_barrier
    ds_read_b128 v[16:19], v8 offset:0
    ds_read_b128 v[20:23], v9 offset:0
    ds_read_b128 v[24:27], v10 offset:0
    v_mfma_f32_32x32x16_bf16 v[80:95], v[236:239], v[28:31], v[80:95]
    ds_read_b128 v[28:31], v11 offset:0
    v_mfma_f32_32x32x16_bf16 v[80:95], v[240:243], v[32:35], v[80:95]
    ds_read_b128 v[32:35], v12 offset:0
    v_mfma_f32_32x32x16_bf16 v[80:95], v[244:247], v[36:39], v[80:95]
    ds_read_b128 v[36:39], v13 offset:0
    v_mfma_f32_32x32x16_bf16 v[80:95], v[248:251], v[40:43], v[80:95]
    ds_read_b128 v[40:43], v14 offset:0
    v_mfma_f32_32x32x16_bf16 v[80:95], v[252:255], v[44:47], v[80:95]
    ds_read_b128 v[44:47], v15 offset:0
    s_cmp_lt_u32 s65, s46
    s_cbranch_scc1 k1_kernel_cq_loop
    s_nop 7
    s_waitcnt lgkmcnt(0)
    s_lshl_b32 s58, s47, 9
    v_add_u32 v3, s58, v2
    ds_read_b64 v[4:5], v3
    s_mul_i32 s57, s47, 151552
    s_add_u32 s57, s57, s62
    s_waitcnt lgkmcnt(0)
    v_fma_f32 v80, v4, v48, v80
    v_fma_f32 v81, v4, v49, v81
    v_fma_f32 v82, v4, v50, v82
    v_fma_f32 v83, v4, v51, v83
    v_fma_f32 v80, v5, v80, s60
    v_fma_f32 v81, v5, v81, s60
    v_fma_f32 v82, v5, v82, s60
    v_fma_f32 v83, v5, v83, s60
    v_exp_f32 v3, v80 clamp
    v_max_f32 v80, s60, v80
    v_exp_f32 v6, v81 clamp
    v_max_f32 v81, s60, v81
    v_exp_f32 v7, v82 clamp
    v_max_f32 v82, s60, v82
    v_fma_f32 v80, v80, s61, v3
    v_exp_f32 v3, v83 clamp
    v_max_f32 v83, s60, v83
    v_fma_f32 v81, v81, s61, v6
    v_fma_f32 v82, v82, s61, v7
    v_fma_f32 v83, v83, s61, v3
    v_cvt_pk_bf16_f32 v80, v80, v81
    v_cvt_pk_bf16_f32 v81, v82, v83
    v_fma_f32 v84, v4, v52, v84
    v_fma_f32 v85, v4, v53, v85
    v_fma_f32 v86, v4, v54, v86
    v_fma_f32 v87, v4, v55, v87
    v_fma_f32 v84, v5, v84, s60
    v_fma_f32 v85, v5, v85, s60
    v_fma_f32 v86, v5, v86, s60
    v_fma_f32 v87, v5, v87, s60
    v_exp_f32 v3, v84 clamp
    v_max_f32 v84, s60, v84
    v_exp_f32 v6, v85 clamp
    v_max_f32 v85, s60, v85
    v_exp_f32 v7, v86 clamp
    v_max_f32 v86, s60, v86
    v_fma_f32 v84, v84, s61, v3
    v_exp_f32 v3, v87 clamp
    v_max_f32 v87, s60, v87
    v_fma_f32 v85, v85, s61, v6
    v_fma_f32 v86, v86, s61, v7
    v_fma_f32 v87, v87, s61, v3
    v_cvt_pk_bf16_f32 v82, v84, v85
    v_cvt_pk_bf16_f32 v83, v86, v87
    buffer_store_dwordx4 v[80:83], v1, s[32:35], s57 offen sc1
    v_fma_f32 v88, v4, v56, v88
    v_fma_f32 v89, v4, v57, v89
    v_fma_f32 v90, v4, v58, v90
    v_fma_f32 v91, v4, v59, v91
    v_fma_f32 v88, v5, v88, s60
    v_fma_f32 v89, v5, v89, s60
    v_fma_f32 v90, v5, v90, s60
    v_fma_f32 v91, v5, v91, s60
    v_exp_f32 v3, v88 clamp
    v_max_f32 v88, s60, v88
    v_exp_f32 v6, v89 clamp
    v_max_f32 v89, s60, v89
    v_exp_f32 v7, v90 clamp
    v_max_f32 v90, s60, v90
    v_fma_f32 v88, v88, s61, v3
    v_exp_f32 v3, v91 clamp
    v_max_f32 v91, s60, v91
    v_fma_f32 v89, v89, s61, v6
    v_fma_f32 v90, v90, s61, v7
    v_fma_f32 v91, v91, s61, v3
    v_cvt_pk_bf16_f32 v88, v88, v89
    v_cvt_pk_bf16_f32 v89, v90, v91
    v_fma_f32 v92, v4, v60, v92
    v_fma_f32 v93, v4, v61, v93
    v_fma_f32 v94, v4, v62, v94
    v_fma_f32 v95, v4, v63, v95
    v_fma_f32 v92, v5, v92, s60
    v_fma_f32 v93, v5, v93, s60
    v_fma_f32 v94, v5, v94, s60
    v_fma_f32 v95, v5, v95, s60
    v_exp_f32 v3, v92 clamp
    v_max_f32 v92, s60, v92
    v_exp_f32 v6, v93 clamp
    v_max_f32 v93, s60, v93
    v_exp_f32 v7, v94 clamp
    v_max_f32 v94, s60, v94
    v_fma_f32 v92, v92, s61, v3
    v_exp_f32 v3, v95 clamp
    v_max_f32 v95, s60, v95
    v_fma_f32 v93, v93, s61, v6
    v_fma_f32 v94, v94, s61, v7
    v_fma_f32 v95, v95, s61, v3
    v_cvt_pk_bf16_f32 v90, v92, v93
    v_cvt_pk_bf16_f32 v91, v94, v95
    s_add_u32 s57, s57, 4096
    buffer_store_dwordx4 v[88:91], v1, s[32:35], s57 offen sc1
    s_add_u32 s47, s47, 1
    s_cmp_ge_u32 s47, s46
    s_cselect_b32 s47, 0, s47
    s_mov_b32 s37, 0
    s_nop 1
    s_branch k1_kernel_y
k1_kernel_cq_fin0:
    s_nop 7
    s_waitcnt lgkmcnt(0)
    s_lshl_b32 s58, s47, 9
    v_add_u32 v3, s58, v2
    ds_read_b64 v[4:5], v3
    s_mul_i32 s57, s47, 151552
    s_add_u32 s57, s57, s62
    s_waitcnt lgkmcnt(0)
    v_fma_f32 v64, v4, v48, v64
    v_fma_f32 v65, v4, v49, v65
    v_fma_f32 v66, v4, v50, v66
    v_fma_f32 v67, v4, v51, v67
    v_fma_f32 v64, v5, v64, s60
    v_fma_f32 v65, v5, v65, s60
    v_fma_f32 v66, v5, v66, s60
    v_fma_f32 v67, v5, v67, s60
    v_exp_f32 v3, v64 clamp
    v_max_f32 v64, s60, v64
    v_exp_f32 v6, v65 clamp
    v_max_f32 v65, s60, v65
    v_exp_f32 v7, v66 clamp
    v_max_f32 v66, s60, v66
    v_fma_f32 v64, v64, s61, v3
    v_exp_f32 v3, v67 clamp
    v_max_f32 v67, s60, v67
    v_fma_f32 v65, v65, s61, v6
    v_fma_f32 v66, v66, s61, v7
    v_fma_f32 v67, v67, s61, v3
    v_cvt_pk_bf16_f32 v64, v64, v65
    v_cvt_pk_bf16_f32 v65, v66, v67
    v_fma_f32 v68, v4, v52, v68
    v_fma_f32 v69, v4, v53, v69
    v_fma_f32 v70, v4, v54, v70
    v_fma_f32 v71, v4, v55, v71
    v_fma_f32 v68, v5, v68, s60
    v_fma_f32 v69, v5, v69, s60
    v_fma_f32 v70, v5, v70, s60
    v_fma_f32 v71, v5, v71, s60
    v_exp_f32 v3, v68 clamp
    v_max_f32 v68, s60, v68
    v_exp_f32 v6, v69 clamp
    v_max_f32 v69, s60, v69
    v_exp_f32 v7, v70 clamp
    v_max_f32 v70, s60, v70
    v_fma_f32 v68, v68, s61, v3
    v_exp_f32 v3, v71 clamp
    v_max_f32 v71, s60, v71
    v_fma_f32 v69, v69, s61, v6
    v_fma_f32 v70, v70, s61, v7
    v_fma_f32 v71, v71, s61, v3
    v_cvt_pk_bf16_f32 v66, v68, v69
    v_cvt_pk_bf16_f32 v67, v70, v71
    buffer_store_dwordx4 v[64:67], v1, s[32:35], s57 offen sc1
    v_fma_f32 v72, v4, v56, v72
    v_fma_f32 v73, v4, v57, v73
    v_fma_f32 v74, v4, v58, v74
    v_fma_f32 v75, v4, v59, v75
    v_fma_f32 v72, v5, v72, s60
    v_fma_f32 v73, v5, v73, s60
    v_fma_f32 v74, v5, v74, s60
    v_fma_f32 v75, v5, v75, s60
    v_exp_f32 v3, v72 clamp
    v_max_f32 v72, s60, v72
    v_exp_f32 v6, v73 clamp
    v_max_f32 v73, s60, v73
    v_exp_f32 v7, v74 clamp
    v_max_f32 v74, s60, v74
    v_fma_f32 v72, v72, s61, v3
    v_exp_f32 v3, v75 clamp
    v_max_f32 v75, s60, v75
    v_fma_f32 v73, v73, s61, v6
    v_fma_f32 v74, v74, s61, v7
    v_fma_f32 v75, v75, s61, v3
    v_cvt_pk_bf16_f32 v72, v72, v73
    v_cvt_pk_bf16_f32 v73, v74, v75
    v_fma_f32 v76, v4, v60, v76
    v_fma_f32 v77, v4, v61, v77
    v_fma_f32 v78, v4, v62, v78
    v_fma_f32 v79, v4, v63, v79
    v_fma_f32 v76, v5, v76, s60
    v_fma_f32 v77, v5, v77, s60
    v_fma_f32 v78, v5, v78, s60
    v_fma_f32 v79, v5, v79, s60
    v_exp_f32 v3, v76 clamp
    v_max_f32 v76, s60, v76
    v_exp_f32 v6, v77 clamp
    v_max_f32 v77, s60, v77
    v_exp_f32 v7, v78 clamp
    v_max_f32 v78, s60, v78
    v_fma_f32 v76, v76, s61, v3
    v_exp_f32 v3, v79 clamp
    v_max_f32 v79, s60, v79
    v_fma_f32 v77, v77, s61, v6
    v_fma_f32 v78, v78, s61, v7
    v_fma_f32 v79, v79, s61, v3
    v_cvt_pk_bf16_f32 v74, v76, v77
    v_cvt_pk_bf16_f32 v75, v78, v79
    s_add_u32 s57, s57, 4096
    buffer_store_dwordx4 v[72:75], v1, s[32:35], s57 offen sc1
    s_add_u32 s47, s47, 1
    s_cmp_ge_u32 s47, s46
    s_cselect_b32 s47, 0, s47
    s_mov_b32 s37, 0
    s_nop 1
    s_branch k1_kernel_y
k1_kernel_cq_chk:
    s_getreg_b32 s53, hwreg(HW_REG_IB_STS, 0, 4)
    s_cmp_lg_u32 s53, 0
    s_cbranch_scc1 k1_kernel_cq_chkr
    s_waitcnt vmcnt(0)
    s_cmp_lt_u32 s66, 2
    s_cbranch_scc1 k1_kernel_cq_chki
k1_kernel_cq_chkd:
    v_cmp_ne_u32 vcc, 1, v0
    s_nop 1
    s_cbranch_vccnz k1_kernel_cq_chki
    v_mbcnt_lo_u32_b32 v0, -1, 0
    v_mbcnt_hi_u32_b32 v0, -1, v0
    s_lshl_b32 s53, s45, 9
    s_add_u32 s53, s53, 12730368
    v_lshlrev_b32 v0, 4, v0
    s_mov_b32 s66, 0
    s_mov_b32 m0, 122880
    s_nop 0
    buffer_load_dwordx4 v0, s[32:35], s53 offen sc1 lds
    s_add_u32 s53, s53, 1024
    s_mov_b32 m0, 123904
    s_nop 0
    buffer_load_dwordx4 v0, s[32:35], s53 offen sc1 lds
    s_add_u32 s53, s53, 1024
    s_mov_b32 m0, 124928
    s_nop 0
    buffer_load_dwordx4 v0, s[32:35], s53 offen sc1 lds
    s_add_u32 s53, s53, 1024
    s_mov_b32 m0, 125952
    s_nop 0
    buffer_load_dwordx4 v0, s[32:35], s53 offen sc1 lds
    s_add_u32 s53, s53, 1024
    s_mov_b32 m0, 126976
    s_nop 0
    buffer_load_dwordx4 v0, s[32:35], s53 offen sc1 lds
    s_add_u32 s53, s53, 1024
    s_mov_b32 m0, 128000
    s_nop 0
    buffer_load_dwordx4 v0, s[32:35], s53 offen sc1 lds
    s_setpc_b64 s[4:5]
k1_kernel_cq_chki:
    v_mbcnt_lo_u32_b32 v0, -1, 0
    v_mbcnt_hi_u32_b32 v0, -1, v0
    v_lshlrev_b32 v0, 2, v0
    s_mov_b32 s66, 2
    buffer_load_dword v0, v0, s[36:39], 0 offen sc1
k1_kernel_cq_chkr:
    s_setpc_b64 s[4:5]
k1_kernel_cq_tbs:
    s_mov_b32 s54, 20000
    s_cmp_eq_u32 s66, 2
    s_cbranch_scc1 k1_kernel_cq_tbw
k1_kernel_cq_tbi:
    v_mbcnt_lo_u32_b32 v0, -1, 0
    v_mbcnt_hi_u32_b32 v0, -1, v0
    v_lshlrev_b32 v0, 2, v0
    s_mov_b32 s66, 2
    buffer_load_dword v0, v0, s[36:39], 0 offen sc1
k1_kernel_cq_tbw:
    s_sub_u32 s54, s54, 1
    s_waitcnt vmcnt(0)
    v_cmp_ne_u32 vcc, 1, v0
    s_cmp_eq_u32 s54, 0
    s_cbranch_scc1 k1_kernel_cq_tbx
    s_nop 1
    s_cbranch_vccnz k1_kernel_cq_tbi
k1_kernel_cq_tbx:
    v_mbcnt_lo_u32_b32 v0, -1, 0
    v_mbcnt_hi_u32_b32 v0, -1, v0
    s_lshl_b32 s53, s45, 9
    s_add_u32 s53, s53, 12730368
    v_lshlrev_b32 v0, 4, v0
    s_mov_b32 s66, 0
    s_mov_b32 m0, 122880
    s_nop 0
    buffer_load_dwordx4 v0, s[32:35], s53 offen sc1 lds
    s_add_u32 s53, s53, 1024
    s_mov_b32 m0, 123904
    s_nop 0
    buffer_load_dwordx4 v0, s[32:35], s53 offen sc1 lds
    s_add_u32 s53, s53, 1024
    s_mov_b32 m0, 124928
    s_nop 0
    buffer_load_dwordx4 v0, s[32:35], s53 offen sc1 lds
    s_add_u32 s53, s53, 1024
    s_mov_b32 m0, 125952
    s_nop 0
    buffer_load_dwordx4 v0, s[32:35], s53 offen sc1 lds
    s_add_u32 s53, s53, 1024
    s_mov_b32 m0, 126976
    s_nop 0
    buffer_load_dwordx4 v0, s[32:35], s53 offen sc1 lds
    s_add_u32 s53, s53, 1024
    s_mov_b32 m0, 128000
    s_nop 0
    buffer_load_dwordx4 v0, s[32:35], s53 offen sc1 lds
    s_waitcnt vmcnt(0)
    s_branch k1_kernel_cq_tbd
k1_kernel_hn:
    s_sub_u32 s101, s44, 4
    v_lshrrev_b32 v10, 4, v0
    s_lshl_b32 s53, s101, 2
    v_add_u32 v10, s53, v10
    v_xor_b32 v11, v0, v10
    v_and_b32 v11, 15, v11
    v_mul_u32_u24 v1, 1280, v10
    v_lshl_add_u32 v1, v11, 4, v1
    v_add_u32 v2, 20480, v1
    s_bfe_u32 s53, s48, 0x40000
    s_lshl_b32 s60, s53, 8
    s_bfe_u32 s53, s48, 0x40004
    s_lshl_b32 s61, s53, 8
    s_bfe_u32 s53, s48, 0x40008
    s_lshl_b32 s62, s53, 8
    s_bfe_u32 s53, s48, 0x4000c
    s_lshl_b32 s63, s53, 8
    s_bfe_u32 s53, s48, 0x40010
    s_lshl_b32 s64, s53, 8
    s_add_u32 s53, s45, s47
    s_mul_i32 s65, s53, 40960
    s_mov_b32 s99, s65
    s_mul_i32 s100, s45, 40960
    s_lshl_b32 s66, s101, 10
    s_mov_b32 s51, s47
    s_add_u32 s65, s65, 40960
    s_add_u32 s51, s51, 1
    s_cmp_ge_u32 s51, s46
    s_cselect_b32 s51, 0, s51
    s_cselect_b32 s65, s100, s65
    s_lshr_b32 s55, s101, 1
    s_and_b32 s56, s101, 1
    s_lshl_b32 s57, s49, 7
    s_lshl_b32 s58, s49, 8
    s_lshl_b32 s53, s55, 7
    s_add_u32 s58, s58, s53
    s_sub_u32 s58, s58, 6912
    s_cmp_ge_u32 s49, 27
    s_cselect_b32 s57, s58, s57
    s_movk_i32 s58, 3456
    s_cselect_b32 s58, 3840, s58
    v_lshrrev_b32 v10, 3, v0
    v_mul_lo_u32 v3, v10, s58
    v_bfe_u32 v10, v0, 1, 2
    v_bfe_u32 v11, v0, 4, 1
    s_lshl_b32 s53, s55, 1
    v_or_b32 v11, s53, v11
    v_xor_b32 v10, v10, v11
    v_lshl_add_u32 v3, v10, 5, v3
    v_and_b32 v10, 1, v0
    v_lshl_add_u32 v3, v10, 4, v3
    s_lshl_b32 s69, s58, 3
    s_lshl_b32 s98, s101, 12
    s_lshl_b32 s53, s56, 5
    s_mul_i32 s67, s53, s58
    s_add_u32 s67, s67, s57
    s_lshr_b32 s68, s58, 1
    s_waitcnt lgkmcnt(0)
    s_mov_b32 s24, s4
    s_and_b32 s25, s5, 0xffff
    s_mov_b32 s26, 2621440
    s_mov_b32 s27, 0x20000
    s_cmp_eq_u32 s55, 0
    s_cselect_b32 s28, s12, s14
    s_cselect_b32 s29, s13, s15
    s_cmp_ge_u32 s49, 27
    s_cselect_b32 s28, s6, s28
    s_cselect_b32 s29, s7, s29
    s_mul_i32 s30, s58, 640
    s_and_b32 s29, s29, 0xffff
    s_mov_b32 s31, 0x20000
    s_mul_i32 s53, s60, s68
    s_add_u32 s53, s53, s67
    s_add_u32 m0, s98, 102400
    s_nop 0
    buffer_load_dwordx4 v3, s[28:31], s53 offen lds
    s_add_u32 m0, s98, 103424
    s_add_u32 s53, s53, s69
    buffer_load_dwordx4 v3, s[28:31], s53 offen lds
    s_add_u32 m0, s98, 104448
    s_add_u32 s53, s53, s69
    buffer_load_dwordx4 v3, s[28:31], s53 offen lds
    s_add_u32 m0, s98, 105472
    s_add_u32 s53, s53, s69
    buffer_load_dwordx4 v3, s[28:31], s53 offen lds
    s_mul_i32 s53, s60, s68
    s_add_u32 s53, s53, s67
    s_lshl_b32 s54, s69, 3
    s_add_u32 s53, s53, s54
    s_add_u32 m0, s98, 130048
    s_nop 0
    buffer_load_dwordx4 v3, s[28:31], s53 offen lds
    s_add_u32 m0, s98, 131072
    s_add_u32 s53, s53, s69
    buffer_load_dwordx4 v3, s[28:31], s53 offen lds
    s_add_u32 m0, s98, 132096
    s_add_u32 s53, s53, s69
    buffer_load_dwordx4 v3, s[28:31], s53 offen lds
    s_add_u32 m0, s98, 133120
    s_add_u32 s53, s53, s69
    buffer_load_dwordx4 v3, s[28:31], s53 offen lds
    s_mov_b32 s32, s22
    s_and_b32 s33, s23, 0xffff
    s_mov_b32 s34, 12849152
    s_mov_b32 s35, 0x20000
    v_lshlrev_b32 v9, 4, v0
    s_sub_u32 s53, s2, 64
    s_lshl_b32 s53, s53, 2
    s_add_u32 s53, s53, s101
    s_mul_i32 s96, s53, 6554
    s_lshr_b32 s96, s96, 16
    s_mul_i32 s54, s96, 10
    s_sub_u32 s97, s53, s54
    s_cmp_ge_u32 s96, 54
    s_cselect_b32 s40, s8, s16
    s_cselect_b32 s41, s9, s17
    s_mov_b32 s42, 2211840
    s_cselect_b32 s42, 819200, s42
    s_and_b32 s41, s41, 0xffff
    s_mov_b32 s43, 0x20000
    s_add_u32 m0, s66, 40960
    s_add_u32 s53, s65, s60
    buffer_load_dwordx4 v1, s[24:27], s53 offen lds
    s_add_u32 m0, s66, 45056
    s_nop 0
    buffer_load_dwordx4 v2, s[24:27], s53 offen lds
    s_mul_i32 s53, s61, s68
    s_add_u32 s53, s53, s67
    s_add_u32 m0, s98, 65536
    s_nop 0
    buffer_load_dwordx4 v3, s[28:31], s53 offen lds
    s_add_u32 m0, s98, 66560
    s_add_u32 s53, s53, s69
    buffer_load_dwordx4 v3, s[28:31], s53 offen lds
    s_add_u32 m0, s98, 67584
    s_add_u32 s53, s53, s69
    buffer_load_dwordx4 v3, s[28:31], s53 offen lds
    s_add_u32 m0, s98, 68608
    s_add_u32 s53, s53, s69
    buffer_load_dwordx4 v3, s[28:31], s53 offen lds
    v_mov_b32 v10, 0
    v_mov_b32 v11, 0
    v_mov_b32 v12, 0
    v_mov_b32 v13, 0
    v_mov_b32 v14, 162816
    ds_write_b128 v14, v[10:13]
    s_lshr_b32 s14, s2, 5
    s_and_b32 s53, s2, 7
    s_bfe_u32 s54, s2, 0x20003
    s_lshl_b32 s13, s53, 2
    s_add_u32 s13, s13, s54
    s_mul_i32 s8, s13, 303104
    s_mul_i32 s9, s14, 378880
    s_add_u32 s9, s9, 9699328
    s_lshr_b32 s53, s13, 4
    s_mul_i32 s11, s53, 6144
    s_and_b32 s53, s13, 15
    s_lshl_b32 s53, s53, 1
    s_add_u32 s54, s53, 1
    s_cmp_ge_u32 s53, 22
    s_cselect_b32 s55, 2048, 0
    s_cselect_b32 s56, 11, 0
    s_add_u32 s11, s11, s55
    s_sub_u32 s54, s54, s56
    s_cmp_ge_u32 s53, 10
    s_cselect_b32 s55, 2048, 0
    s_cselect_b32 s56, 11, 0
    s_add_u32 s12, s11, s55
    s_sub_u32 s54, s54, s56
    s_cmp_eq_u32 s53, 10
    s_cselect_b32 s11, s11, s12
    s_mul_i32 s55, s54, 11
    s_lshr_b32 s55, s55, 5
    s_mul_i32 s54, s54, 3
    s_sub_u32 s54, s54, s55
    s_add_u32 s54, s54, 11
    s_sub_u32 s55, s54, 27
    s_cmp_ge_u32 s54, 27
    s_cselect_b32 s54, s55, s54
    s_lshl_b32 s10, s54, 1
    s_and_b32 s53, s2, 1
    s_mul_i32 s53, s53, 3
    s_lshr_b32 s54, s2, 6
    s_add_u32 s53, s53, s54
    s_sub_u32 s53, s53, 1
    s_lshl_b32 s53, s53, 5
    s_add_u32 s53, s53, s49
    s_lshl_b32 s15, s53, 6
    s_add_u32 s15, s15, 12821504
    s_mov_b32 s53, 40960
    s_mov_b32 s54, 81920
    s_cmp_eq_u32 s46, 10
    s_cselect_b32 s16, s53, s54
    s_cselect_b32 s17, s54, 0
    s_cselect_b32 s7, 0, s53
    s_mov_b32 s50, 0
    s_setprio 3
    s_waitcnt lgkmcnt(0)
    s_waitcnt vmcnt(10)
    s_barrier
    s_mul_i32 s53, s61, s68
    s_add_u32 s53, s53, s67
    s_lshl_b32 s54, s69, 3
    s_add_u32 s53, s53, s54
    s_add_u32 m0, s98, 81920
    s_nop 0
    buffer_load_dwordx4 v3, s[28:31], s53 offen lds
    s_add_u32 m0, s98, 82944
    s_add_u32 s53, s53, s69
    buffer_load_dwordx4 v3, s[28:31], s53 offen lds
    s_add_u32 m0, s98, 83968
    s_add_u32 s53, s53, s69
    buffer_load_dwordx4 v3, s[28:31], s53 offen lds
    s_add_u32 m0, s98, 84992
    s_add_u32 s53, s53, s69
    buffer_load_dwordx4 v3, s[28:31], s53 offen lds
    s_add_u32 m0, s66, 49152
    s_add_u32 s53, s65, s61
    buffer_load_dwordx4 v1, s[24:27], s53 offen lds
    s_add_u32 m0, s66, 53248
    s_nop 0
    buffer_load_dwordx4 v2, s[24:27], s53 offen lds
    s_waitcnt vmcnt(12)
    s_barrier
    s_mul_i32 s53, s62, s68
    s_add_u32 s53, s53, s67
    s_add_u32 m0, s98, 102400
    s_nop 0
    buffer_load_dwordx4 v3, s[28:31], s53 offen lds
    s_add_u32 m0, s98, 103424
    s_add_u32 s53, s53, s69
    buffer_load_dwordx4 v3, s[28:31], s53 offen lds
    s_add_u32 m0, s98, 104448
    s_add_u32 s53, s53, s69
    buffer_load_dwordx4 v3, s[28:31], s53 offen lds
    s_add_u32 m0, s98, 105472
    s_add_u32 s53, s53, s69
    buffer_load_dwordx4 v3, s[28:31], s53 offen lds
    s_waitcnt vmcnt(10)
    s_barrier
    s_mul_i32 s53, s62, s68
    s_add_u32 s53, s53, s67
    s_lshl_b32 s54, s69, 3
    s_add_u32 s53, s53, s54
    s_add_u32 m0, s98, 130048
    s_nop 0
    buffer_load_dwordx4 v3, s[28:31], s53 offen lds
    s_add_u32 m0, s98, 131072
    s_add_u32 s53, s53, s69
    buffer_load_dwordx4 v3, s[28:31], s53 offen lds
    s_add_u32 m0, s98, 132096
    s_add_u32 s53, s53, s69
    buffer_load_dwordx4 v3, s[28:31], s53 offen lds
    s_add_u32 m0, s98, 133120
    s_add_u32 s53, s53, s69
    buffer_load_dwordx4 v3, s[28:31], s53 offen lds
    s_add_u32 m0, s66, 57344
    s_add_u32 s53, s65, s62
    buffer_load_dwordx4 v1, s[24:27], s53 offen lds
    s_add_u32 m0, s66, 61440
    s_nop 0
    buffer_load_dwordx4 v2, s[24:27], s53 offen lds
    s_waitcnt vmcnt(12)
    s_barrier
    s_mul_i32 s53, s63, s68
    s_add_u32 s53, s53, s67
    s_add_u32 m0, s98, 65536
    s_nop 0
    buffer_load_dwordx4 v3, s[28:31], s53 offen lds
    s_add_u32 m0, s98, 66560
    s_add_u32 s53, s53, s69
    buffer_load_dwordx4 v3, s[28:31], s53 offen lds
    s_add_u32 m0, s98, 67584
    s_add_u32 s53, s53, s69
    buffer_load_dwordx4 v3, s[28:31], s53 offen lds
    s_add_u32 m0, s98, 68608
    s_add_u32 s53, s53, s69
    buffer_load_dwordx4 v3, s[28:31], s53 offen lds
    s_waitcnt vmcnt(10)
    s_barrier
    s_mul_i32 s53, s63, s68
    s_add_u32 s53, s53, s67
    s_lshl_b32 s54, s69, 3
    s_add_u32 s53, s53, s54
    s_add_u32 m0, s98, 81920
    s_nop 0
    buffer_load_dwordx4 v3, s[28:31], s53 offen lds
    s_add_u32 m0, s98, 82944
    s_add_u32 s53, s53, s69
    buffer_load_dwordx4 v3, s[28:31], s53 offen lds
    s_add_u32 m0, s98, 83968
    s_add_u32 s53, s53, s69
    buffer_load_dwordx4 v3, s[28:31], s53 offen lds
    s_add_u32 m0, s98, 84992
    s_add_u32 s53, s53, s69
    buffer_load_dwordx4 v3, s[28:31], s53 offen lds
    s_waitcnt vmcnt(10)
    s_barrier
    s_mul_i32 s53, s64, s68
    s_add_u32 s53, s53, s67
    s_add_u32 m0, s98, 102400
    s_nop 0
    buffer_load_dwordx4 v3, s[28:31], s53 offen lds
    s_add_u32 m0, s98, 103424
    s_add_u32 s53, s53, s69
    buffer_load_dwordx4 v3, s[28:31], s53 offen lds
    s_add_u32 m0, s98, 104448
    s_add_u32 s53, s53, s69
    buffer_load_dwordx4 v3, s[28:31], s53 offen lds
    s_add_u32 m0, s98, 105472
    s_add_u32 s53, s53, s69
    buffer_load_dwordx4 v3, s[28:31], s53 offen lds
    s_waitcnt vmcnt(8)
    s_barrier
    s_mul_i32 s53, s64, s68
    s_add_u32 s53, s53, s67
    s_lshl_b32 s54, s69, 3
    s_add_u32 s53, s53, s54
    s_add_u32 m0, s98, 130048
    s_nop 0
    buffer_load_dwordx4 v3, s[28:31], s53 offen lds
    s_add_u32 m0, s98, 131072
    s_add_u32 s53, s53, s69
    buffer_load_dwordx4 v3, s[28:31], s53 offen lds
    s_add_u32 m0, s98, 132096
    s_add_u32 s53, s53, s69
    buffer_load_dwordx4 v3, s[28:31], s53 offen lds
    s_add_u32 m0, s98, 133120
    s_add_u32 s53, s53, s69
    buffer_load_dwordx4 v3, s[28:31], s53 offen lds
    s_waitcnt vmcnt(8)
    s_barrier
    s_add_u32 m0, s66, 65536
    s_add_u32 s53, s65, s63
    buffer_load_dwordx4 v1, s[24:27], s53 offen lds
    s_add_u32 m0, s66, 69632
    s_nop 0
    buffer_load_dwordx4 v2, s[24:27], s53 offen lds
    s_add_u32 m0, s66, 73728
    s_add_u32 s53, s65, s64
    buffer_load_dwordx4 v1, s[24:27], s53 offen lds
    s_add_u32 m0, s66, 77824
    s_nop 0
    buffer_load_dwordx4 v2, s[24:27], s53 offen lds
    s_add_u32 s65, s65, 40960
    s_add_u32 s51, s51, 1
    s_cmp_ge_u32 s51, s46
    s_cselect_b32 s51, 0, s51
    s_cselect_b32 s65, s100, s65
    s_waitcnt vmcnt(8)
    s_barrier
    s_add_u32 m0, s66, 81920
    s_add_u32 s53, s65, s60
    buffer_load_dwordx4 v1, s[24:27], s53 offen lds
    s_add_u32 m0, s66, 86016
    s_nop 0
    buffer_load_dwordx4 v2, s[24:27], s53 offen lds
    s_add_u32 m0, s66, 90112
    s_add_u32 s53, s65, s61
    buffer_load_dwordx4 v1, s[24:27], s53 offen lds
    s_add_u32 m0, s66, 94208
    s_nop 0
    buffer_load_dwordx4 v2, s[24:27], s53 offen lds
    s_add_u32 m0, s66, 98304
    s_add_u32 s53, s65, s62
    buffer_load_dwordx4 v1, s[24:27], s53 offen lds
    s_waitcnt vmcnt(9)
    s_barrier
    s_add_u32 m0, s66, 102400
    s_add_u32 s53, s65, s62
    buffer_load_dwordx4 v2, s[24:27], s53 offen lds
    s_add_u32 m0, s66, 106496
    s_add_u32 s53, s65, s63
    buffer_load_dwordx4 v1, s[24:27], s53 offen lds
    s_add_u32 m0, s66, 110592
    s_nop 0
    buffer_load_dwordx4 v2, s[24:27], s53 offen lds
    s_add_u32 m0, s66, 114688
    s_add_u32 s53, s65, s64
    buffer_load_dwordx4 v1, s[24:27], s53 offen lds
    s_add_u32 m0, s66, 118784
    s_nop 0
    buffer_load_dwordx4 v2, s[24:27], s53 offen lds
    s_add_u32 s65, s65, 40960
    s_add_u32 s51, s51, 1
    s_cmp_ge_u32 s51, s46
    s_cselect_b32 s51, 0, s51
    s_cselect_b32 s65, s100, s65
    s_waitcnt vmcnt(10)
    s_barrier
    s_sub_u32 s53, s96, 54
    s_mul_i32 s54, s53, 205
    s_lshr_b32 s54, s54, 10
    s_mul_i32 s55, s54, 5
    s_sub_u32 s53, s53, s55
    s_lshl_b32 s53, s53, 3
    v_lshrrev_b32 v10, 3, v0
    v_add_u32 v11, s53, v10
    v_mul_u32_u24 v12, 205, v11
    v_lshrrev_b32 v12, 11, v12
    v_mul_u32_u24 v13, 10, v12
    v_sub_u32 v11, v11, v13
    v_mul_u32_u24 v11, 6, v11
    s_mov_b32 s55, 0x540c2040
    s_mov_b32 s56, 0x6045d65
    v_mov_b32 v14, s55
    v_mov_b32 v15, s56
    v_lshrrev_b64 v[14:15], v11, v[14:15]
    v_and_b32 v14, 63, v14
    v_lshl_add_u32 v14, v13, 2, v14
    s_mul_i32 s54, s54, 5
    s_cmp_ge_u32 s96, 54
    s_cselect_b64 vcc, -1, 0
    s_cselect_b32 s53, s54, s96
    s_movk_i32 s55, 10240
    s_cselect_b32 s55, 6400, s55
    v_cndmask_b32 v10, v10, v14, vcc
    v_mul_u32_u24 v10, 1280, v10
    v_and_b32 v11, 7, v0
    v_lshl_add_u32 v10, v11, 4, v10
    s_mul_i32 s53, s53, 40960
    s_lshl_b32 s54, s97, 7
    s_add_u32 s53, s53, s54
    s_lshl_b32 s54, s101, 12
    s_add_u32 m0, s54, 130048
    s_nop 0
    buffer_load_dwordx4 v10, s[40:43], s53 offen lds
    s_add_u32 s53, s53, s55
    s_add_u32 m0, s54, 131072
    s_nop 0
    buffer_load_dwordx4 v10, s[40:43], s53 offen lds
    s_add_u32 s53, s53, s55
    s_add_u32 m0, s54, 132096
    s_nop 0
    buffer_load_dwordx4 v10, s[40:43], s53 offen lds
    s_add_u32 s53, s53, s55
    s_add_u32 m0, s54, 133120
    s_nop 0
    buffer_load_dwordx4 v10, s[40:43], s53 offen lds
    s_add_u32 m0, s66, 0
    s_add_u32 s53, s65, s60
    buffer_load_dwordx4 v1, s[24:27], s53 offen lds
    s_add_u32 m0, s66, 4096
    s_nop 0
    buffer_load_dwordx4 v2, s[24:27], s53 offen lds
    s_add_u32 m0, s66, 8192
    s_add_u32 s53, s65, s61
    buffer_load_dwordx4 v1, s[24:27], s53 offen lds
    s_add_u32 m0, s66, 12288
    s_nop 0
    buffer_load_dwordx4 v2, s[24:27], s53 offen lds
    s_add_u32 m0, s66, 16384
    s_add_u32 s53, s65, s62
    buffer_load_dwordx4 v1, s[24:27], s53 offen lds
    s_add_u32 m0, s66, 20480
    s_nop 0
    buffer_load_dwordx4 v2, s[24:27], s53 offen lds
    s_add_u32 m0, s66, 24576
    s_add_u32 s53, s65, s63
    buffer_load_dwordx4 v1, s[24:27], s53 offen lds
    s_add_u32 m0, s66, 28672
    s_nop 0
    buffer_load_dwordx4 v2, s[24:27], s53 offen lds
    s_add_u32 m0, s66, 32768
    s_add_u32 s53, s65, s64
    buffer_load_dwordx4 v1, s[24:27], s53 offen lds
    s_add_u32 m0, s66, 36864
    s_nop 0
    buffer_load_dwordx4 v2, s[24:27], s53 offen lds
    s_add_u32 s65, s65, 40960
    s_add_u32 s51, s51, 1
    s_cmp_ge_u32 s51, s46
    s_cselect_b32 s51, 0, s51
    s_cselect_b32 s65, s100, s65
    s_mov_b32 s50, 1
    s_mov_b32 s67, 1
    s_add_u32 s98, s66, 40960
    s_mov_b32 s69, 40960
    s_waitcnt vmcnt(14)
    s_nop 3
k1_kernel_hn_loop:
    s_barrier
    s_add_u32 s68, s50, 3
    s_cmp_ge_u32 s68, s46
    s_cbranch_scc1 k1_kernel_hn_tail
    s_add_u32 m0, s98, 0
    s_add_u32 s53, s65, s60
    buffer_load_dwordx4 v1, s[24:27], s53 offen lds
    s_add_u32 m0, s98, 4096
    s_nop 0
    buffer_load_dwordx4 v2, s[24:27], s53 offen lds
    s_add_u32 m0, s98, 8192
    s_add_u32 s53, s65, s61
    buffer_load_dwordx4 v1, s[24:27], s53 offen lds
    s_add_u32 m0, s98, 12288
    s_nop 0
    buffer_load_dwordx4 v2, s[24:27], s53 offen lds
    s_add_u32 m0, s98, 16384
    s_add_u32 s53, s65, s62
    buffer_load_dwordx4 v1, s[24:27], s53 offen lds
    s_add_u32 m0, s98, 20480
    s_nop 0
    buffer_load_dwordx4 v2, s[24:27], s53 offen lds
    s_add_u32 m0, s98, 24576
    s_add_u32 s53, s65, s63
    buffer_load_dwordx4 v1, s[24:27], s53 offen lds
    s_add_u32 m0, s98, 28672
    s_nop 0
    buffer_load_dwordx4 v2, s[24:27], s53 offen lds
    s_add_u32 m0, s98, 32768
    s_add_u32 s53, s65, s64
    buffer_load_dwordx4 v1, s[24:27], s53 offen lds
    s_add_u32 m0, s98, 36864
    s_nop 0
    buffer_load_dwordx4 v2, s[24:27], s53 offen lds
    s_add_u32 s65, s65, 40960
    s_add_u32 s51, s51, 1
    s_cmp_ge_u32 s51, s46
    s_cselect_b32 s51, 0, s51
    s_cselect_b32 s65, s100, s65
    s_add_u32 s98, s98, 40960
    s_cmp_ge_u32 s98, 122880
    s_cselect_b32 s98, s66, s98
    s_waitcnt vmcnt(10)
    s_cmp_eq_u32 s50, 1
    s_cbranch_scc1 k1_kernel_hn_e1
    s_cmp_eq_u32 s50, 2
    s_cbranch_scc1 k1_kernel_hn_e2
    s_cmp_eq_u32 s50, 3
    s_cbranch_scc1 k1_kernel_hn_e3
    s_cmp_eq_u32 s50, 4
    s_cbranch_scc1 k1_kernel_hn_e4
    s_cmp_eq_u32 s50, 5
    s_cbranch_scc1 k1_kernel_hn_e5
    s_cmp_eq_u32 s50, 6
    s_cbranch_scc1 k1_kernel_hn_e6
k1_kernel_hn_nx:
    s_add_u32 s50, s50, 1
    s_nop 3
    s_branch k1_kernel_hn_loop
k1_kernel_hn_e1:
    s_cmp_ge_u32 s96, 74
    s_cbranch_scc1 k1_kernel_hn_nx
    v_lshrrev_b32 v10, 4, v0
    v_lshlrev_b32 v10, 10, v10
    v_bfe_u32 v11, v0, 2, 2
    v_lshl_add_u32 v10, v11, 7, v10
    v_and_b32 v11, 3, v0
    v_lshl_add_u32 v10, v11, 3, v10
    s_lshl_b32 s53, s101, 12
    s_add_u32 s53, s53, 130048
    v_add_u32 v10, s53, v10
    ds_read_b64_tr_b16 v[24:25], v10 offset:0
    ds_read_b64_tr_b16 v[26:27], v10 offset:512
    ds_read_b64_tr_b16 v[28:29], v10 offset:32
    ds_read_b64_tr_b16 v[30:31], v10 offset:544
    ds_read_b64_tr_b16 v[32:33], v10 offset:64
    ds_read_b64_tr_b16 v[34:35], v10 offset:576
    ds_read_b64_tr_b16 v[36:37], v10 offset:96
    ds_read_b64_tr_b16 v[38:39], v10 offset:608
    s_lshl_b32 s53, s97, 2
    s_add_u32 s53, s53, 0
    s_mul_i32 s54, s53, 205
    s_lshr_b32 s54, s54, 10
    s_mul_i32 s54, s54, 365
    s_add_u32 s53, s53, s54
    s_mul_i32 s54, s96, 5
    s_add_u32 s53, s53, s54
    s_lshl_b32 s53, s53, 10
    s_add_u32 s53, s53, 9699328
    s_waitcnt lgkmcnt(6)
    buffer_store_dwordx4 v[24:27], v9, s[32:35], s53 offen sc1
    s_lshl_b32 s53, s97, 2
    s_add_u32 s53, s53, 1
    s_mul_i32 s54, s53, 205
    s_lshr_b32 s54, s54, 10
    s_mul_i32 s54, s54, 365
    s_add_u32 s53, s53, s54
    s_mul_i32 s54, s96, 5
    s_add_u32 s53, s53, s54
    s_lshl_b32 s53, s53, 10
    s_add_u32 s53, s53, 9699328
    s_waitcnt lgkmcnt(4)
    buffer_store_dwordx4 v[28:31], v9, s[32:35], s53 offen sc1
    s_lshl_b32 s53, s97, 2
    s_add_u32 s53, s53, 2
    s_mul_i32 s54, s53, 205
    s_lshr_b32 s54, s54, 10
    s_mul_i32 s54, s54, 365
    s_add_u32 s53, s53, s54
    s_mul_i32 s54, s96, 5
    s_add_u32 s53, s53, s54
    s_lshl_b32 s53, s53, 10
    s_add_u32 s53, s53, 9699328
    s_waitcnt lgkmcnt(2)
    buffer_store_dwordx4 v[32:35], v9, s[32:35], s53 offen sc1
    s_lshl_b32 s53, s97, 2
    s_add_u32 s53, s53, 3
    s_mul_i32 s54, s53, 205
    s_lshr_b32 s54, s54, 10
    s_mul_i32 s54, s54, 365
    s_add_u32 s53, s53, s54
    s_mul_i32 s54, s96, 5
    s_add_u32 s53, s53, s54
    s_lshl_b32 s53, s53, 10
    s_add_u32 s53, s53, 9699328
    s_waitcnt lgkmcnt(0)
    buffer_store_dwordx4 v[36:39], v9, s[32:35], s53 offen sc1
    s_branch k1_kernel_hn_nx
k1_kernel_hn_e2:
    s_cmp_lg_u32 s101, 0
    s_cbranch_scc1 k1_kernel_hn_nx
    s_branch k1_kernel_hn_nx
k1_kernel_hn_e3:
    s_cmp_lg_u32 s101, 0
    s_cbranch_scc1 k1_kernel_hn_nx
    v_mov_b32 v10, 1
    s_mov_b64 exec, 1
    buffer_store_dword v10, off, s[32:35], s15 offset:0 sc1
    s_mov_b64 exec, -1
    s_branch k1_kernel_hn_nx
k1_kernel_hn_e4:
    s_cmp_lg_u32 s101, 0
    s_cbranch_scc1 k1_kernel_hn_nx
    s_branch k1_kernel_hn_nx
k1_kernel_hn_e5:
    s_cmp_lg_u32 s101, 0
    s_cbranch_scc1 k1_kernel_hn_nx
    v_lshlrev_b32 v43, 2, v9
    s_mov_b32 s53, 12821504
    buffer_load_dword v40, v43, s[32:35], s53 offen sc1
    s_mov_b32 s53, 12825600
    buffer_load_dword v41, v43, s[32:35], s53 offen sc1
    s_mov_b32 s53, 12829696
    buffer_load_dword v42, v43, s[32:35], s53 offen sc1
    s_branch k1_kernel_hn_nx
k1_kernel_hn_e6:
    s_cmp_lg_u32 s101, 0
    s_cbranch_scc1 k1_kernel_hn_nx
    s_mov_b32 s54, 20000
k1_kernel_hn_w2:
    v_min3_u32 v40, v40, v41, v42
    v_cmp_eq_u32 vcc, 0, v40
    s_sub_u32 s54, s54, 1
    s_cbranch_scc1 k1_kernel_hn_w2x
    s_nop 0
    s_cbranch_vccz k1_kernel_hn_w2x
    s_sleep 4
    v_lshlrev_b32 v43, 2, v9
    s_mov_b32 s53, 12821504
    buffer_load_dword v40, v43, s[32:35], s53 offen sc1
    s_mov_b32 s53, 12825600
    buffer_load_dword v41, v43, s[32:35], s53 offen sc1
    s_mov_b32 s53, 12829696
    buffer_load_dword v42, v43, s[32:35], s53 offen sc1
    s_waitcnt vmcnt(0)
    s_branch k1_kernel_hn_w2
k1_kernel_hn_w2x:
    s_branch k1_kernel_hn_nx
k1_kernel_hn_tail:
    s_and_b32 s53, s101, 1
    s_lshl_b32 s53, s53, 3
    s_lshr_b32 s54, s101, 1
    s_add_u32 s53, s53, s54
    s_add_u32 s53, s53, s10
    s_mul_i32 s55, s101, 9216
    s_add_u32 s55, s55, s98
    s_add_u32 s54, s53, 0xfffffff2
    s_cselect_b32 s56, 0, 54
    s_add_u32 s54, s54, s56
    s_mul_i32 s54, s54, 5120
    s_add_u32 s54, s54, s9
    s_add_u32 m0, s55, 0
    s_nop 0
    buffer_load_dwordx4 v9, s[32:35], s54 offen sc1 lds
    s_add_u32 s54, s54, 1024
    s_add_u32 m0, s55, 1024
    s_nop 0
    buffer_load_dwordx4 v9, s[32:35], s54 offen sc1 lds
    s_add_u32 s54, s54, 1024
    s_add_u32 m0, s55, 2048
    s_nop 0
    buffer_load_dwordx4 v9, s[32:35], s54 offen sc1 lds
    s_add_u32 s54, s54, 1024
    s_add_u32 m0, s55, 3072
    s_nop 0
    buffer_load_dwordx4 v9, s[32:35], s54 offen sc1 lds
    s_add_u32 s54, s54, 1024
    s_add_u32 m0, s55, 4096
    s_nop 0
    buffer_load_dwordx4 v9, s[32:35], s54 offen sc1 lds
    s_add_u32 s54, s53, 0xfffffff6
    s_cselect_b32 s56, 0, 54
    s_add_u32 s54, s54, s56
    s_mul_i32 s54, s54, 5120
    s_add_u32 s54, s54, s9
    s_add_u32 m0, s55, 5120
    s_nop 0
    buffer_load_dwordx4 v9, s[32:35], s54 offen sc1 lds
    s_add_u32 s54, s54, 1024
    s_add_u32 m0, s55, 6144
    s_nop 0
    buffer_load_dwordx4 v9, s[32:35], s54 offen sc1 lds
    s_add_u32 s54, s54, 1024
    s_add_u32 m0, s55, 7168
    s_nop 0
    buffer_load_dwordx4 v9, s[32:35], s54 offen sc1 lds
    s_add_u32 s54, s54, 1024
    s_add_u32 m0, s55, 8192
    s_nop 0
    buffer_load_dwordx4 v9, s[32:35], s54 offen sc1 lds
    s_add_u32 s54, s54, 1024
    s_add_u32 m0, s55, 9216
    s_nop 0
    buffer_load_dwordx4 v9, s[32:35], s54 offen sc1 lds
    s_add_u32 s98, s98, 40960
    s_cmp_ge_u32 s98, 122880
    s_cselect_b32 s98, s66, s98
    s_mul_i32 s53, s101, 25600
    s_add_u32 s53, s53, s9
    s_add_u32 s53, s53, 276480
    s_add_u32 s54, s53, 4096
    buffer_load_dwordx4 v[180:183], v9, s[32:35], s53 offen offset:0 sc1
    buffer_load_dwordx4 v[184:187], v9, s[32:35], s53 offen offset:1024 sc1
    buffer_load_dwordx4 v[188:191], v9, s[32:35], s53 offen offset:2048 sc1
    buffer_load_dwordx4 v[192:195], v9, s[32:35], s53 offen offset:3072 sc1
    buffer_load_dwordx4 v[196:199], v9, s[32:35], s54 offen offset:0 sc1
    s_waitcnt vmcnt(15)
    s_barrier
    s_cmp_lg_u32 s101, 0
    s_cbranch_scc1 k1_kernel_hn_ne
    v_mov_b32 v10, 2
    s_mov_b64 exec, 1
    buffer_store_dword v10, off, s[32:35], s15 offset:0 sc1
    s_mov_b64 exec, -1
k1_kernel_hn_ne:
    s_and_b32 s53, s101, 1
    s_lshl_b32 s53, s53, 3
    s_lshr_b32 s54, s101, 1
    s_add_u32 s53, s53, s54
    s_add_u32 s53, s53, s10
    s_mul_i32 s55, s101, 9216
    s_add_u32 s55, s55, s98
    s_add_u32 s54, s53, 0xfffffff4
    s_cselect_b32 s56, 0, 54
    s_add_u32 s54, s54, s56
    s_mul_i32 s54, s54, 5120
    s_add_u32 s54, s54, s9
    s_add_u32 m0, s55, 0
    s_nop 0
    buffer_load_dwordx4 v9, s[32:35], s54 offen sc1 lds
    s_add_u32 s54, s54, 1024
    s_add_u32 m0, s55, 1024
    s_nop 0
    buffer_load_dwordx4 v9, s[32:35], s54 offen sc1 lds
    s_add_u32 s54, s54, 1024
    s_add_u32 m0, s55, 2048
    s_nop 0
    buffer_load_dwordx4 v9, s[32:35], s54 offen sc1 lds
    s_add_u32 s54, s54, 1024
    s_add_u32 m0, s55, 3072
    s_nop 0
    buffer_load_dwordx4 v9, s[32:35], s54 offen sc1 lds
    s_add_u32 s54, s54, 1024
    s_add_u32 m0, s55, 4096
    s_nop 0
    buffer_load_dwordx4 v9, s[32:35], s54 offen sc1 lds
    s_add_u32 s54, s53, 0xfffffff8
    s_cselect_b32 s56, 0, 54
    s_add_u32 s54, s54, s56
    s_mul_i32 s54, s54, 5120
    s_add_u32 s54, s54, s9
    s_add_u32 m0, s55, 5120
    s_nop 0
    buffer_load_dwordx4 v9, s[32:35], s54 offen sc1 lds
    s_add_u32 s54, s54, 1024
    s_add_u32 m0, s55, 6144
    s_nop 0
    buffer_load_dwordx4 v9, s[32:35], s54 offen sc1 lds
    s_add_u32 s54, s54, 1024
    s_add_u32 m0, s55, 7168
    s_nop 0
    buffer_load_dwordx4 v9, s[32:35], s54 offen sc1 lds
    s_add_u32 s54, s54, 1024
    s_add_u32 m0, s55, 8192
    s_nop 0
    buffer_load_dwordx4 v9, s[32:35], s54 offen sc1 lds
    s_add_u32 s54, s54, 1024
    s_add_u32 m0, s55, 9216
    s_nop 0
    buffer_load_dwordx4 v9, s[32:35], s54 offen sc1 lds
    s_add_u32 s98, s98, 40960
    s_cmp_ge_u32 s98, 122880
    s_cselect_b32 s98, s66, s98
    s_mul_i32 s53, s101, 25600
    s_add_u32 s53, s53, s9
    s_add_u32 s53, s53, 281600
    s_add_u32 s54, s53, 4096
    buffer_load_dwordx4 v[200:203], v9, s[32:35], s53 offen offset:0 sc1
    buffer_load_dwordx4 v[204:207], v9, s[32:35], s53 offen offset:1024 sc1
    buffer_load_dwordx4 v[208:211], v9, s[32:35], s53 offen offset:2048 sc1
    buffer_load_dwordx4 v[212:215], v9, s[32:35], s53 offen offset:3072 sc1
    buffer_load_dwordx4 v[216:219], v9, s[32:35], s54 offen offset:0 sc1
    s_barrier
    s_nop 3
    s_branch k1_kernel_s
k1_kernel_kvmap:
    s_mov_b32 s46, 8
    s_and_b32 s56, s53, 1
    s_lshl_b32 s49, s55, 1
    s_add_u32 s49, s49, s56
    s_lshr_b32 s57, s53, 1
    s_lshl_b32 s47, s55, 1
    s_lshl_b32 s56, s57, 3
    s_add_u32 s45, s45, s56
    s_lshl_b32 s48, s57, 1
    s_add_u32 s48, s48, s54
    s_mov_b32 s58, s48
    s_mov_b32 s48, 0x43210
    s_cmp_eq_u32 s58, 1
    s_cselect_b32 s48, 0x43210, s48
    s_cmp_eq_u32 s58, 2
    s_cselect_b32 s48, 0x43210, s48
    s_cmp_eq_u32 s58, 3
    s_cselect_b32 s48, 0x43210, s48
    s_cmp_eq_u32 s58, 4
    s_cselect_b32 s48, 0x43210, s48
    s_cmp_eq_u32 s58, 5
    s_cselect_b32 s48, 0x43210, s48
    s_cmp_eq_u32 s58, 6
    s_cselect_b32 s48, 0x43210, s48
    s_cmp_eq_u32 s58, 7
    s_cselect_b32 s48, 0x43210, s48
    s_cmp_ge_u32 s44, 4
    s_cbranch_scc1 k1_kernel_hk
    s_setprio 3
    v_lshrrev_b32 v52, 4, v0
    s_lshl_b32 s53, s44, 3
    v_add_u32 v52, s53, v52
    v_xor_b32 v53, v0, v52
    v_and_b32 v53, 15, v53
    v_mul_u32_u24 v48, 1280, v52
    v_lshl_add_u32 v48, v53, 4, v48
    v_xor_b32 v49, 64, v48
    v_add_u32 v49, 5120, v49
    s_add_u32 s53, s45, s47
    s_mul_i32 s100, s53, 40960
    s_bfe_u32 s53, s48, 0x40000
    s_lshl_b32 s53, s53, 8
    s_add_u32 s60, s53, s100
    s_bfe_u32 s53, s48, 0x40004
    s_lshl_b32 s53, s53, 8
    s_add_u32 s61, s53, s100
    s_bfe_u32 s53, s48, 0x40008
    s_lshl_b32 s53, s53, 8
    s_add_u32 s62, s53, s100
    s_bfe_u32 s53, s48, 0x4000c
    s_lshl_b32 s53, s53, 8
    s_add_u32 s63, s53, s100
    s_bfe_u32 s53, s48, 0x40010
    s_lshl_b32 s53, s53, 8
    s_add_u32 s64, s53, s100
    s_lshl_b32 s68, s44, 11
    s_waitcnt lgkmcnt(0)
    s_mov_b32 s24, s4
    s_and_b32 s25, s5, 0xffff
    s_mov_b32 s26, 2621440
    s_mov_b32 s27, 0x20000
    s_add_u32 m0, s68, 0
    s_nop 0
    buffer_load_dwordx4 v48, s[24:27], s60 offen lds
    s_add_u32 m0, s68, 1024
    s_nop 0
    buffer_load_dwordx4 v49, s[24:27], s60 offen lds
    s_add_u32 m0, s68, 8192
    s_nop 0
    buffer_load_dwordx4 v48, s[24:27], s61 offen lds
    s_add_u32 m0, s68, 9216
    s_nop 0
    buffer_load_dwordx4 v49, s[24:27], s61 offen lds
    s_add_u32 m0, s68, 16384
    s_nop 0
    buffer_load_dwordx4 v48, s[24:27], s62 offen lds
    s_add_u32 m0, s68, 17408
    s_nop 0
    buffer_load_dwordx4 v49, s[24:27], s62 offen lds
    s_add_u32 m0, s68, 24576
    s_nop 0
    buffer_load_dwordx4 v48, s[24:27], s63 offen lds
    s_add_u32 m0, s68, 25600
    s_nop 0
    buffer_load_dwordx4 v49, s[24:27], s63 offen lds
    s_add_u32 m0, s68, 32768
    s_nop 0
    buffer_load_dwordx4 v48, s[24:27], s64 offen lds
    s_add_u32 m0, s68, 33792
    s_nop 0
    buffer_load_dwordx4 v49, s[24:27], s64 offen lds
    s_setprio 0
    v_and_b32 v6, 31, v0
    v_lshrrev_b32 v7, 5, v0
    v_xor_b32 v8, v6, v7
    v_and_b32 v8, 15, v8
    v_lshlrev_b32 v8, 4, v8
    v_lshl_add_u32 v8, v6, 8, v8
    v_xor_b32 v9, 32, v8
    v_xor_b32 v10, 64, v8
    v_xor_b32 v11, 96, v8
    v_xor_b32 v12, 128, v8
    v_xor_b32 v13, 160, v8
    v_xor_b32 v14, 192, v8
    v_xor_b32 v15, 224, v8
    v_lshlrev_b32 v1, 4, v0
    v_bfe_u32 v16, v0, 2, 2
    v_and_b32 v17, 3, v0
    v_bfe_u32 v18, v0, 4, 1
    v_lshl_add_u32 v19, v7, 3, v16
    v_lshl_add_u32 v20, v18, 2, v17
    v_mul_u32_u24 v3, 160, v19
    v_lshl_add_u32 v3, v20, 3, v3
    s_mul_i32 s53, s44, 40
    v_add_u32 v3, s53, v3
    v_mov_b32 v21, 10240
    v_mov_b32 v22, -24
    v_cmp_gt_u32 vcc, 3, v20
    s_nop 1
    v_cndmask_b32 v21, v22, v21, vcc
    v_add_u32 v3, v3, v21
    v_add_u32 v3, 40960, v3
    v_add_u32 v4, 40960, v3
    v_lshlrev_b32 v2, 6, v7
    v_add_u32 v2, 122880, v2
    s_mov_b32 s60, 0x35c1a2a0
    s_mov_b32 s61, 0x3f317218
    s_mov_b32 s100, 40960
    s_mov_b32 s32, s22
    s_and_b32 s33, s23, 0xffff
    s_mov_b32 s34, 12849152
    s_mov_b32 s35, 0x20000
    s_mov_b32 s36, s20
    s_and_b32 s37, s21, 0xffff
    s_mov_b32 s38, 256
    s_mov_b32 s39, 0x20000
    s_mov_b32 s101, 0
    s_cmp_eq_u32 s44, 0
    s_cselect_b32 s66, 1, 0
    s_lshl_b32 s67, s45, 2
    s_lshr_b32 s14, s2, 5
    s_and_b32 s53, s2, 7
    s_bfe_u32 s54, s2, 0x20003
    s_lshl_b32 s13, s53, 2
    s_add_u32 s13, s13, s54
    s_mul_i32 s8, s13, 303104
    s_mul_i32 s9, s14, 378880
    s_add_u32 s9, s9, 9699328
    s_lshr_b32 s53, s13, 4
    s_mul_i32 s11, s53, 6144
    s_and_b32 s53, s13, 15
    s_lshl_b32 s53, s53, 1
    s_add_u32 s54, s53, 1
    s_cmp_ge_u32 s53, 22
    s_cselect_b32 s55, 2048, 0
    s_cselect_b32 s56, 11, 0
    s_add_u32 s11, s11, s55
    s_sub_u32 s54, s54, s56
    s_cmp_ge_u32 s53, 10
    s_cselect_b32 s55, 2048, 0
    s_cselect_b32 s56, 11, 0
    s_add_u32 s12, s11, s55
    s_sub_u32 s54, s54, s56
    s_cmp_eq_u32 s53, 10
    s_cselect_b32 s11, s11, s12
    s_mul_i32 s55, s54, 11
    s_lshr_b32 s55, s55, 5
    s_mul_i32 s54, s54, 3
    s_sub_u32 s54, s54, s55
    s_add_u32 s54, s54, 11
    s_sub_u32 s55, s54, 27
    s_cmp_ge_u32 s54, 27
    s_cselect_b32 s54, s55, s54
    s_lshl_b32 s10, s54, 1
    s_lshl_b32 s15, s2, 6
    s_add_u32 s15, s15, 12833792
    s_mov_b32 s16, 81920
    s_mov_b32 s17, 0
    s_mov_b32 s7, 40960
    s_lshl_b32 s54, s47, 9
    s_add_u32 s54, s54, 122880
    s_waitcnt vmcnt(0)
    v_lshrrev_b32 v16, 3, v0
    s_lshl_b32 s53, s44, 3
    v_add_u32 v16, s53, v16
    v_and_b32 v17, 7, v0
    v_lshlrev_b32 v18, 4, v17
    v_lshl_add_u32 v18, v16, 8, v18
    v_and_b32 v19, 16, v0
    v_lshl_add_u32 v18, v19, 3, v18
    v_xor_b32 v19, 0x80, v18
    ds_read_b128 v[48:51], v18 offset:0
    ds_read_b128 v[52:55], v19 offset:0
    ds_read_b128 v[56:59], v18 offset:8192
    ds_read_b128 v[60:63], v19 offset:8192
    ds_read_b128 v[64:67], v18 offset:16384
    ds_read_b128 v[68:71], v19 offset:16384
    ds_read_b128 v[72:75], v18 offset:24576
    ds_read_b128 v[76:79], v19 offset:24576
    ds_read_b128 v[80:83], v18 offset:32768
    ds_read_b128 v[84:87], v19 offset:32768
    v_lshlrev_b32 v17, 4, v16
    s_waitcnt lgkmcnt(9)
    v_dot2_f32_bf16 v22, v48, v48, 0
    v_dot2_f32_bf16 v23, v49, v49, 0
    v_dot2_f32_bf16 v22, v50, v50, v22
    v_dot2_f32_bf16 v23, v51, v51, v23
    s_waitcnt lgkmcnt(8)
    v_dot2_f32_bf16 v22, v52, v52, v22
    v_dot2_f32_bf16 v18, v52, s52, 0
    v_dot2_f32_bf16 v23, v53, v53, v23
    v_dot2_f32_bf16 v19, v53, s52, 0
    v_dot2_f32_bf16 v22, v54, v54, v22
    v_dot2_f32_bf16 v18, v54, s52, v18
    v_dot2_f32_bf16 v23, v55, v55, v23
    v_dot2_f32_bf16 v19, v55, s52, v19
    s_waitcnt lgkmcnt(7)
    v_dot2_f32_bf16 v22, v56, v56, v22
    v_dot2_f32_bf16 v18, v56, s52, v18
    v_dot2_f32_bf16 v23, v57, v57, v23
    v_dot2_f32_bf16 v19, v57, s52, v19
    v_dot2_f32_bf16 v22, v58, v58, v22
    v_dot2_f32_bf16 v18, v58, s52, v18
    v_dot2_f32_bf16 v23, v59, v59, v23
    v_dot2_f32_bf16 v19, v59, s52, v19
    s_waitcnt lgkmcnt(6)
    v_dot2_f32_bf16 v22, v60, v60, v22
    v_dot2_f32_bf16 v18, v60, s52, v18
    v_dot2_f32_bf16 v23, v61, v61, v23
    v_dot2_f32_bf16 v19, v61, s52, v19
    v_dot2_f32_bf16 v22, v62, v62, v22
    v_dot2_f32_bf16 v18, v62, s52, v18
    v_dot2_f32_bf16 v23, v63, v63, v23
    v_dot2_f32_bf16 v19, v63, s52, v19
    s_waitcnt lgkmcnt(5)
    v_dot2_f32_bf16 v22, v64, v64, v22
    v_dot2_f32_bf16 v18, v64, s52, v18
    v_dot2_f32_bf16 v23, v65, v65, v23
    v_dot2_f32_bf16 v19, v65, s52, v19
    v_dot2_f32_bf16 v22, v66, v66, v22
    v_dot2_f32_bf16 v18, v66, s52, v18
    v_dot2_f32_bf16 v23, v67, v67, v23
    v_dot2_f32_bf16 v19, v67, s52, v19
    s_waitcnt lgkmcnt(4)
    v_dot2_f32_bf16 v22, v68, v68, v22
    v_dot2_f32_bf16 v18, v68, s52, v18
    v_dot2_f32_bf16 v23, v69, v69, v23
    v_dot2_f32_bf16 v19, v69, s52, v19
    v_dot2_f32_bf16 v22, v70, v70, v22
    v_dot2_f32_bf16 v18, v70, s52, v18
    v_dot2_f32_bf16 v23, v71, v71, v23
    v_dot2_f32_bf16 v19, v71, s52, v19
    s_waitcnt lgkmcnt(3)
    v_dot2_f32_bf16 v22, v72, v72, v22
    v_dot2_f32_bf16 v18, v72, s52, v18
    v_dot2_f32_bf16 v23, v73, v73, v23
    v_dot2_f32_bf16 v19, v73, s52, v19
    v_dot2_f32_bf16 v22, v74, v74, v22
    v_dot2_f32_bf16 v18, v74, s52, v18
    v_dot2_f32_bf16 v23, v75, v75, v23
    v_dot2_f32_bf16 v19, v75, s52, v19
    s_waitcnt lgkmcnt(2)
    v_dot2_f32_bf16 v22, v76, v76, v22
    v_dot2_f32_bf16 v18, v76, s52, v18
    v_dot2_f32_bf16 v23, v77, v77, v23
    v_dot2_f32_bf16 v19, v77, s52, v19
    v_dot2_f32_bf16 v22, v78, v78, v22
    v_dot2_f32_bf16 v18, v78, s52, v18
    v_dot2_f32_bf16 v23, v79, v79, v23
    v_dot2_f32_bf16 v19, v79, s52, v19
    s_waitcnt lgkmcnt(1)
    v_dot2_f32_bf16 v22, v80, v80, v22
    v_dot2_f32_bf16 v18, v80, s52, v18
    v_dot2_f32_bf16 v23, v81, v81, v23
    v_dot2_f32_bf16 v19, v81, s52, v19
    v_dot2_f32_bf16 v22, v82, v82, v22
    v_dot2_f32_bf16 v18, v82, s52, v18
    v_dot2_f32_bf16 v23, v83, v83, v23
    v_dot2_f32_bf16 v19, v83, s52, v19
    s_waitcnt lgkmcnt(0)
    v_dot2_f32_bf16 v22, v84, v84, v22
    v_dot2_f32_bf16 v18, v84, s52, v18
    v_dot2_f32_bf16 v23, v85, v85, v23
    v_dot2_f32_bf16 v19, v85, s52, v19
    v_dot2_f32_bf16 v22, v86, v86, v22
    v_dot2_f32_bf16 v18, v86, s52, v18
    v_dot2_f32_bf16 v23, v87, v87, v23
    v_dot2_f32_bf16 v19, v87, s52, v19
    v_dot2_f32_bf16 v18, v48, s52, v18
    v_dot2_f32_bf16 v19, v49, s52, v19
    v_dot2_f32_bf16 v18, v50, s52, v18
    v_dot2_f32_bf16 v19, v51, s52, v19
    s_nop 2
    v_add_f32 v18, v18, v19
    v_add_f32 v22, v22, v23
    s_nop 0
    v_add_f32_dpp v18, v18, v18 quad_perm:[1,0,3,2] row_mask:0xf bank_mask:0xf
    v_add_f32_dpp v22, v22, v22 quad_perm:[1,0,3,2] row_mask:0xf bank_mask:0xf
    s_nop 0
    v_add_f32_dpp v18, v18, v18 quad_perm:[2,3,0,1] row_mask:0xf bank_mask:0xf
    v_add_f32_dpp v22, v22, v22 quad_perm:[2,3,0,1] row_mask:0xf bank_mask:0xf
    s_nop 0
    v_add_f32_dpp v18, v18, v18 row_half_mirror row_mask:0xf bank_mask:0xf
    v_add_f32_dpp v22, v22, v22 row_half_mirror row_mask:0xf bank_mask:0xf
    v_mul_f32 v18, 0x3acccccd, v18
    v_mov_b32 v19, 0x3727c5ac
    v_fmac_f32 v19, 0x3acccccd, v22
    v_fma_f32 v19, -v18, v18, v19
    v_rsq_f32 v23, v19
    v_xor_b32 v20, 0x80000000, v18
    v_add_u32 v18, s54, v17
    s_mov_b32 exec_lo, 0x01010101
    s_mov_b32 exec_hi, 0x01010101
    v_mul_f32 v21, 0x3fb8aa3b, v23
    v_mul_f32 v22, v19, v23
    ds_write_b128 v18, v[20:23]
    s_mov_b64 exec, -1
    s_mov_b32 vcc_lo, 0xf0f00f0f
    s_mov_b32 vcc_hi, 0xf0f00f0f
    v_mov_b32 v47, s52
    s_nop 1
    v_cndmask_b32 v44, 0, v47, vcc
    v_cndmask_b32 v45, 0, v47, vcc
    v_cndmask_b32 v46, 0, v47, vcc
    v_cndmask_b32 v47, 0, v47, vcc
    s_waitcnt lgkmcnt(0)
    s_barrier
    ds_read_b64_tr_b16 v[96:97], v4 offset:20480
    ds_read_b64_tr_b16 v[98:99], v4 offset:21120
    ds_read_b64_tr_b16 v[100:101], v4 offset:23040
    ds_read_b64_tr_b16 v[102:103], v4 offset:23680
    ds_read_b64_tr_b16 v[104:105], v4 offset:25600
    ds_read_b64_tr_b16 v[106:107], v4 offset:26240
    ds_read_b64_tr_b16 v[108:109], v4 offset:28160
    ds_read_b64_tr_b16 v[110:111], v4 offset:28800
    ds_read_b128 v[20:23], v8 offset:0
    ds_read_b128 v[24:27], v9 offset:0
    ds_read_b128 v[28:31], v10 offset:0
    ds_read_b128 v[36:39], v11 offset:0
    ds_read_b128 v[40:43], v12 offset:0
    ds_read_b128 v[32:35], v13 offset:0
    ds_read_b128 v[16:19], v14 offset:0
    s_waitcnt lgkmcnt(7)
    s_barrier
    v_mfma_f32_16x16x32_bf16 v[48:51], v[44:47], v[96:99], 0
    ds_read_b64_tr_b16 v[112:113], v4 offset:48128
    ds_read_b64_tr_b16 v[114:115], v4 offset:48768
    v_mfma_f32_16x16x32_bf16 v[48:51], v[44:47], v[100:103], v[48:51]
    ds_read_b64_tr_b16 v[116:117], v4 offset:50688
    ds_read_b64_tr_b16 v[118:119], v4 offset:51328
    v_mfma_f32_16x16x32_bf16 v[48:51], v[44:47], v[104:107], v[48:51]
    ds_read_b64_tr_b16 v[120:121], v4 offset:53248
    ds_read_b64_tr_b16 v[122:123], v4 offset:53888
    v_mfma_f32_16x16x32_bf16 v[48:51], v[44:47], v[108:111], v[48:51]
    ds_read_b64_tr_b16 v[124:125], v4 offset:55808
    ds_read_b64_tr_b16 v[126:127], v4 offset:56448
    s_waitcnt lgkmcnt(14)
    v_mfma_f32_32x32x16_bf16 v[64:79], v[20:23], v[96:99], 0
    ds_read_b128 v[20:23], v15 offset:0
    s_waitcnt lgkmcnt(14)
    v_mfma_f32_32x32x16_bf16 v[64:79], v[24:27], v[100:103], v[64:79]
    s_waitcnt lgkmcnt(13)
    v_mfma_f32_32x32x16_bf16 v[64:79], v[28:31], v[104:107], v[64:79]
    s_waitcnt lgkmcnt(12)
    v_mfma_f32_32x32x16_bf16 v[64:79], v[36:39], v[108:111], v[64:79]
    s_waitcnt lgkmcnt(1)
    s_barrier
    v_mfma_f32_16x16x32_bf16 v[48:51], v[44:47], v[112:115], v[48:51]
    ds_read_b64_tr_b16 v[128:129], v3 offset:20480
    ds_read_b64_tr_b16 v[130:131], v3 offset:21120
    v_mfma_f32_16x16x32_bf16 v[48:51], v[44:47], v[116:119], v[48:51]
    ds_read_b64_tr_b16 v[132:133], v3 offset:23040
    ds_read_b64_tr_b16 v[134:135], v3 offset:23680
    v_mfma_f32_16x16x32_bf16 v[48:51], v[44:47], v[120:123], v[48:51]
    ds_read_b64_tr_b16 v[136:137], v3 offset:25600
    ds_read_b64_tr_b16 v[138:139], v3 offset:26240
    v_mfma_f32_16x16x32_bf16 v[48:51], v[44:47], v[124:127], v[48:51]
    ds_read_b64_tr_b16 v[140:141], v3 offset:28160
    ds_read_b64_tr_b16 v[142:143], v3 offset:28800
    v_mfma_f32_32x32x16_bf16 v[64:79], v[40:43], v[112:115], v[64:79]
    ds_read_b128 v[24:27], v8 offset:40960
    ds_read_b128 v[28:31], v9 offset:40960
    v_mfma_f32_32x32x16_bf16 v[64:79], v[32:35], v[116:119], v[64:79]
    ds_read_b128 v[36:39], v10 offset:40960
    ds_read_b128 v[40:43], v11 offset:40960
    v_mfma_f32_32x32x16_bf16 v[64:79], v[16:19], v[120:123], v[64:79]
    ds_read_b128 v[32:35], v8 offset:8192
    ds_read_b128 v[16:19], v9 offset:8192
    s_waitcnt lgkmcnt(14)
    v_mfma_f32_32x32x16_bf16 v[64:79], v[20:23], v[124:127], v[64:79]
    ds_read_b128 v[20:23], v10 offset:8192
    s_waitcnt lgkmcnt(6)
    v_mfma_f32_32x32x16_bf16 v[80:95], v[24:27], v[96:99], 0
    ds_read_b128 v[24:27], v11 offset:8192
    s_waitcnt lgkmcnt(6)
    v_mfma_f32_32x32x16_bf16 v[80:95], v[28:31], v[100:103], v[80:95]
    ds_read_b128 v[28:31], v12 offset:40960
    s_waitcnt lgkmcnt(6)
    v_mfma_f32_32x32x16_bf16 v[80:95], v[36:39], v[104:107], v[80:95]
    ds_read_b128 v[36:39], v13 offset:40960
    s_waitcnt lgkmcnt(6)
    v_mfma_f32_32x32x16_bf16 v[80:95], v[40:43], v[108:111], v[80:95]
    ds_read_b128 v[40:43], v14 offset:40960
    s_barrier
    v_mfma_f32_16x16x32_bf16 v[48:51], v[44:47], v[128:131], v[48:51]
    ds_read_b64_tr_b16 v[144:145], v4 offset:0
    ds_read_b64_tr_b16 v[146:147], v4 offset:640
    v_mfma_f32_16x16x32_bf16 v[48:51], v[44:47], v[132:135], v[48:51]
    ds_read_b64_tr_b16 v[148:149], v4 offset:2560
    ds_read_b64_tr_b16 v[150:151], v4 offset:3200
    v_mfma_f32_16x16x32_bf16 v[48:51], v[44:47], v[136:139], v[48:51]
    ds_read_b64_tr_b16 v[152:153], v4 offset:5120
    ds_read_b64_tr_b16 v[154:155], v4 offset:5760
    v_mfma_f32_16x16x32_bf16 v[48:51], v[44:47], v[140:143], v[48:51]
    ds_read_b64_tr_b16 v[156:157], v4 offset:7680
    ds_read_b64_tr_b16 v[158:159], v4 offset:8320
    s_waitcnt lgkmcnt(14)
    v_mfma_f32_32x32x16_bf16 v[64:79], v[32:35], v[128:131], v[64:79]
    ds_read_b128 v[32:35], v15 offset:40960
    s_waitcnt lgkmcnt(14)
    v_mfma_f32_32x32x16_bf16 v[64:79], v[16:19], v[132:135], v[64:79]
    ds_read_b128 v[16:19], v12 offset:8192
    s_waitcnt lgkmcnt(14)
    v_mfma_f32_32x32x16_bf16 v[64:79], v[20:23], v[136:139], v[64:79]
    ds_read_b128 v[20:23], v13 offset:8192
    s_waitcnt lgkmcnt(14)
    v_mfma_f32_32x32x16_bf16 v[64:79], v[24:27], v[140:143], v[64:79]
    ds_read_b128 v[24:27], v14 offset:8192
    s_waitcnt lgkmcnt(14)
    v_mfma_f32_32x32x16_bf16 v[80:95], v[28:31], v[112:115], v[80:95]
    ds_read_b128 v[28:31], v15 offset:8192
    s_waitcnt lgkmcnt(14)
    v_mfma_f32_32x32x16_bf16 v[80:95], v[36:39], v[116:119], v[80:95]
    s_waitcnt lgkmcnt(13)
    v_mfma_f32_32x32x16_bf16 v[80:95], v[40:43], v[120:123], v[80:95]
    s_waitcnt lgkmcnt(4)
    v_mfma_f32_32x32x16_bf16 v[80:95], v[32:35], v[124:127], v[80:95]
    s_barrier
    v_mfma_f32_16x16x32_bf16 v[48:51], v[44:47], v[144:147], v[48:51]
    ds_read_b64_tr_b16 v[160:161], v4 offset:20480
    ds_read_b64_tr_b16 v[162:163], v4 offset:21120
    v_mfma_f32_16x16x32_bf16 v[48:51], v[44:47], v[148:151], v[48:51]
    ds_read_b64_tr_b16 v[164:165], v4 offset:23040
    ds_read_b64_tr_b16 v[166:167], v4 offset:23680
    v_mfma_f32_16x16x32_bf16 v[48:51], v[44:47], v[152:155], v[48:51]
    ds_read_b64_tr_b16 v[168:169], v4 offset:25600
    ds_read_b64_tr_b16 v[170:171], v4 offset:26240
    v_mfma_f32_16x16x32_bf16 v[48:51], v[44:47], v[156:159], v[48:51]
    ds_read_b64_tr_b16 v[172:173], v4 offset:28160
    ds_read_b64_tr_b16 v[174:175], v4 offset:28800
    s_waitcnt lgkmcnt(11)
    v_mfma_f32_32x32x16_bf16 v[64:79], v[16:19], v[144:147], v[64:79]
    ds_read_b128 v[36:39], v8 offset:49152
    ds_read_b128 v[40:43], v9 offset:49152
    s_waitcnt lgkmcnt(12)
    v_mfma_f32_32x32x16_bf16 v[64:79], v[20:23], v[148:151], v[64:79]
    ds_read_b128 v[32:35], v10 offset:49152
    ds_read_b128 v[16:19], v11 offset:49152
    s_waitcnt lgkmcnt(13)
    v_mfma_f32_32x32x16_bf16 v[64:79], v[24:27], v[152:155], v[64:79]
    ds_read_b128 v[20:23], v8 offset:16384
    ds_read_b128 v[24:27], v9 offset:16384
    s_waitcnt lgkmcnt(14)
    v_mfma_f32_32x32x16_bf16 v[64:79], v[28:31], v[156:159], v[64:79]
    ds_read_b128 v[28:31], v10 offset:16384
    s_waitcnt lgkmcnt(6)
    v_mfma_f32_32x32x16_bf16 v[80:95], v[36:39], v[128:131], v[80:95]
    ds_read_b128 v[36:39], v11 offset:16384
    s_waitcnt lgkmcnt(6)
    v_mfma_f32_32x32x16_bf16 v[80:95], v[40:43], v[132:135], v[80:95]
    ds_read_b128 v[40:43], v12 offset:49152
    s_waitcnt lgkmcnt(6)
    v_mfma_f32_32x32x16_bf16 v[80:95], v[32:35], v[136:139], v[80:95]
    ds_read_b128 v[32:35], v13 offset:49152
    s_waitcnt lgkmcnt(6)
    v_mfma_f32_32x32x16_bf16 v[80:95], v[16:19], v[140:143], v[80:95]
    ds_read_b128 v[16:19], v14 offset:49152
    s_barrier
    v_mfma_f32_16x16x32_bf16 v[48:51], v[44:47], v[160:163], v[48:51]
    ds_read_b64_tr_b16 v[176:177], v4 offset:48128
    ds_read_b64_tr_b16 v[178:179], v4 offset:48768
    v_mfma_f32_16x16x32_bf16 v[48:51], v[44:47], v[164:167], v[48:51]
    ds_read_b64_tr_b16 v[180:181], v4 offset:50688
    ds_read_b64_tr_b16 v[182:183], v4 offset:51328
    v_mfma_f32_16x16x32_bf16 v[48:51], v[44:47], v[168:171], v[48:51]
    ds_read_b64_tr_b16 v[184:185], v4 offset:53248
    ds_read_b64_tr_b16 v[186:187], v4 offset:53888
    v_mfma_f32_16x16x32_bf16 v[48:51], v[44:47], v[172:175], v[48:51]
    ds_read_b64_tr_b16 v[188:189], v4 offset:55808
    ds_read_b64_tr_b16 v[190:191], v4 offset:56448
    s_waitcnt lgkmcnt(14)
    v_mfma_f32_32x32x16_bf16 v[64:79], v[20:23], v[160:163], v[64:79]
    ds_read_b128 v[20:23], v15 offset:49152
    s_waitcnt lgkmcnt(14)
    v_mfma_f32_32x32x16_bf16 v[64:79], v[24:27], v[164:167], v[64:79]
    ds_read_b128 v[24:27], v12 offset:16384
    s_waitcnt lgkmcnt(14)
    v_mfma_f32_32x32x16_bf16 v[64:79], v[28:31], v[168:171], v[64:79]
    ds_read_b128 v[28:31], v13 offset:16384
    s_waitcnt lgkmcnt(14)
    v_mfma_f32_32x32x16_bf16 v[64:79], v[36:39], v[172:175], v[64:79]
    ds_read_b128 v[36:39], v14 offset:16384
    s_waitcnt lgkmcnt(14)
    v_mfma_f32_32x32x16_bf16 v[80:95], v[40:43], v[144:147], v[80:95]
    ds_read_b128 v[40:43], v15 offset:16384
    s_waitcnt lgkmcnt(14)
    v_mfma_f32_32x32x16_bf16 v[80:95], v[32:35], v[148:151], v[80:95]
    ds_read_b128 v[32:35], v8 offset:24576
    s_waitcnt lgkmcnt(14)
    v_mfma_f32_32x32x16_bf16 v[80:95], v[16:19], v[152:155], v[80:95]
    ds_read_b128 v[16:19], v9 offset:24576
    s_waitcnt lgkmcnt(6)
    v_mfma_f32_32x32x16_bf16 v[80:95], v[20:23], v[156:159], v[80:95]
    ds_read_b128 v[20:23], v10 offset:24576
    s_barrier
    v_mfma_f32_16x16x32_bf16 v[48:51], v[44:47], v[176:179], v[48:51]
    ds_read_b64_tr_b16 v[192:193], v3 offset:20480
    ds_read_b64_tr_b16 v[194:195], v3 offset:21120
    v_mfma_f32_16x16x32_bf16 v[48:51], v[44:47], v[180:183], v[48:51]
    ds_read_b64_tr_b16 v[196:197], v3 offset:23040
    ds_read_b64_tr_b16 v[198:199], v3 offset:23680
    v_mfma_f32_16x16x32_bf16 v[48:51], v[44:47], v[184:187], v[48:51]
    ds_read_b64_tr_b16 v[200:201], v3 offset:25600
    ds_read_b64_tr_b16 v[202:203], v3 offset:26240
    v_mfma_f32_16x16x32_bf16 v[48:51], v[44:47], v[188:191], v[48:51]
    ds_read_b64_tr_b16 v[204:205], v3 offset:28160
    ds_read_b64_tr_b16 v[206:207], v3 offset:28800
    s_waitcnt lgkmcnt(14)
    v_mfma_f32_32x32x16_bf16 v[64:79], v[24:27], v[176:179], v[64:79]
    ds_read_b128 v[24:27], v11 offset:24576
    s_waitcnt lgkmcnt(14)
    v_mfma_f32_32x32x16_bf16 v[64:79], v[28:31], v[180:183], v[64:79]
    ds_read_b128 v[28:31], v12 offset:24576
    s_waitcnt lgkmcnt(14)
    v_mfma_f32_32x32x16_bf16 v[64:79], v[36:39], v[184:187], v[64:79]
    ds_read_b128 v[36:39], v13 offset:24576
    s_waitcnt lgkmcnt(14)
    v_mfma_f32_32x32x16_bf16 v[64:79], v[40:43], v[188:191], v[64:79]
    ds_read_b128 v[40:43], v14 offset:24576
    s_waitcnt lgkmcnt(4)
    s_barrier
    v_mfma_f32_16x16x32_bf16 v[48:51], v[44:47], v[192:195], v[48:51]
    ds_read_b64_tr_b16 v[208:209], v4 offset:0
    ds_read_b64_tr_b16 v[210:211], v4 offset:640
    v_mfma_f32_16x16x32_bf16 v[48:51], v[44:47], v[196:199], v[48:51]
    ds_read_b64_tr_b16 v[212:213], v4 offset:2560
    ds_read_b64_tr_b16 v[214:215], v4 offset:3200
    v_mfma_f32_16x16x32_bf16 v[48:51], v[44:47], v[200:203], v[48:51]
    ds_read_b64_tr_b16 v[216:217], v4 offset:5120
    ds_read_b64_tr_b16 v[218:219], v4 offset:5760
    v_mfma_f32_16x16x32_bf16 v[48:51], v[44:47], v[204:207], v[48:51]
    ds_read_b64_tr_b16 v[220:221], v4 offset:7680
    ds_read_b64_tr_b16 v[222:223], v4 offset:8320
    s_cmp_lg_u32 s66, 0
    s_cbranch_scc0 k1_kernel_ckv_k7
    s_call_b64 s[4:5], k1_kernel_ckv_chk
k1_kernel_ckv_k7:
    v_mfma_f32_32x32x16_bf16 v[64:79], v[32:35], v[192:195], v[64:79]
    ds_read_b128 v[32:35], v15 offset:24576
    v_mfma_f32_32x32x16_bf16 v[64:79], v[16:19], v[196:199], v[64:79]
    ds_read_b128 v[16:19], v8 offset:32768
    v_mfma_f32_32x32x16_bf16 v[64:79], v[20:23], v[200:203], v[64:79]
    ds_read_b128 v[20:23], v9 offset:32768
    s_waitcnt lgkmcnt(14)
    v_mfma_f32_32x32x16_bf16 v[64:79], v[24:27], v[204:207], v[64:79]
    ds_read_b128 v[24:27], v10 offset:32768
    s_waitcnt lgkmcnt(4)
    s_barrier
    v_mfma_f32_16x16x32_bf16 v[48:51], v[44:47], v[208:211], v[48:51]
    ds_read_b64_tr_b16 v[224:225], v4 offset:20480
    ds_read_b64_tr_b16 v[226:227], v4 offset:21120
    v_mfma_f32_16x16x32_bf16 v[48:51], v[44:47], v[212:215], v[48:51]
    ds_read_b64_tr_b16 v[228:229], v4 offset:23040
    ds_read_b64_tr_b16 v[230:231], v4 offset:23680
    v_mfma_f32_16x16x32_bf16 v[48:51], v[44:47], v[216:219], v[48:51]
    ds_read_b64_tr_b16 v[232:233], v4 offset:25600
    ds_read_b64_tr_b16 v[234:235], v4 offset:26240
    v_mfma_f32_16x16x32_bf16 v[48:51], v[44:47], v[220:223], v[48:51]
    ds_read_b64_tr_b16 v[236:237], v4 offset:28160
    ds_read_b64_tr_b16 v[238:239], v4 offset:28800
    s_cmp_lg_u32 s66, 0
    s_cbranch_scc0 k1_kernel_ckv_k8
    s_call_b64 s[4:5], k1_kernel_ckv_chk
k1_kernel_ckv_k8:
    v_mfma_f32_32x32x16_bf16 v[64:79], v[28:31], v[208:211], v[64:79]
    ds_read_b128 v[28:31], v11 offset:32768
    v_mfma_f32_32x32x16_bf16 v[64:79], v[36:39], v[212:215], v[64:79]
    ds_read_b128 v[36:39], v12 offset:32768
    v_mfma_f32_32x32x16_bf16 v[64:79], v[40:43], v[216:219], v[64:79]
    ds_read_b128 v[40:43], v13 offset:32768
    s_waitcnt lgkmcnt(14)
    v_mfma_f32_32x32x16_bf16 v[64:79], v[32:35], v[220:223], v[64:79]
    ds_read_b128 v[32:35], v14 offset:32768
    s_waitcnt lgkmcnt(4)
    s_barrier
    v_mfma_f32_16x16x32_bf16 v[48:51], v[44:47], v[224:227], v[48:51]
    ds_read_b64_tr_b16 v[240:241], v4 offset:48128
    ds_read_b64_tr_b16 v[242:243], v4 offset:48768
    v_mfma_f32_16x16x32_bf16 v[48:51], v[44:47], v[228:231], v[48:51]
    ds_read_b64_tr_b16 v[244:245], v4 offset:50688
    ds_read_b64_tr_b16 v[246:247], v4 offset:51328
    v_mfma_f32_16x16x32_bf16 v[48:51], v[44:47], v[232:235], v[48:51]
    ds_read_b64_tr_b16 v[248:249], v4 offset:53248
    ds_read_b64_tr_b16 v[250:251], v4 offset:53888
    v_mfma_f32_16x16x32_bf16 v[48:51], v[44:47], v[236:239], v[48:51]
    ds_read_b64_tr_b16 v[252:253], v4 offset:55808
    ds_read_b64_tr_b16 v[254:255], v4 offset:56448
    s_cmp_lg_u32 s66, 0
    s_cbranch_scc0 k1_kernel_ckv_k9
    s_call_b64 s[4:5], k1_kernel_ckv_chk
k1_kernel_ckv_k9:
    v_mfma_f32_32x32x16_bf16 v[64:79], v[16:19], v[224:227], v[64:79]
    ds_read_b128 v[16:19], v15 offset:32768
    v_mfma_f32_32x32x16_bf16 v[64:79], v[20:23], v[228:231], v[64:79]
    v_mfma_f32_32x32x16_bf16 v[64:79], v[24:27], v[232:235], v[64:79]
    s_waitcnt lgkmcnt(12)
    v_mfma_f32_32x32x16_bf16 v[64:79], v[28:31], v[236:239], v[64:79]
    s_waitcnt lgkmcnt(1)
    s_waitcnt lgkmcnt(0)
    s_barrier
    v_add_u32 v8, 40960, v8
    v_add_u32 v9, 40960, v9
    v_add_u32 v10, 40960, v10
    v_add_u32 v11, 40960, v11
    v_add_u32 v12, 40960, v12
    v_add_u32 v13, 40960, v13
    v_add_u32 v14, 40960, v14
    v_add_u32 v15, 40960, v15
    v_mfma_f32_16x16x32_bf16 v[48:51], v[44:47], v[240:243], v[48:51]
    ds_read_b128 v[20:23], v8 offset:16384
    ds_read_b128 v[24:27], v9 offset:16384
    v_mfma_f32_16x16x32_bf16 v[48:51], v[44:47], v[244:247], v[48:51]
    ds_read_b128 v[28:31], v10 offset:16384
    v_mfma_f32_16x16x32_bf16 v[48:51], v[44:47], v[248:251], v[48:51]
    v_mfma_f32_16x16x32_bf16 v[48:51], v[44:47], v[252:255], v[48:51]
    s_cmp_lg_u32 s66, 0
    s_cbranch_scc0 k1_kernel_ckv_k10
    s_call_b64 s[4:5], k1_kernel_ckv_chk
k1_kernel_ckv_k10:
    v_mfma_f32_32x32x16_bf16 v[64:79], v[36:39], v[240:243], v[64:79]
    v_mfma_f32_32x32x16_bf16 v[64:79], v[40:43], v[244:247], v[64:79]
    v_mfma_f32_32x32x16_bf16 v[64:79], v[32:35], v[248:251], v[64:79]
    ds_read_b128 v[32:35], v11 offset:16384
    v_mfma_f32_32x32x16_bf16 v[64:79], v[16:19], v[252:255], v[64:79]
    ds_read_b128 v[16:19], v12 offset:16384
    s_mov_b32 s51, 1
    s_mov_b32 s65, 1
    v_mbcnt_lo_u32_b32 v4, -1, 0
    v_mbcnt_hi_u32_b32 v4, -1, v4
    v_and_b32 v1, 31, v4
    v_cmp_gt_u32 s[62:63], 12, v1
    v_mov_b32 v5, s60
    v_mov_b32 v6, s60
    v_mov_b32 v7, 0x3fb8aa3b
    v_mov_b32 v3, 0xff800000
    v_cndmask_b32 v5, v5, 0, s[62:63]
    v_cndmask_b32 v6, v6, v3, s[62:63]
    v_cndmask_b32 v7, v7, 0, s[62:63]
    v_subrev_u32 v3, 12, v1
    v_cmp_gt_u32 vcc, 8, v3
    v_lshlrev_b32 v3, 4, v3
    v_lshrrev_b32 v1, 5, v4
    v_lshl_add_u32 v3, v1, 7, v3
    s_lshl_b32 s53, s44, 9
    s_add_u32 s53, s53, 150528
    v_add_u32 v3, s53, v3
    v_mov_b32 v1, 154624
    v_cndmask_b32 v3, v1, v3, vcc
    v_mov_b32 v4, v48
    s_waitcnt lgkmcnt(4)
    v_mfma_f32_32x32x16_bf16 v[80:95], v[20:23], v[160:163], v[80:95]
    s_add_u32 s65, s65, 1
    s_add_u32 s51, s51, 1
    s_cmp_eq_u32 s51, 3
    s_cselect_b32 s51, 0, s51
    s_cselect_b32 s68, 0xfffec000, s100
    ds_read_b128 v[20:23], v13 offset:16384
    s_lshl_b32 s58, s47, 9
    v_add_u32 v1, s58, v2
    ds_read2_b64 v[36:39], v1 offset0:0 offset1:2
    ds_read2_b64 v[40:43], v1 offset0:4 offset1:6
    s_waitcnt lgkmcnt(6)
    v_mfma_f32_32x32x16_bf16 v[80:95], v[24:27], v[164:167], v[80:95]
    ds_read_b128 v[24:27], v14 offset:16384
    s_waitcnt lgkmcnt(6)
    v_mfma_f32_32x32x16_bf16 v[80:95], v[28:31], v[168:171], v[80:95]
    s_cmp_lg_u32 s66, 0
    s_cbranch_scc0 k1_kernel_ckv_k22
    s_call_b64 s[4:5], k1_kernel_ckv_chk
k1_kernel_ckv_k22:
    ds_read_b128 v[28:31], v15 offset:16384
    s_waitcnt lgkmcnt(6)
    v_mfma_f32_32x32x16_bf16 v[80:95], v[32:35], v[172:175], v[80:95]
    ds_read_b128 v[32:35], v8 offset:24576
    s_waitcnt lgkmcnt(3)
    v_fma_f32 v64, v36, v4, v64
    v_fma_f32 v65, v38, v4, v65
    v_fma_f32 v66, v40, v4, v66
    v_fma_f32 v67, v42, v4, v67
    v_fma_f32 v64, v37, v64, v5
    v_fma_f32 v65, v39, v65, v5
    v_fma_f32 v66, v41, v66, v5
    v_fma_f32 v67, v43, v67, v5
    ds_read2_b64 v[36:39], v1 offset0:16 offset1:18
    v_mfma_f32_32x32x16_bf16 v[80:95], v[16:19], v[176:179], v[80:95]
    ds_read_b128 v[16:19], v9 offset:24576
    ds_read2_b64 v[40:43], v1 offset0:20 offset1:22
    v_exp_f32 v44, v64 clamp
    v_max_f32 v64, v6, v64
    v_exp_f32 v45, v65 clamp
    v_max_f32 v65, v6, v65
    v_exp_f32 v46, v66 clamp
    v_mfma_f32_32x32x16_bf16 v[80:95], v[20:23], v[180:183], v[80:95]
    ds_read_b128 v[20:23], v10 offset:24576
    v_max_f32 v66, v6, v66
    v_exp_f32 v47, v67 clamp
    v_max_f32 v67, v6, v67
    v_fma_f32 v64, v44, v7, v64
    v_fma_f32 v65, v45, v7, v65
    v_fma_f32 v66, v46, v7, v66
    v_fma_f32 v67, v47, v7, v67
    v_cvt_pk_bf16_f32 v64, v64, v65
    s_waitcnt lgkmcnt(6)
    v_mfma_f32_32x32x16_bf16 v[80:95], v[24:27], v[184:187], v[80:95]
    s_cmp_lg_u32 s66, 0
    s_cbranch_scc0 k1_kernel_ckv_k26
    s_call_b64 s[4:5], k1_kernel_ckv_chk
k1_kernel_ckv_k26:
    ds_read_b128 v[24:27], v11 offset:24576
    v_cvt_pk_bf16_f32 v65, v66, v67
    s_waitcnt lgkmcnt(2)
    v_fma_f32 v68, v36, v4, v68
    v_fma_f32 v69, v38, v4, v69
    v_fma_f32 v70, v40, v4, v70
    v_fma_f32 v71, v42, v4, v71
    v_fma_f32 v68, v37, v68, v5
    v_fma_f32 v69, v39, v69, v5
    v_fma_f32 v70, v41, v70, v5
    v_fma_f32 v71, v43, v71, v5
    v_mfma_f32_32x32x16_bf16 v[80:95], v[28:31], v[188:191], v[80:95]
    ds_read_b128 v[28:31], v12 offset:24576
    ds_read2_b64 v[36:39], v1 offset0:32 offset1:34
    ds_read2_b64 v[40:43], v1 offset0:36 offset1:38
    v_exp_f32 v44, v68 clamp
    v_max_f32 v68, v6, v68
    v_exp_f32 v45, v69 clamp
    v_max_f32 v69, v6, v69
    v_mfma_f32_32x32x16_bf16 v[80:95], v[32:35], v[192:195], v[80:95]
    ds_read_b128 v[32:35], v13 offset:24576
    v_exp_f32 v46, v70 clamp
    v_max_f32 v70, v6, v70
    v_exp_f32 v47, v71 clamp
    v_max_f32 v71, v6, v71
    v_fma_f32 v68, v44, v7, v68
    v_fma_f32 v69, v45, v7, v69
    v_fma_f32 v70, v46, v7, v70
    v_mfma_f32_32x32x16_bf16 v[80:95], v[16:19], v[196:199], v[80:95]
    ds_read_b128 v[16:19], v14 offset:24576
    v_fma_f32 v71, v47, v7, v71
    v_cvt_pk_bf16_f32 v66, v68, v69
    v_cvt_pk_bf16_f32 v67, v70, v71
    s_waitcnt lgkmcnt(2)
    v_fma_f32 v72, v36, v4, v72
    v_fma_f32 v73, v38, v4, v73
    v_fma_f32 v74, v40, v4, v74
    v_fma_f32 v75, v42, v4, v75
    v_fma_f32 v72, v37, v72, v5
    v_fma_f32 v73, v39, v73, v5
    v_mfma_f32_32x32x16_bf16 v[80:95], v[20:23], v[200:203], v[80:95]
    ds_read_b128 v[20:23], v15 offset:24576
    v_fma_f32 v74, v41, v74, v5
    v_fma_f32 v75, v43, v75, v5
    ds_read2_b64 v[36:39], v1 offset0:48 offset1:50
    ds_read2_b64 v[40:43], v1 offset0:52 offset1:54
    v_exp_f32 v44, v72 clamp
    v_max_f32 v72, v6, v72
    v_exp_f32 v45, v73 clamp
    v_mfma_f32_32x32x16_bf16 v[80:95], v[24:27], v[204:207], v[80:95]
    ds_read_b128 v[24:27], v8 offset:32768
    v_max_f32 v73, v6, v73
    v_exp_f32 v46, v74 clamp
    v_max_f32 v74, v6, v74
    v_exp_f32 v47, v75 clamp
    v_max_f32 v75, v6, v75
    v_fma_f32 v72, v44, v7, v72
    v_fma_f32 v73, v45, v7, v73
    v_mfma_f32_32x32x16_bf16 v[80:95], v[28:31], v[208:211], v[80:95]
    ds_read_b128 v[28:31], v9 offset:32768
    v_add_u32 v8, s68, v8
    v_fma_f32 v74, v46, v7, v74
    v_fma_f32 v75, v47, v7, v75
    v_cvt_pk_bf16_f32 v68, v72, v73
    v_cvt_pk_bf16_f32 v69, v74, v75
    s_waitcnt lgkmcnt(2)
    v_fma_f32 v76, v36, v4, v76
    v_fma_f32 v77, v38, v4, v77
    v_fma_f32 v78, v40, v4, v78
    v_fma_f32 v79, v42, v4, v79
    v_mfma_f32_32x32x16_bf16 v[80:95], v[32:35], v[212:215], v[80:95]
    ds_read_b128 v[32:35], v10 offset:32768
    v_add_u32 v9, s68, v9
    v_fma_f32 v76, v37, v76, v5
    v_fma_f32 v77, v39, v77, v5
    v_fma_f32 v78, v41, v78, v5
    v_fma_f32 v79, v43, v79, v5
    v_exp_f32 v44, v76 clamp
    v_max_f32 v76, v6, v76
    v_mfma_f32_32x32x16_bf16 v[80:95], v[16:19], v[216:219], v[80:95]
    ds_read_b128 v[16:19], v11 offset:32768
    v_add_u32 v10, s68, v10
    v_exp_f32 v45, v77 clamp
    v_max_f32 v77, v6, v77
    v_exp_f32 v46, v78 clamp
    v_max_f32 v78, v6, v78
    v_exp_f32 v47, v79 clamp
    v_mfma_f32_32x32x16_bf16 v[80:95], v[20:23], v[220:223], v[80:95]
    ds_read_b128 v[20:23], v12 offset:32768
    v_add_u32 v11, s68, v11
    v_max_f32 v79, v6, v79
    v_fma_f32 v76, v44, v7, v76
    v_fma_f32 v77, v45, v7, v77
    v_fma_f32 v78, v46, v7, v78
    v_fma_f32 v79, v47, v7, v79
    v_cvt_pk_bf16_f32 v70, v76, v77
    v_cvt_pk_bf16_f32 v71, v78, v79
    s_add_u32 s47, s47, 1
    s_cmp_ge_u32 s47, s46
    s_cselect_b32 s47, 0, s47
    s_waitcnt lgkmcnt(4)
    v_mfma_f32_32x32x16_bf16 v[80:95], v[24:27], v[224:227], v[80:95]
    ds_read_b128 v[24:27], v13 offset:32768
    v_add_u32 v12, s68, v12
    s_waitcnt lgkmcnt(4)
    v_mfma_f32_32x32x16_bf16 v[80:95], v[28:31], v[228:231], v[80:95]
    ds_read_b128 v[28:31], v14 offset:32768
    v_add_u32 v13, s68, v13
    s_waitcnt lgkmcnt(4)
    v_mfma_f32_32x32x16_bf16 v[80:95], v[32:35], v[232:235], v[80:95]
    ds_read_b128 v[32:35], v15 offset:32768
    v_add_u32 v14, s68, v14
    s_waitcnt lgkmcnt(4)
    v_mfma_f32_32x32x16_bf16 v[80:95], v[16:19], v[236:239], v[80:95]
    v_add_u32 v15, s68, v15
    s_waitcnt lgkmcnt(3)
    v_mfma_f32_32x32x16_bf16 v[80:95], v[20:23], v[240:243], v[80:95]
    s_cmp_lg_u32 s66, 0
    s_cbranch_scc1 k1_kernel_ckv_tbs
k1_kernel_ckv_tbd:
    s_waitcnt vmcnt(0)
    s_waitcnt lgkmcnt(0)
    s_barrier
    ds_read_b128 v[72:75], v3 offset:0
    ds_read_b128 v[76:79], v3 offset:256
    ds_read_b128 v[16:19], v8 offset:0
    ds_read_b128 v[20:23], v9 offset:0
    v_mfma_f32_32x32x16_bf16 v[80:95], v[24:27], v[244:247], v[80:95]
    ds_read_b128 v[24:27], v10 offset:0
    v_mfma_f32_32x32x16_bf16 v[80:95], v[28:31], v[248:251], v[80:95]
    ds_read_b128 v[28:31], v11 offset:0
    s_waitcnt lgkmcnt(5)
    v_cndmask_b32 v72, v72, v64, s[62:63]
    v_cndmask_b32 v73, v73, v65, s[62:63]
    v_cndmask_b32 v74, v74, v66, s[62:63]
    v_cndmask_b32 v75, v75, v67, s[62:63]
    v_mfma_f32_32x32x16_bf16 v[80:95], v[32:35], v[252:255], v[80:95]
    ds_read_b128 v[32:35], v12 offset:0
    s_waitcnt lgkmcnt(5)
    v_cndmask_b32 v76, v76, v68, s[62:63]
    v_cndmask_b32 v77, v77, v69, s[62:63]
    v_cndmask_b32 v78, v78, v70, s[62:63]
    v_cndmask_b32 v79, v79, v71, s[62:63]
    v_mfma_f32_32x32x16_bf16 v[48:63], v[72:75], v[64:67], 0
    s_nop 0
    v_mfma_f32_32x32x16_bf16 v[48:63], v[76:79], v[68:71], v[48:63]
    s_nop 3
k1_kernel_ckv_loop:
    s_waitcnt lgkmcnt(4)
    v_mfma_f32_32x32x16_bf16 v[64:79], v[16:19], v[96:99], 0
    ds_read_b128 v[16:19], v13 offset:0
    s_lshl_b32 s58, s47, 9
    v_add_u32 v1, s58, v2
    ds_read2_b64 v[36:39], v1 offset0:0 offset1:2
    ds_read2_b64 v[40:43], v1 offset0:4 offset1:6
    s_waitcnt lgkmcnt(6)
    v_mfma_f32_32x32x16_bf16 v[64:79], v[20:23], v[100:103], v[64:79]
    s_add_u32 s65, s65, 1
    s_add_u32 s51, s51, 1
    s_cmp_eq_u32 s51, 3
    s_cselect_b32 s51, 0, s51
    s_cselect_b32 s68, 0xfffec000, s100
    ds_read_b128 v[20:23], v14 offset:0
    s_waitcnt lgkmcnt(6)
    v_mfma_f32_32x32x16_bf16 v[64:79], v[24:27], v[104:107], v[64:79]
    ds_read_b128 v[24:27], v15 offset:0
    s_waitcnt lgkmcnt(6)
    v_mfma_f32_32x32x16_bf16 v[64:79], v[28:31], v[108:111], v[64:79]
    ds_read_b128 v[28:31], v8 offset:8192
    s_waitcnt lgkmcnt(3)
    v_fma_f32 v80, v36, v4, v80
    v_fma_f32 v81, v38, v4, v81
    v_fma_f32 v82, v40, v4, v82
    v_fma_f32 v83, v42, v4, v83
    v_mfma_f32_32x32x16_bf16 v[64:79], v[32:35], v[112:115], v[64:79]
    ds_read_b128 v[32:35], v9 offset:8192
    v_fma_f32 v80, v37, v80, v5
    v_fma_f32 v81, v39, v81, v5
    v_fma_f32 v82, v41, v82, v5
    v_fma_f32 v83, v43, v83, v5
    v_mfma_f32_32x32x16_bf16 v[64:79], v[16:19], v[116:119], v[64:79]
    ds_read_b128 v[16:19], v10 offset:8192
    ds_read2_b64 v[36:39], v1 offset0:16 offset1:18
    ds_read2_b64 v[40:43], v1 offset0:20 offset1:22
    v_exp_f32 v44, v80 clamp
    s_waitcnt lgkmcnt(6)
    v_mfma_f32_32x32x16_bf16 v[64:79], v[20:23], v[120:123], v[64:79]
    ds_read_b128 v[20:23], v11 offset:8192
    v_max_f32 v80, v6, v80
    v_exp_f32 v45, v81 clamp
    v_max_f32 v81, v6, v81
    s_waitcnt lgkmcnt(6)
    v_mfma_f32_32x32x16_bf16 v[64:79], v[24:27], v[124:127], v[64:79]
    ds_read_b128 v[24:27], v12 offset:8192
    v_exp_f32 v46, v82 clamp
    v_max_f32 v82, v6, v82
    s_waitcnt lgkmcnt(6)
    v_mfma_f32_32x32x16_bf16 v[64:79], v[28:31], v[128:131], v[64:79]
    ds_read_b128 v[28:31], v13 offset:8192
    v_exp_f32 v47, v83 clamp
    v_max_f32 v83, v6, v83
    v_fma_f32 v80, v44, v7, v80
    s_waitcnt lgkmcnt(6)
    v_mfma_f32_32x32x16_bf16 v[64:79], v[32:35], v[132:135], v[64:79]
    ds_read_b128 v[32:35], v14 offset:8192
    v_fma_f32 v81, v45, v7, v81
    v_fma_f32 v82, v46, v7, v82
    v_fma_f32 v83, v47, v7, v83
    v_cvt_pk_bf16_f32 v80, v80, v81
    s_waitcnt lgkmcnt(6)
    v_mfma_f32_32x32x16_bf16 v[64:79], v[16:19], v[136:139], v[64:79]
    ds_read_b128 v[16:19], v15 offset:8192
    v_cvt_pk_bf16_f32 v81, v82, v83
    s_waitcnt lgkmcnt(5)
    v_fma_f32 v84, v36, v4, v84
    v_fma_f32 v85, v38, v4, v85
    v_fma_f32 v86, v40, v4, v86
    s_waitcnt lgkmcnt(4)
    v_mfma_f32_32x32x16_bf16 v[64:79], v[20:23], v[140:143], v[64:79]
    ds_read_b128 v[20:23], v8 offset:16384
    v_fma_f32 v87, v42, v4, v87
    v_fma_f32 v84, v37, v84, v5
    v_fma_f32 v85, v39, v85, v5
    v_fma_f32 v86, v41, v86, v5
    s_waitcnt lgkmcnt(4)
    v_mfma_f32_32x32x16_bf16 v[64:79], v[24:27], v[144:147], v[64:79]
    ds_read_b128 v[24:27], v9 offset:16384
    v_fma_f32 v87, v43, v87, v5
    ds_read2_b64 v[36:39], v1 offset0:32 offset1:34
    ds_read2_b64 v[40:43], v1 offset0:36 offset1:38
    s_waitcnt lgkmcnt(6)
    v_mfma_f32_32x32x16_bf16 v[64:79], v[28:31], v[148:151], v[64:79]
    ds_read_b128 v[28:31], v10 offset:16384
    v_exp_f32 v44, v84 clamp
    v_max_f32 v84, v6, v84
    s_waitcnt lgkmcnt(6)
    v_mfma_f32_32x32x16_bf16 v[64:79], v[32:35], v[152:155], v[64:79]
    ds_read_b128 v[32:35], v11 offset:16384
    v_exp_f32 v45, v85 clamp
    v_max_f32 v85, v6, v85
    s_waitcnt lgkmcnt(6)
    v_mfma_f32_32x32x16_bf16 v[64:79], v[16:19], v[156:159], v[64:79]
    ds_read_b128 v[16:19], v12 offset:16384
    v_exp_f32 v46, v86 clamp
    v_max_f32 v86, v6, v86
    s_waitcnt lgkmcnt(6)
    v_mfma_f32_32x32x16_bf16 v[64:79], v[20:23], v[160:163], v[64:79]
    ds_read_b128 v[20:23], v13 offset:16384
    v_exp_f32 v47, v87 clamp
    v_max_f32 v87, v6, v87
    v_fma_f32 v84, v44, v7, v84
    s_waitcnt lgkmcnt(6)
    v_mfma_f32_32x32x16_bf16 v[64:79], v[24:27], v[164:167], v[64:79]
    ds_read_b128 v[24:27], v14 offset:16384
    v_fma_f32 v85, v45, v7, v85
    v_fma_f32 v86, v46, v7, v86
    v_fma_f32 v87, v47, v7, v87
    v_cvt_pk_bf16_f32 v82, v84, v85
    s_waitcnt lgkmcnt(4)
    v_mfma_f32_32x32x16_bf16 v[64:79], v[28:31], v[168:171], v[64:79]
    ds_read_b128 v[28:31], v15 offset:16384
    v_cvt_pk_bf16_f32 v83, v86, v87
    v_fma_f32 v88, v36, v4, v88
    v_fma_f32 v89, v38, v4, v89
    v_fma_f32 v90, v40, v4, v90
    s_waitcnt lgkmcnt(4)
    v_mfma_f32_32x32x16_bf16 v[64:79], v[32:35], v[172:175], v[64:79]
    ds_read_b128 v[32:35], v8 offset:24576
    v_fma_f32 v91, v42, v4, v91
    v_fma_f32 v88, v37, v88, v5
    v_fma_f32 v89, v39, v89, v5
    v_fma_f32 v90, v41, v90, v5
    s_waitcnt lgkmcnt(4)
    v_mfma_f32_32x32x16_bf16 v[64:79], v[16:19], v[176:179], v[64:79]
    ds_read_b128 v[16:19], v9 offset:24576
    v_fma_f32 v91, v43, v91, v5
    ds_read2_b64 v[36:39], v1 offset0:48 offset1:50
    ds_read2_b64 v[40:43], v1 offset0:52 offset1:54
    s_waitcnt lgkmcnt(6)
    v_mfma_f32_32x32x16_bf16 v[64:79], v[20:23], v[180:183], v[64:79]
    ds_read_b128 v[20:23], v10 offset:24576
    v_exp_f32 v44, v88 clamp
    v_max_f32 v88, v6, v88
    s_waitcnt lgkmcnt(6)
    v_mfma_f32_32x32x16_bf16 v[64:79], v[24:27], v[184:187], v[64:79]
    ds_read_b128 v[24:27], v11 offset:24576
    v_exp_f32 v45, v89 clamp
    v_max_f32 v89, v6, v89
    s_waitcnt lgkmcnt(6)
    v_mfma_f32_32x32x16_bf16 v[64:79], v[28:31], v[188:191], v[64:79]
    ds_read_b128 v[28:31], v12 offset:24576
    v_exp_f32 v46, v90 clamp
    v_max_f32 v90, v6, v90
    s_waitcnt lgkmcnt(6)
    v_mfma_f32_32x32x16_bf16 v[64:79], v[32:35], v[192:195], v[64:79]
    ds_read_b128 v[32:35], v13 offset:24576
    v_exp_f32 v47, v91 clamp
    v_max_f32 v91, v6, v91
    v_fma_f32 v88, v44, v7, v88
    s_waitcnt lgkmcnt(6)
    v_mfma_f32_32x32x16_bf16 v[64:79], v[16:19], v[196:199], v[64:79]
    ds_read_b128 v[16:19], v14 offset:24576
    v_fma_f32 v89, v45, v7, v89
    v_fma_f32 v90, v46, v7, v90
    v_fma_f32 v91, v47, v7, v91
    v_cvt_pk_bf16_f32 v84, v88, v89
    s_waitcnt lgkmcnt(4)
    v_mfma_f32_32x32x16_bf16 v[64:79], v[20:23], v[200:203], v[64:79]
    ds_read_b128 v[20:23], v15 offset:24576
    v_cvt_pk_bf16_f32 v85, v90, v91
    v_fma_f32 v92, v36, v4, v92
    v_fma_f32 v93, v38, v4, v93
    v_fma_f32 v94, v40, v4, v94
    s_waitcnt lgkmcnt(4)
    v_mfma_f32_32x32x16_bf16 v[64:79], v[24:27], v[204:207], v[64:79]
    ds_read_b128 v[24:27], v8 offset:32768
    v_fma_f32 v95, v42, v4, v95
    v_fma_f32 v92, v37, v92, v5
    v_fma_f32 v93, v39, v93, v5
    v_fma_f32 v94, v41, v94, v5
    s_waitcnt lgkmcnt(4)
    v_mfma_f32_32x32x16_bf16 v[64:79], v[28:31], v[208:211], v[64:79]
    ds_read_b128 v[28:31], v9 offset:32768
    v_add_u32 v8, s68, v8
    v_fma_f32 v95, v43, v95, v5
    v_exp_f32 v44, v92 clamp
    s_waitcnt lgkmcnt(4)
    v_mfma_f32_32x32x16_bf16 v[64:79], v[32:35], v[212:215], v[64:79]
    ds_read_b128 v[32:35], v10 offset:32768
    v_add_u32 v9, s68, v9
    v_max_f32 v92, v6, v92
    v_exp_f32 v45, v93 clamp
    s_waitcnt lgkmcnt(4)
    v_mfma_f32_32x32x16_bf16 v[64:79], v[16:19], v[216:219], v[64:79]
    ds_read_b128 v[16:19], v11 offset:32768
    v_add_u32 v10, s68, v10
    v_max_f32 v93, v6, v93
    v_exp_f32 v46, v94 clamp
    s_waitcnt lgkmcnt(4)
    v_mfma_f32_32x32x16_bf16 v[64:79], v[20:23], v[220:223], v[64:79]
    ds_read_b128 v[20:23], v12 offset:32768
    v_add_u32 v11, s68, v11
    v_max_f32 v94, v6, v94
    v_exp_f32 v47, v95 clamp
    s_waitcnt lgkmcnt(4)
    v_mfma_f32_32x32x16_bf16 v[64:79], v[24:27], v[224:227], v[64:79]
    ds_read_b128 v[24:27], v13 offset:32768
    v_add_u32 v12, s68, v12
    v_max_f32 v95, v6, v95
    v_fma_f32 v92, v44, v7, v92
    v_fma_f32 v93, v45, v7, v93
    s_waitcnt lgkmcnt(4)
    v_mfma_f32_32x32x16_bf16 v[64:79], v[28:31], v[228:231], v[64:79]
    ds_read_b128 v[28:31], v14 offset:32768
    v_add_u32 v13, s68, v13
    v_fma_f32 v94, v46, v7, v94
    v_fma_f32 v95, v47, v7, v95
    v_cvt_pk_bf16_f32 v86, v92, v93
    s_waitcnt lgkmcnt(4)
    v_mfma_f32_32x32x16_bf16 v[64:79], v[32:35], v[232:235], v[64:79]
    ds_read_b128 v[32:35], v15 offset:32768
    v_add_u32 v14, s68, v14
    v_cvt_pk_bf16_f32 v87, v94, v95
    s_add_u32 s47, s47, 1
    s_cmp_ge_u32 s47, s46
    s_cselect_b32 s47, 0, s47
    s_waitcnt lgkmcnt(4)
    v_mfma_f32_32x32x16_bf16 v[64:79], v[16:19], v[236:239], v[64:79]
    v_add_u32 v15, s68, v15
    s_waitcnt lgkmcnt(3)
    v_mfma_f32_32x32x16_bf16 v[64:79], v[20:23], v[240:243], v[64:79]
    s_waitcnt lgkmcnt(0)
    s_barrier
    ds_read_b128 v[88:91], v3 offset:2048
    ds_read_b128 v[92:95], v3 offset:2304
    ds_read_b128 v[16:19], v8 offset:0
    ds_read_b128 v[20:23], v9 offset:0
    v_mfma_f32_32x32x16_bf16 v[64:79], v[24:27], v[244:247], v[64:79]
    ds_read_b128 v[24:27], v10 offset:0
    v_mfma_f32_32x32x16_bf16 v[64:79], v[28:31], v[248:251], v[64:79]
    ds_read_b128 v[28:31], v11 offset:0
    s_waitcnt lgkmcnt(5)
    v_cndmask_b32 v88, v88, v80, s[62:63]
    v_cndmask_b32 v89, v89, v81, s[62:63]
    v_cndmask_b32 v90, v90, v82, s[62:63]
    v_cndmask_b32 v91, v91, v83, s[62:63]
    v_mfma_f32_32x32x16_bf16 v[64:79], v[32:35], v[252:255], v[64:79]
    ds_read_b128 v[32:35], v12 offset:0
    s_waitcnt lgkmcnt(5)
    v_cndmask_b32 v92, v92, v84, s[62:63]
    v_cndmask_b32 v93, v93, v85, s[62:63]
    v_cndmask_b32 v94, v94, v86, s[62:63]
    v_cndmask_b32 v95, v95, v87, s[62:63]
    v_mfma_f32_32x32x16_bf16 v[48:63], v[88:91], v[80:83], v[48:63]
    s_nop 0
    v_mfma_f32_32x32x16_bf16 v[48:63], v[92:95], v[84:87], v[48:63]
    s_cmp_ge_u32 s65, s46
    s_cbranch_scc1 k1_kernel_ckv_fin0
    s_waitcnt lgkmcnt(4)
    v_mfma_f32_32x32x16_bf16 v[80:95], v[16:19], v[96:99], 0
    ds_read_b128 v[16:19], v13 offset:0
    s_lshl_b32 s58, s47, 9
    v_add_u32 v1, s58, v2
    ds_read2_b64 v[36:39], v1 offset0:0 offset1:2
    ds_read2_b64 v[40:43], v1 offset0:4 offset1:6
    s_waitcnt lgkmcnt(6)
    v_mfma_f32_32x32x16_bf16 v[80:95], v[20:23], v[100:103], v[80:95]
    s_add_u32 s65, s65, 1
    s_add_u32 s51, s51, 1
    s_cmp_eq_u32 s51, 3
    s_cselect_b32 s51, 0, s51
    s_cselect_b32 s68, 0xfffec000, s100
    ds_read_b128 v[20:23], v14 offset:0
    s_waitcnt lgkmcnt(6)
    v_mfma_f32_32x32x16_bf16 v[80:95], v[24:27], v[104:107], v[80:95]
    ds_read_b128 v[24:27], v15 offset:0
    s_waitcnt lgkmcnt(6)
    v_mfma_f32_32x32x16_bf16 v[80:95], v[28:31], v[108:111], v[80:95]
    ds_read_b128 v[28:31], v8 offset:8192
    s_waitcnt lgkmcnt(3)
    v_fma_f32 v64, v36, v4, v64
    v_fma_f32 v65, v38, v4, v65
    v_fma_f32 v66, v40, v4, v66
    v_fma_f32 v67, v42, v4, v67
    v_mfma_f32_32x32x16_bf16 v[80:95], v[32:35], v[112:115], v[80:95]
    ds_read_b128 v[32:35], v9 offset:8192
    v_fma_f32 v64, v37, v64, v5
    v_fma_f32 v65, v39, v65, v5
    v_fma_f32 v66, v41, v66, v5
    v_fma_f32 v67, v43, v67, v5
    v_mfma_f32_32x32x16_bf16 v[80:95], v[16:19], v[116:119], v[80:95]
    ds_read_b128 v[16:19], v10 offset:8192
    ds_read2_b64 v[36:39], v1 offset0:16 offset1:18
    ds_read2_b64 v[40:43], v1 offset0:20 offset1:22
    v_exp_f32 v44, v64 clamp
    s_waitcnt lgkmcnt(6)
    v_mfma_f32_32x32x16_bf16 v[80:95], v[20:23], v[120:123], v[80:95]
    ds_read_b128 v[20:23], v11 offset:8192
    v_max_f32 v64, v6, v64
    v_exp_f32 v45, v65 clamp
    v_max_f32 v65, v6, v65
    s_waitcnt lgkmcnt(6)
    v_mfma_f32_32x32x16_bf16 v[80:95], v[24:27], v[124:127], v[80:95]
    ds_read_b128 v[24:27], v12 offset:8192
    v_exp_f32 v46, v66 clamp
    v_max_f32 v66, v6, v66
    s_waitcnt lgkmcnt(6)
    v_mfma_f32_32x32x16_bf16 v[80:95], v[28:31], v[128:131], v[80:95]
    ds_read_b128 v[28:31], v13 offset:8192
    v_exp_f32 v47, v67 clamp
    v_max_f32 v67, v6, v67
    v_fma_f32 v64, v44, v7, v64
    s_waitcnt lgkmcnt(6)
    v_mfma_f32_32x32x16_bf16 v[80:95], v[32:35], v[132:135], v[80:95]
    ds_read_b128 v[32:35], v14 offset:8192
    v_fma_f32 v65, v45, v7, v65
    v_fma_f32 v66, v46, v7, v66
    v_fma_f32 v67, v47, v7, v67
    v_cvt_pk_bf16_f32 v64, v64, v65
    s_waitcnt lgkmcnt(6)
    v_mfma_f32_32x32x16_bf16 v[80:95], v[16:19], v[136:139], v[80:95]
    ds_read_b128 v[16:19], v15 offset:8192
    v_cvt_pk_bf16_f32 v65, v66, v67
    s_waitcnt lgkmcnt(5)
    v_fma_f32 v68, v36, v4, v68
    v_fma_f32 v69, v38, v4, v69
    v_fma_f32 v70, v40, v4, v70
    s_waitcnt lgkmcnt(4)
    v_mfma_f32_32x32x16_bf16 v[80:95], v[20:23], v[140:143], v[80:95]
    ds_read_b128 v[20:23], v8 offset:16384
    v_fma_f32 v71, v42, v4, v71
    v_fma_f32 v68, v37, v68, v5
    v_fma_f32 v69, v39, v69, v5
    v_fma_f32 v70, v41, v70, v5
    s_waitcnt lgkmcnt(4)
    v_mfma_f32_32x32x16_bf16 v[80:95], v[24:27], v[144:147], v[80:95]
    ds_read_b128 v[24:27], v9 offset:16384
    v_fma_f32 v71, v43, v71, v5
    ds_read2_b64 v[36:39], v1 offset0:32 offset1:34
    ds_read2_b64 v[40:43], v1 offset0:36 offset1:38
    s_waitcnt lgkmcnt(6)
    v_mfma_f32_32x32x16_bf16 v[80:95], v[28:31], v[148:151], v[80:95]
    ds_read_b128 v[28:31], v10 offset:16384
    v_exp_f32 v44, v68 clamp
    v_max_f32 v68, v6, v68
    s_waitcnt lgkmcnt(6)
    v_mfma_f32_32x32x16_bf16 v[80:95], v[32:35], v[152:155], v[80:95]
    ds_read_b128 v[32:35], v11 offset:16384
    v_exp_f32 v45, v69 clamp
    v_max_f32 v69, v6, v69
    s_waitcnt lgkmcnt(6)
    v_mfma_f32_32x32x16_bf16 v[80:95], v[16:19], v[156:159], v[80:95]
    ds_read_b128 v[16:19], v12 offset:16384
    v_exp_f32 v46, v70 clamp
    v_max_f32 v70, v6, v70
    s_waitcnt lgkmcnt(6)
    v_mfma_f32_32x32x16_bf16 v[80:95], v[20:23], v[160:163], v[80:95]
    ds_read_b128 v[20:23], v13 offset:16384
    v_exp_f32 v47, v71 clamp
    v_max_f32 v71, v6, v71
    v_fma_f32 v68, v44, v7, v68
    s_waitcnt lgkmcnt(6)
    v_mfma_f32_32x32x16_bf16 v[80:95], v[24:27], v[164:167], v[80:95]
    ds_read_b128 v[24:27], v14 offset:16384
    v_fma_f32 v69, v45, v7, v69
    v_fma_f32 v70, v46, v7, v70
    v_fma_f32 v71, v47, v7, v71
    v_cvt_pk_bf16_f32 v66, v68, v69
    s_waitcnt lgkmcnt(4)
    v_mfma_f32_32x32x16_bf16 v[80:95], v[28:31], v[168:171], v[80:95]
    ds_read_b128 v[28:31], v15 offset:16384
    v_cvt_pk_bf16_f32 v67, v70, v71
    v_fma_f32 v72, v36, v4, v72
    v_fma_f32 v73, v38, v4, v73
    v_fma_f32 v74, v40, v4, v74
    s_waitcnt lgkmcnt(4)
    v_mfma_f32_32x32x16_bf16 v[80:95], v[32:35], v[172:175], v[80:95]
    ds_read_b128 v[32:35], v8 offset:24576
    v_fma_f32 v75, v42, v4, v75
    v_fma_f32 v72, v37, v72, v5
    v_fma_f32 v73, v39, v73, v5
    v_fma_f32 v74, v41, v74, v5
    s_waitcnt lgkmcnt(4)
    v_mfma_f32_32x32x16_bf16 v[80:95], v[16:19], v[176:179], v[80:95]
    ds_read_b128 v[16:19], v9 offset:24576
    v_fma_f32 v75, v43, v75, v5
    ds_read2_b64 v[36:39], v1 offset0:48 offset1:50
    ds_read2_b64 v[40:43], v1 offset0:52 offset1:54
    s_waitcnt lgkmcnt(6)
    v_mfma_f32_32x32x16_bf16 v[80:95], v[20:23], v[180:183], v[80:95]
    ds_read_b128 v[20:23], v10 offset:24576
    v_exp_f32 v44, v72 clamp
    v_max_f32 v72, v6, v72
    s_waitcnt lgkmcnt(6)
    v_mfma_f32_32x32x16_bf16 v[80:95], v[24:27], v[184:187], v[80:95]
    ds_read_b128 v[24:27], v11 offset:24576
    v_exp_f32 v45, v73 clamp
    v_max_f32 v73, v6, v73
    s_waitcnt lgkmcnt(6)
    v_mfma_f32_32x32x16_bf16 v[80:95], v[28:31], v[188:191], v[80:95]
    ds_read_b128 v[28:31], v12 offset:24576
    v_exp_f32 v46, v74 clamp
    v_max_f32 v74, v6, v74
    s_waitcnt lgkmcnt(6)
    v_mfma_f32_32x32x16_bf16 v[80:95], v[32:35], v[192:195], v[80:95]
    ds_read_b128 v[32:35], v13 offset:24576
    v_exp_f32 v47, v75 clamp
    v_max_f32 v75, v6, v75
    v_fma_f32 v72, v44, v7, v72
    s_waitcnt lgkmcnt(6)
    v_mfma_f32_32x32x16_bf16 v[80:95], v[16:19], v[196:199], v[80:95]
    ds_read_b128 v[16:19], v14 offset:24576
    v_fma_f32 v73, v45, v7, v73
    v_fma_f32 v74, v46, v7, v74
    v_fma_f32 v75, v47, v7, v75
    v_cvt_pk_bf16_f32 v68, v72, v73
    s_waitcnt lgkmcnt(4)
    v_mfma_f32_32x32x16_bf16 v[80:95], v[20:23], v[200:203], v[80:95]
    ds_read_b128 v[20:23], v15 offset:24576
    v_cvt_pk_bf16_f32 v69, v74, v75
    v_fma_f32 v76, v36, v4, v76
    v_fma_f32 v77, v38, v4, v77
    v_fma_f32 v78, v40, v4, v78
    s_waitcnt lgkmcnt(4)
    v_mfma_f32_32x32x16_bf16 v[80:95], v[24:27], v[204:207], v[80:95]
    ds_read_b128 v[24:27], v8 offset:32768
    v_fma_f32 v79, v42, v4, v79
    v_fma_f32 v76, v37, v76, v5
    v_fma_f32 v77, v39, v77, v5
    v_fma_f32 v78, v41, v78, v5
    s_waitcnt lgkmcnt(4)
    v_mfma_f32_32x32x16_bf16 v[80:95], v[28:31], v[208:211], v[80:95]
    ds_read_b128 v[28:31], v9 offset:32768
    v_add_u32 v8, s68, v8
    v_fma_f32 v79, v43, v79, v5
    v_exp_f32 v44, v76 clamp
    s_waitcnt lgkmcnt(4)
    v_mfma_f32_32x32x16_bf16 v[80:95], v[32:35], v[212:215], v[80:95]
    ds_read_b128 v[32:35], v10 offset:32768
    v_add_u32 v9, s68, v9
    v_max_f32 v76, v6, v76
    v_exp_f32 v45, v77 clamp
    s_waitcnt lgkmcnt(4)
    v_mfma_f32_32x32x16_bf16 v[80:95], v[16:19], v[216:219], v[80:95]
    ds_read_b128 v[16:19], v11 offset:32768
    v_add_u32 v10, s68, v10
    v_max_f32 v77, v6, v77
    v_exp_f32 v46, v78 clamp
    s_waitcnt lgkmcnt(4)
    v_mfma_f32_32x32x16_bf16 v[80:95], v[20:23], v[220:223], v[80:95]
    ds_read_b128 v[20:23], v12 offset:32768
    v_add_u32 v11, s68, v11
    v_max_f32 v78, v6, v78
    v_exp_f32 v47, v79 clamp
    s_waitcnt lgkmcnt(4)
    v_mfma_f32_32x32x16_bf16 v[80:95], v[24:27], v[224:227], v[80:95]
    ds_read_b128 v[24:27], v13 offset:32768
    v_add_u32 v12, s68, v12
    v_max_f32 v79, v6, v79
    v_fma_f32 v76, v44, v7, v76
    v_fma_f32 v77, v45, v7, v77
    s_waitcnt lgkmcnt(4)
    v_mfma_f32_32x32x16_bf16 v[80:95], v[28:31], v[228:231], v[80:95]
    ds_read_b128 v[28:31], v14 offset:32768
    v_add_u32 v13, s68, v13
    v_fma_f32 v78, v46, v7, v78
    v_fma_f32 v79, v47, v7, v79
    v_cvt_pk_bf16_f32 v70, v76, v77
    s_waitcnt lgkmcnt(4)
    v_mfma_f32_32x32x16_bf16 v[80:95], v[32:35], v[232:235], v[80:95]
    ds_read_b128 v[32:35], v15 offset:32768
    v_add_u32 v14, s68, v14
    v_cvt_pk_bf16_f32 v71, v78, v79
    s_add_u32 s47, s47, 1
    s_cmp_ge_u32 s47, s46
    s_cselect_b32 s47, 0, s47
    s_waitcnt lgkmcnt(4)
    v_mfma_f32_32x32x16_bf16 v[80:95], v[16:19], v[236:239], v[80:95]
    v_add_u32 v15, s68, v15
    s_waitcnt lgkmcnt(3)
    v_mfma_f32_32x32x16_bf16 v[80:95], v[20:23], v[240:243], v[80:95]
    s_waitcnt lgkmcnt(0)
    s_barrier
    ds_read_b128 v[72:75], v3 offset:0
    ds_read_b128 v[76:79], v3 offset:256
    ds_read_b128 v[16:19], v8 offset:0
    ds_read_b128 v[20:23], v9 offset:0
    v_mfma_f32_32x32x16_bf16 v[80:95], v[24:27], v[244:247], v[80:95]
    ds_read_b128 v[24:27], v10 offset:0
    v_mfma_f32_32x32x16_bf16 v[80:95], v[28:31], v[248:251], v[80:95]
    ds_read_b128 v[28:31], v11 offset:0
    s_waitcnt lgkmcnt(5)
    v_cndmask_b32 v72, v72, v64, s[62:63]
    v_cndmask_b32 v73, v73, v65, s[62:63]
    v_cndmask_b32 v74, v74, v66, s[62:63]
    v_cndmask_b32 v75, v75, v67, s[62:63]
    v_mfma_f32_32x32x16_bf16 v[80:95], v[32:35], v[252:255], v[80:95]
    ds_read_b128 v[32:35], v12 offset:0
    s_waitcnt lgkmcnt(5)
    v_cndmask_b32 v76, v76, v68, s[62:63]
    v_cndmask_b32 v77, v77, v69, s[62:63]
    v_cndmask_b32 v78, v78, v70, s[62:63]
    v_cndmask_b32 v79, v79, v71, s[62:63]
    v_mfma_f32_32x32x16_bf16 v[48:63], v[72:75], v[64:67], v[48:63]
    s_nop 0
    v_mfma_f32_32x32x16_bf16 v[48:63], v[76:79], v[68:71], v[48:63]
    s_cmp_lt_u32 s65, s46
    s_cbranch_scc1 k1_kernel_ckv_loop
    v_mbcnt_lo_u32_b32 v0, -1, 0
    v_mbcnt_hi_u32_b32 v0, -1, v0
    s_nop 7
    s_waitcnt lgkmcnt(0)
    s_lshl_b32 s58, s47, 9
    v_add_u32 v1, s58, v2
    ds_read2_b64 v[36:39], v1 offset0:0 offset1:2
    ds_read2_b64 v[40:43], v1 offset0:4 offset1:6
    s_waitcnt lgkmcnt(0)
    v_fma_f32 v80, v36, v4, v80
    v_fma_f32 v81, v38, v4, v81
    v_fma_f32 v82, v40, v4, v82
    v_fma_f32 v83, v42, v4, v83
    v_fma_f32 v80, v37, v80, v5
    v_fma_f32 v81, v39, v81, v5
    v_fma_f32 v82, v41, v82, v5
    v_fma_f32 v83, v43, v83, v5
    ds_read2_b64 v[36:39], v1 offset0:16 offset1:18
    ds_read2_b64 v[40:43], v1 offset0:20 offset1:22
    v_exp_f32 v44, v80 clamp
    v_max_f32 v80, v6, v80
    v_exp_f32 v45, v81 clamp
    v_max_f32 v81, v6, v81
    v_exp_f32 v46, v82 clamp
    v_max_f32 v82, v6, v82
    v_exp_f32 v47, v83 clamp
    v_max_f32 v83, v6, v83
    v_fma_f32 v80, v44, v7, v80
    v_fma_f32 v81, v45, v7, v81
    v_fma_f32 v82, v46, v7, v82
    v_fma_f32 v83, v47, v7, v83
    v_cvt_pk_bf16_f32 v80, v80, v81
    v_cvt_pk_bf16_f32 v81, v82, v83
    s_waitcnt lgkmcnt(0)
    v_fma_f32 v84, v36, v4, v84
    v_fma_f32 v85, v38, v4, v85
    v_fma_f32 v86, v40, v4, v86
    v_fma_f32 v87, v42, v4, v87
    v_fma_f32 v84, v37, v84, v5
    v_fma_f32 v85, v39, v85, v5
    v_fma_f32 v86, v41, v86, v5
    v_fma_f32 v87, v43, v87, v5
    ds_read2_b64 v[36:39], v1 offset0:32 offset1:34
    ds_read2_b64 v[40:43], v1 offset0:36 offset1:38
    v_exp_f32 v44, v84 clamp
    v_max_f32 v84, v6, v84
    v_exp_f32 v45, v85 clamp
    v_max_f32 v85, v6, v85
    v_exp_f32 v46, v86 clamp
    v_max_f32 v86, v6, v86
    v_exp_f32 v47, v87 clamp
    v_max_f32 v87, v6, v87
    v_fma_f32 v84, v44, v7, v84
    v_fma_f32 v85, v45, v7, v85
    v_fma_f32 v86, v46, v7, v86
    v_fma_f32 v87, v47, v7, v87
    v_cvt_pk_bf16_f32 v82, v84, v85
    v_cvt_pk_bf16_f32 v83, v86, v87
    s_waitcnt lgkmcnt(0)
    v_fma_f32 v88, v36, v4, v88
    v_fma_f32 v89, v38, v4, v89
    v_fma_f32 v90, v40, v4, v90
    v_fma_f32 v91, v42, v4, v91
    v_fma_f32 v88, v37, v88, v5
    v_fma_f32 v89, v39, v89, v5
    v_fma_f32 v90, v41, v90, v5
    v_fma_f32 v91, v43, v91, v5
    ds_read2_b64 v[36:39], v1 offset0:48 offset1:50
    ds_read2_b64 v[40:43], v1 offset0:52 offset1:54
    v_exp_f32 v44, v88 clamp
    v_max_f32 v88, v6, v88
    v_exp_f32 v45, v89 clamp
    v_max_f32 v89, v6, v89
    v_exp_f32 v46, v90 clamp
    v_max_f32 v90, v6, v90
    v_exp_f32 v47, v91 clamp
    v_max_f32 v91, v6, v91
    v_fma_f32 v88, v44, v7, v88
    v_fma_f32 v89, v45, v7, v89
    v_fma_f32 v90, v46, v7, v90
    v_fma_f32 v91, v47, v7, v91
    v_cvt_pk_bf16_f32 v84, v88, v89
    v_cvt_pk_bf16_f32 v85, v90, v91
    s_waitcnt lgkmcnt(0)
    v_fma_f32 v92, v36, v4, v92
    v_fma_f32 v93, v38, v4, v93
    v_fma_f32 v94, v40, v4, v94
    v_fma_f32 v95, v42, v4, v95
    v_fma_f32 v92, v37, v92, v5
    v_fma_f32 v93, v39, v93, v5
    v_fma_f32 v94, v41, v94, v5
    v_fma_f32 v95, v43, v95, v5
    v_exp_f32 v44, v92 clamp
    v_max_f32 v92, v6, v92
    v_exp_f32 v45, v93 clamp
    v_max_f32 v93, v6, v93
    v_exp_f32 v46, v94 clamp
    v_max_f32 v94, v6, v94
    v_exp_f32 v47, v95 clamp
    v_max_f32 v95, v6, v95
    v_fma_f32 v92, v44, v7, v92
    v_fma_f32 v93, v45, v7, v93
    v_fma_f32 v94, v46, v7, v94
    v_fma_f32 v95, v47, v7, v95
    v_cvt_pk_bf16_f32 v86, v92, v93
    v_cvt_pk_bf16_f32 v87, v94, v95
    s_add_u32 s47, s47, 1
    s_cmp_ge_u32 s47, s46
    s_cselect_b32 s47, 0, s47
    s_barrier
    ds_read_b128 v[88:91], v3 offset:2048
    ds_read_b128 v[92:95], v3 offset:2304
    s_waitcnt lgkmcnt(1)
    v_cndmask_b32 v88, v88, v80, s[62:63]
    v_cndmask_b32 v89, v89, v81, s[62:63]
    v_cndmask_b32 v90, v90, v82, s[62:63]
    v_cndmask_b32 v91, v91, v83, s[62:63]
    s_nop 1
    v_mfma_f32_32x32x16_bf16 v[48:63], v[88:91], v[80:83], v[48:63]
    s_waitcnt lgkmcnt(0)
    v_cndmask_b32 v92, v92, v84, s[62:63]
    v_cndmask_b32 v93, v93, v85, s[62:63]
    v_cndmask_b32 v94, v94, v86, s[62:63]
    v_cndmask_b32 v95, v95, v87, s[62:63]
    s_nop 1
    v_mfma_f32_32x32x16_bf16 v[48:63], v[92:95], v[84:87], v[48:63]
    v_and_b32 v1, 31, v0
    v_lshrrev_b32 v2, 5, v0
    v_mul_u32_u24 v3, 320, v2
    v_lshl_add_u32 v3, v1, 2, v3
    s_lshl_b32 s53, s49, 2
    s_add_u32 s53, s53, s44
    s_mul_i32 s53, s53, 1680
    s_add_u32 s53, s53, 12767184
    v_mov_b32 v4, 0x40000000
    v_cndmask_b32 v3, v3, v4, s[62:63]
    v_cmp_eq_u32 vcc, 1, v2
    s_nop 1
    v_cndmask_b32 v5, v3, v4, vcc
    v_mov_b32 v6, 0x3ef5fdf0
    v_mov_b32 v7, 0x3f317218
    v_cndmask_b32 v7, v6, v7, vcc
    s_nop 7
    v_mul_f32 v48, v6, v48
    buffer_atomic_add_f32 v48, v3, s[32:35], s53 offen offset:0 sc0 sc1
    v_mul_f32 v49, v6, v49
    buffer_atomic_add_f32 v49, v3, s[32:35], s53 offen offset:80 sc0 sc1
    v_mul_f32 v50, v6, v50
    buffer_atomic_add_f32 v50, v3, s[32:35], s53 offen offset:160 sc0 sc1
    v_mul_f32 v51, v6, v51
    buffer_atomic_add_f32 v51, v3, s[32:35], s53 offen offset:240 sc0 sc1
    v_mul_f32 v52, v6, v52
    buffer_atomic_add_f32 v52, v3, s[32:35], s53 offen offset:640 sc0 sc1
    v_mul_f32 v53, v6, v53
    buffer_atomic_add_f32 v53, v3, s[32:35], s53 offen offset:720 sc0 sc1
    v_mul_f32 v54, v6, v54
    buffer_atomic_add_f32 v54, v3, s[32:35], s53 offen offset:800 sc0 sc1
    v_mul_f32 v55, v6, v55
    buffer_atomic_add_f32 v55, v3, s[32:35], s53 offen offset:880 sc0 sc1
    v_mul_f32 v56, v7, v56
    buffer_atomic_add_f32 v56, v3, s[32:35], s53 offen offset:1280 sc0 sc1
    v_mul_f32 v57, v6, v57
    buffer_atomic_add_f32 v57, v5, s[32:35], s53 offen offset:1360 sc0 sc1
    v_mul_f32 v58, v6, v58
    buffer_atomic_add_f32 v58, v5, s[32:35], s53 offen offset:1440 sc0 sc1
    v_mul_f32 v59, v6, v59
    buffer_atomic_add_f32 v59, v5, s[32:35], s53 offen offset:1520 sc0 sc1
    s_mov_b32 s37, 1
    s_nop 1
    s_branch k1_kernel_y
k1_kernel_ckv_fin0:
    v_mbcnt_lo_u32_b32 v0, -1, 0
    v_mbcnt_hi_u32_b32 v0, -1, v0
    s_nop 7
    s_waitcnt lgkmcnt(0)
    s_lshl_b32 s58, s47, 9
    v_add_u32 v1, s58, v2
    ds_read2_b64 v[36:39], v1 offset0:0 offset1:2
    ds_read2_b64 v[40:43], v1 offset0:4 offset1:6
    s_waitcnt lgkmcnt(0)
    v_fma_f32 v64, v36, v4, v64
    v_fma_f32 v65, v38, v4, v65
    v_fma_f32 v66, v40, v4, v66
    v_fma_f32 v67, v42, v4, v67
    v_fma_f32 v64, v37, v64, v5
    v_fma_f32 v65, v39, v65, v5
    v_fma_f32 v66, v41, v66, v5
    v_fma_f32 v67, v43, v67, v5
    ds_read2_b64 v[36:39], v1 offset0:16 offset1:18
    ds_read2_b64 v[40:43], v1 offset0:20 offset1:22
    v_exp_f32 v44, v64 clamp
    v_max_f32 v64, v6, v64
    v_exp_f32 v45, v65 clamp
    v_max_f32 v65, v6, v65
    v_exp_f32 v46, v66 clamp
    v_max_f32 v66, v6, v66
    v_exp_f32 v47, v67 clamp
    v_max_f32 v67, v6, v67
    v_fma_f32 v64, v44, v7, v64
    v_fma_f32 v65, v45, v7, v65
    v_fma_f32 v66, v46, v7, v66
    v_fma_f32 v67, v47, v7, v67
    v_cvt_pk_bf16_f32 v64, v64, v65
    v_cvt_pk_bf16_f32 v65, v66, v67
    s_waitcnt lgkmcnt(0)
    v_fma_f32 v68, v36, v4, v68
    v_fma_f32 v69, v38, v4, v69
    v_fma_f32 v70, v40, v4, v70
    v_fma_f32 v71, v42, v4, v71
    v_fma_f32 v68, v37, v68, v5
    v_fma_f32 v69, v39, v69, v5
    v_fma_f32 v70, v41, v70, v5
    v_fma_f32 v71, v43, v71, v5
    ds_read2_b64 v[36:39], v1 offset0:32 offset1:34
    ds_read2_b64 v[40:43], v1 offset0:36 offset1:38
    v_exp_f32 v44, v68 clamp
    v_max_f32 v68, v6, v68
    v_exp_f32 v45, v69 clamp
    v_max_f32 v69, v6, v69
    v_exp_f32 v46, v70 clamp
    v_max_f32 v70, v6, v70
    v_exp_f32 v47, v71 clamp
    v_max_f32 v71, v6, v71
    v_fma_f32 v68, v44, v7, v68
    v_fma_f32 v69, v45, v7, v69
    v_fma_f32 v70, v46, v7, v70
    v_fma_f32 v71, v47, v7, v71
    v_cvt_pk_bf16_f32 v66, v68, v69
    v_cvt_pk_bf16_f32 v67, v70, v71
    s_waitcnt lgkmcnt(0)
    v_fma_f32 v72, v36, v4, v72
    v_fma_f32 v73, v38, v4, v73
    v_fma_f32 v74, v40, v4, v74
    v_fma_f32 v75, v42, v4, v75
    v_fma_f32 v72, v37, v72, v5
    v_fma_f32 v73, v39, v73, v5
    v_fma_f32 v74, v41, v74, v5
    v_fma_f32 v75, v43, v75, v5
    ds_read2_b64 v[36:39], v1 offset0:48 offset1:50
    ds_read2_b64 v[40:43], v1 offset0:52 offset1:54
    v_exp_f32 v44, v72 clamp
    v_max_f32 v72, v6, v72
    v_exp_f32 v45, v73 clamp
    v_max_f32 v73, v6, v73
    v_exp_f32 v46, v74 clamp
    v_max_f32 v74, v6, v74
    v_exp_f32 v47, v75 clamp
    v_max_f32 v75, v6, v75
    v_fma_f32 v72, v44, v7, v72
    v_fma_f32 v73, v45, v7, v73
    v_fma_f32 v74, v46, v7, v74
    v_fma_f32 v75, v47, v7, v75
    v_cvt_pk_bf16_f32 v68, v72, v73
    v_cvt_pk_bf16_f32 v69, v74, v75
    s_waitcnt lgkmcnt(0)
    v_fma_f32 v76, v36, v4, v76
    v_fma_f32 v77, v38, v4, v77
    v_fma_f32 v78, v40, v4, v78
    v_fma_f32 v79, v42, v4, v79
    v_fma_f32 v76, v37, v76, v5
    v_fma_f32 v77, v39, v77, v5
    v_fma_f32 v78, v41, v78, v5
    v_fma_f32 v79, v43, v79, v5
    v_exp_f32 v44, v76 clamp
    v_max_f32 v76, v6, v76
    v_exp_f32 v45, v77 clamp
    v_max_f32 v77, v6, v77
    v_exp_f32 v46, v78 clamp
    v_max_f32 v78, v6, v78
    v_exp_f32 v47, v79 clamp
    v_max_f32 v79, v6, v79
    v_fma_f32 v76, v44, v7, v76
    v_fma_f32 v77, v45, v7, v77
    v_fma_f32 v78, v46, v7, v78
    v_fma_f32 v79, v47, v7, v79
    v_cvt_pk_bf16_f32 v70, v76, v77
    v_cvt_pk_bf16_f32 v71, v78, v79
    s_add_u32 s47, s47, 1
    s_cmp_ge_u32 s47, s46
    s_cselect_b32 s47, 0, s47
    s_barrier
    ds_read_b128 v[72:75], v3 offset:0
    ds_read_b128 v[76:79], v3 offset:256
    s_waitcnt lgkmcnt(1)
    v_cndmask_b32 v72, v72, v64, s[62:63]
    v_cndmask_b32 v73, v73, v65, s[62:63]
    v_cndmask_b32 v74, v74, v66, s[62:63]
    v_cndmask_b32 v75, v75, v67, s[62:63]
    s_nop 1
    v_mfma_f32_32x32x16_bf16 v[48:63], v[72:75], v[64:67], v[48:63]
    s_waitcnt lgkmcnt(0)
    v_cndmask_b32 v76, v76, v68, s[62:63]
    v_cndmask_b32 v77, v77, v69, s[62:63]
    v_cndmask_b32 v78, v78, v70, s[62:63]
    v_cndmask_b32 v79, v79, v71, s[62:63]
    s_nop 1
    v_mfma_f32_32x32x16_bf16 v[48:63], v[76:79], v[68:71], v[48:63]
    v_and_b32 v1, 31, v0
    v_lshrrev_b32 v2, 5, v0
    v_mul_u32_u24 v3, 320, v2
    v_lshl_add_u32 v3, v1, 2, v3
    s_lshl_b32 s53, s49, 2
    s_add_u32 s53, s53, s44
    s_mul_i32 s53, s53, 1680
    s_add_u32 s53, s53, 12767184
    v_mov_b32 v4, 0x40000000
    v_cndmask_b32 v3, v3, v4, s[62:63]
    v_cmp_eq_u32 vcc, 1, v2
    s_nop 1
    v_cndmask_b32 v5, v3, v4, vcc
    v_mov_b32 v6, 0x3ef5fdf0
    v_mov_b32 v7, 0x3f317218
    v_cndmask_b32 v7, v6, v7, vcc
    s_nop 7
    v_mul_f32 v48, v6, v48
    buffer_atomic_add_f32 v48, v3, s[32:35], s53 offen offset:0 sc0 sc1
    v_mul_f32 v49, v6, v49
    buffer_atomic_add_f32 v49, v3, s[32:35], s53 offen offset:80 sc0 sc1
    v_mul_f32 v50, v6, v50
    buffer_atomic_add_f32 v50, v3, s[32:35], s53 offen offset:160 sc0 sc1
    v_mul_f32 v51, v6, v51
    buffer_atomic_add_f32 v51, v3, s[32:35], s53 offen offset:240 sc0 sc1
    v_mul_f32 v52, v6, v52
    buffer_atomic_add_f32 v52, v3, s[32:35], s53 offen offset:640 sc0 sc1
    v_mul_f32 v53, v6, v53
    buffer_atomic_add_f32 v53, v3, s[32:35], s53 offen offset:720 sc0 sc1
    v_mul_f32 v54, v6, v54
    buffer_atomic_add_f32 v54, v3, s[32:35], s53 offen offset:800 sc0 sc1
    v_mul_f32 v55, v6, v55
    buffer_atomic_add_f32 v55, v3, s[32:35], s53 offen offset:880 sc0 sc1
    v_mul_f32 v56, v7, v56
    buffer_atomic_add_f32 v56, v3, s[32:35], s53 offen offset:1280 sc0 sc1
    v_mul_f32 v57, v6, v57
    buffer_atomic_add_f32 v57, v5, s[32:35], s53 offen offset:1360 sc0 sc1
    v_mul_f32 v58, v6, v58
    buffer_atomic_add_f32 v58, v5, s[32:35], s53 offen offset:1440 sc0 sc1
    v_mul_f32 v59, v6, v59
    buffer_atomic_add_f32 v59, v5, s[32:35], s53 offen offset:1520 sc0 sc1
    s_mov_b32 s37, 1
    s_nop 1
    s_branch k1_kernel_y
k1_kernel_ckv_chk:
    s_getreg_b32 s53, hwreg(HW_REG_IB_STS, 0, 4)
    s_cmp_lg_u32 s53, 0
    s_cbranch_scc1 k1_kernel_ckv_chkr
    s_waitcnt vmcnt(0)
    s_cmp_lt_u32 s66, 2
    s_cbranch_scc1 k1_kernel_ckv_chki
k1_kernel_ckv_chkd:
    v_cmp_ne_u32 vcc, 1, v0
    s_nop 1
    s_cbranch_vccnz k1_kernel_ckv_chki
    v_mbcnt_lo_u32_b32 v0, -1, 0
    v_mbcnt_hi_u32_b32 v0, -1, v0
    s_lshl_b32 s53, s45, 9
    s_add_u32 s53, s53, 12730368
    v_lshlrev_b32 v0, 4, v0
    s_mov_b32 s66, 0
    s_mov_b32 m0, 122880
    s_nop 0
    buffer_load_dwordx4 v0, s[32:35], s53 offen sc1 lds
    s_add_u32 s53, s53, 1024
    s_mov_b32 m0, 123904
    s_nop 0
    buffer_load_dwordx4 v0, s[32:35], s53 offen sc1 lds
    s_add_u32 s53, s53, 1024
    s_mov_b32 m0, 124928
    s_nop 0
    buffer_load_dwordx4 v0, s[32:35], s53 offen sc1 lds
    s_add_u32 s53, s53, 1024
    s_mov_b32 m0, 125952
    s_nop 0
    buffer_load_dwordx4 v0, s[32:35], s53 offen sc1 lds
    s_setpc_b64 s[4:5]
k1_kernel_ckv_chki:
    v_mbcnt_lo_u32_b32 v0, -1, 0
    v_mbcnt_hi_u32_b32 v0, -1, v0
    v_lshlrev_b32 v0, 2, v0
    s_mov_b32 s66, 2
    buffer_load_dword v0, v0, s[36:39], 0 offen sc1
k1_kernel_ckv_chkr:
    s_setpc_b64 s[4:5]
k1_kernel_ckv_tbs:
    s_mov_b32 s54, 20000
    s_cmp_eq_u32 s66, 2
    s_cbranch_scc1 k1_kernel_ckv_tbw
k1_kernel_ckv_tbi:
    v_mbcnt_lo_u32_b32 v0, -1, 0
    v_mbcnt_hi_u32_b32 v0, -1, v0
    v_lshlrev_b32 v0, 2, v0
    s_mov_b32 s66, 2
    buffer_load_dword v0, v0, s[36:39], 0 offen sc1
k1_kernel_ckv_tbw:
    s_sub_u32 s54, s54, 1
    s_waitcnt vmcnt(0)
    v_cmp_ne_u32 vcc, 1, v0
    s_cmp_eq_u32 s54, 0
    s_cbranch_scc1 k1_kernel_ckv_tbx
    s_nop 1
    s_cbranch_vccnz k1_kernel_ckv_tbi
k1_kernel_ckv_tbx:
    v_mbcnt_lo_u32_b32 v0, -1, 0
    v_mbcnt_hi_u32_b32 v0, -1, v0
    s_lshl_b32 s53, s45, 9
    s_add_u32 s53, s53, 12730368
    v_lshlrev_b32 v0, 4, v0
    s_mov_b32 s66, 0
    s_mov_b32 m0, 122880
    s_nop 0
    buffer_load_dwordx4 v0, s[32:35], s53 offen sc1 lds
    s_add_u32 s53, s53, 1024
    s_mov_b32 m0, 123904
    s_nop 0
    buffer_load_dwordx4 v0, s[32:35], s53 offen sc1 lds
    s_add_u32 s53, s53, 1024
    s_mov_b32 m0, 124928
    s_nop 0
    buffer_load_dwordx4 v0, s[32:35], s53 offen sc1 lds
    s_add_u32 s53, s53, 1024
    s_mov_b32 m0, 125952
    s_nop 0
    buffer_load_dwordx4 v0, s[32:35], s53 offen sc1 lds
    s_waitcnt vmcnt(0)
    s_branch k1_kernel_ckv_tbd
k1_kernel_hk:
    s_sub_u32 s101, s44, 4
    v_lshrrev_b32 v10, 4, v0
    s_lshl_b32 s53, s101, 2
    v_add_u32 v10, s53, v10
    v_xor_b32 v11, v0, v10
    v_and_b32 v11, 15, v11
    v_mul_u32_u24 v1, 1280, v10
    v_lshl_add_u32 v1, v11, 4, v1
    v_add_u32 v2, 20480, v1
    s_bfe_u32 s53, s48, 0x40000
    s_lshl_b32 s60, s53, 8
    s_bfe_u32 s53, s48, 0x40004
    s_lshl_b32 s61, s53, 8
    s_bfe_u32 s53, s48, 0x40008
    s_lshl_b32 s62, s53, 8
    s_bfe_u32 s53, s48, 0x4000c
    s_lshl_b32 s63, s53, 8
    s_bfe_u32 s53, s48, 0x40010
    s_lshl_b32 s64, s53, 8
    s_add_u32 s53, s45, s47
    s_mul_i32 s65, s53, 40960
    s_mov_b32 s99, s65
    s_mul_i32 s100, s45, 40960
    s_lshl_b32 s66, s101, 10
    s_mov_b32 s51, s47
    s_add_u32 s65, s65, 40960
    s_add_u32 s51, s51, 1
    s_cmp_ge_u32 s51, s46
    s_cselect_b32 s51, 0, s51
    s_cselect_b32 s65, s100, s65
    s_lshr_b32 s55, s101, 1
    s_and_b32 s56, s101, 1
    s_mul_i32 s57, s49, 160
    s_mul_i32 s53, s55, 1280
    s_add_u32 s57, s57, s53
    s_add_u32 s57, s57, 1280
    s_mov_b32 s58, 3840
    v_add_u32 v10, 0, v0
    v_mul_u32_u24 v11, 205, v10
    v_lshrrev_b32 v11, 11, v11
    v_mul_u32_u24 v3, 3680, v11
    v_lshl_add_u32 v3, v10, 4, v3
    v_add_u32 v10, 64, v0
    v_mul_u32_u24 v11, 205, v10
    v_lshrrev_b32 v11, 11, v11
    v_mul_u32_u24 v4, 3680, v11
    v_lshl_add_u32 v4, v10, 4, v4
    v_add_u32 v10, 128, v0
    v_mul_u32_u24 v11, 205, v10
    v_lshrrev_b32 v11, 11, v11
    v_mul_u32_u24 v5, 3680, v11
    v_lshl_add_u32 v5, v10, 4, v5
    v_add_u32 v10, 192, v0
    v_mul_u32_u24 v11, 205, v10
    v_lshrrev_b32 v11, 11, v11
    v_mul_u32_u24 v6, 3680, v11
    v_lshl_add_u32 v6, v10, 4, v6
    v_add_u32 v10, 256, v0
    v_mul_u32_u24 v11, 205, v10
    v_lshrrev_b32 v11, 11, v11
    v_mul_u32_u24 v7, 3680, v11
    v_lshl_add_u32 v7, v10, 4, v7
    s_mov_b32 s69, 30720
    s_mul_i32 s98, s101, 5120
    s_lshl_b32 s53, s56, 5
    s_mul_i32 s67, s53, s58
    s_add_u32 s67, s67, s57
    s_lshr_b32 s68, s58, 1
    s_waitcnt lgkmcnt(0)
    s_mov_b32 s24, s4
    s_and_b32 s25, s5, 0xffff
    s_mov_b32 s26, 2621440
    s_mov_b32 s27, 0x20000
    s_mov_b32 s28, s6
    s_and_b32 s29, s7, 0xffff
    s_mov_b32 s30, 2457600
    s_mov_b32 s31, 0x20000
    s_mul_i32 s53, s60, s68
    s_add_u32 s53, s53, s67
    s_add_u32 m0, s98, 102400
    s_nop 0
    buffer_load_dwordx4 v3, s[28:31], s53 offen lds
    s_add_u32 m0, s98, 103424
    s_nop 0
    buffer_load_dwordx4 v4, s[28:31], s53 offen lds
    s_add_u32 m0, s98, 104448
    s_nop 0
    buffer_load_dwordx4 v5, s[28:31], s53 offen lds
    s_add_u32 m0, s98, 105472
    s_nop 0
    buffer_load_dwordx4 v6, s[28:31], s53 offen lds
    s_add_u32 m0, s98, 106496
    s_nop 0
    buffer_load_dwordx4 v7, s[28:31], s53 offen lds
    s_mul_i32 s53, s60, s68
    s_add_u32 s53, s53, s67
    s_lshl_b32 s54, s69, 3
    s_add_u32 s53, s53, s54
    s_add_u32 m0, s98, 130048
    s_nop 0
    buffer_load_dwordx4 v3, s[28:31], s53 offen lds
    s_add_u32 m0, s98, 131072
    s_nop 0
    buffer_load_dwordx4 v4, s[28:31], s53 offen lds
    s_add_u32 m0, s98, 132096
    s_nop 0
    buffer_load_dwordx4 v5, s[28:31], s53 offen lds
    s_add_u32 m0, s98, 133120
    s_nop 0
    buffer_load_dwordx4 v6, s[28:31], s53 offen lds
    s_add_u32 m0, s98, 134144
    s_nop 0
    buffer_load_dwordx4 v7, s[28:31], s53 offen lds
    s_mov_b32 s32, s22
    s_and_b32 s33, s23, 0xffff
    s_mov_b32 s34, 12849152
    s_mov_b32 s35, 0x20000
    v_lshlrev_b32 v9, 4, v0
    v_mov_b32 v10, 0
    v_mov_b32 v11, 0
    v_mov_b32 v12, 0
    v_mov_b32 v13, 0
    v_add_u32 v14, s66, v9
    v_add_u32 v14, 150528, v14
    ds_write_b128 v14, v[10:13]
    v_mov_b32 v88, s52
    v_mov_b32 v89, s52
    v_mov_b32 v90, s52
    v_mov_b32 v91, s52
    ds_write_b128 v14, v[88:91] offset:4096
    v_and_b32 v10, 15, v0
    v_lshrrev_b32 v11, 4, v0
    v_xor_b32 v12, v10, v11
    v_lshlrev_b32 v12, 4, v12
    v_lshl_add_u32 v18, v10, 8, v12
    s_lshl_b32 s53, s56, 12
    v_add_u32 v18, s53, v18
    v_xor_b32 v19, 64, v18
    v_xor_b32 v20, 128, v18
    v_xor_b32 v21, 192, v18
    v_bfe_u32 v12, v0, 2, 2
    v_lshl_add_u32 v12, v11, 3, v12
    v_mul_u32_u24 v22, 160, v12
    v_bfe_u32 v12, v0, 1, 1
    v_mul_u32_u24 v12, 40, v12
    v_add_u32 v22, v22, v12
    v_and_b32 v12, 1, v0
    v_lshl_add_u32 v22, v12, 3, v22
    s_mul_i32 s53, s55, 80
    s_add_u32 s53, s53, 51224
    v_add_u32 v22, s53, v22
    v_add_u32 v23, 40960, v22
    s_lshl_b32 s53, s56, 8
    s_add_u32 s53, s53, 122880
    v_lshl_add_u32 v92, v11, 6, s53
    v_lshrrev_b32 v12, 3, v10
    v_lshlrev_b32 v93, 9, v12
    v_and_b32 v12, 1, v11
    v_lshl_add_u32 v93, v12, 7, v93
    v_and_b32 v12, 7, v10
    v_lshl_add_u32 v93, v12, 4, v93
    v_lshrrev_b32 v12, 1, v11
    v_lshl_add_u32 v93, v12, 3, v93
    s_lshl_b32 s53, s55, 10
    s_lshl_b32 s54, s56, 8
    s_add_u32 s53, s53, s54
    s_add_u32 s53, s53, 150528
    v_add_u32 v93, s53, v93
    s_add_u32 m0, s66, 40960
    s_add_u32 s53, s65, s60
    buffer_load_dwordx4 v1, s[24:27], s53 offen lds
    s_add_u32 m0, s66, 45056
    s_nop 0
    buffer_load_dwordx4 v2, s[24:27], s53 offen lds
    s_mul_i32 s53, s61, s68
    s_add_u32 s53, s53, s67
    s_add_u32 m0, s98, 61440
    s_nop 0
    buffer_load_dwordx4 v3, s[28:31], s53 offen lds
    s_add_u32 m0, s98, 62464
    s_nop 0
    buffer_load_dwordx4 v4, s[28:31], s53 offen lds
    s_add_u32 m0, s98, 63488
    s_nop 0
    buffer_load_dwordx4 v5, s[28:31], s53 offen lds
    s_add_u32 m0, s98, 64512
    s_nop 0
    buffer_load_dwordx4 v6, s[28:31], s53 offen lds
    s_add_u32 m0, s98, 65536
    s_nop 0
    buffer_load_dwordx4 v7, s[28:31], s53 offen lds
    v_mov_b32 v10, 0
    v_mov_b32 v11, 0
    v_mov_b32 v12, 0
    v_mov_b32 v13, 0
    v_mov_b32 v14, 162816
    ds_write_b128 v14, v[10:13]
    s_lshr_b32 s14, s2, 5
    s_and_b32 s53, s2, 7
    s_bfe_u32 s54, s2, 0x20003
    s_lshl_b32 s13, s53, 2
    s_add_u32 s13, s13, s54
    s_mul_i32 s8, s13, 303104
    s_mul_i32 s9, s14, 378880
    s_add_u32 s9, s9, 9699328
    s_lshr_b32 s53, s13, 4
    s_mul_i32 s11, s53, 6144
    s_and_b32 s53, s13, 15
    s_lshl_b32 s53, s53, 1
    s_add_u32 s54, s53, 1
    s_cmp_ge_u32 s53, 22
    s_cselect_b32 s55, 2048, 0
    s_cselect_b32 s56, 11, 0
    s_add_u32 s11, s11, s55
    s_sub_u32 s54, s54, s56
    s_cmp_ge_u32 s53, 10
    s_cselect_b32 s55, 2048, 0
    s_cselect_b32 s56, 11, 0
    s_add_u32 s12, s11, s55
    s_sub_u32 s54, s54, s56
    s_cmp_eq_u32 s53, 10
    s_cselect_b32 s11, s11, s12
    s_mul_i32 s55, s54, 11
    s_lshr_b32 s55, s55, 5
    s_mul_i32 s54, s54, 3
    s_sub_u32 s54, s54, s55
    s_add_u32 s54, s54, 11
    s_sub_u32 s55, s54, 27
    s_cmp_ge_u32 s54, 27
    s_cselect_b32 s54, s55, s54
    s_lshl_b32 s10, s54, 1
    s_lshl_b32 s15, s2, 6
    s_add_u32 s15, s15, 12833792
    s_mov_b32 s16, 81920
    s_mov_b32 s17, 0
    s_mov_b32 s7, 40960
    s_mov_b32 s50, 0
    s_setprio 3
    s_waitcnt lgkmcnt(0)
    s_waitcnt vmcnt(12)
    s_waitcnt lgkmcnt(0)
    s_barrier
    ds_read_b64_tr_b16 v[96:97], v23 offset:20480
    ds_read_b64_tr_b16 v[98:99], v23 offset:21120
    ds_read_b64_tr_b16 v[100:101], v23 offset:25600
    ds_read_b64_tr_b16 v[102:103], v23 offset:26240
    ds_read_b128 v[32:35], v18 offset:0
    ds_read_b128 v[36:39], v19 offset:0
    s_mul_i32 s53, s61, s68
    s_add_u32 s53, s53, s67
    s_lshl_b32 s54, s69, 3
    s_add_u32 s53, s53, s54
    s_add_u32 m0, s98, 81920
    s_nop 0
    buffer_load_dwordx4 v3, s[28:31], s53 offen lds
    s_add_u32 m0, s98, 82944
    s_nop 0
    buffer_load_dwordx4 v4, s[28:31], s53 offen lds
    s_add_u32 m0, s98, 83968
    s_nop 0
    buffer_load_dwordx4 v5, s[28:31], s53 offen lds
    s_add_u32 m0, s98, 84992
    s_nop 0
    buffer_load_dwordx4 v6, s[28:31], s53 offen lds
    s_add_u32 m0, s98, 86016
    s_nop 0
    buffer_load_dwordx4 v7, s[28:31], s53 offen lds
    s_add_u32 m0, s66, 49152
    s_add_u32 s53, s65, s61
    buffer_load_dwordx4 v1, s[24:27], s53 offen lds
    s_add_u32 m0, s66, 53248
    s_nop 0
    buffer_load_dwordx4 v2, s[24:27], s53 offen lds
    s_waitcnt vmcnt(14)
    s_waitcnt lgkmcnt(0)
    s_barrier
    ds_read_b64_tr_b16 v[104:105], v23 offset:48128
    ds_read_b64_tr_b16 v[106:107], v23 offset:48768
    ds_read_b64_tr_b16 v[108:109], v23 offset:53248
    ds_read_b64_tr_b16 v[110:111], v23 offset:53888
    ds_read_b128 v[48:51], v20 offset:0
    ds_read_b128 v[52:55], v21 offset:0
    s_mul_i32 s53, s62, s68
    s_add_u32 s53, s53, s67
    s_add_u32 m0, s98, 102400
    s_nop 0
    buffer_load_dwordx4 v3, s[28:31], s53 offen lds
    v_mfma_f32_16x16x32_bf16 v[176:179], v[32:35], v[96:99], 0
    s_add_u32 m0, s98, 103424
    s_nop 0
    buffer_load_dwordx4 v4, s[28:31], s53 offen lds
    v_mfma_f32_16x16x32_bf16 v[84:87], v[88:91], v[96:99], 0
    s_add_u32 m0, s98, 104448
    s_nop 0
    buffer_load_dwordx4 v5, s[28:31], s53 offen lds
    v_mfma_f32_16x16x32_bf16 v[176:179], v[36:39], v[100:103], v[176:179]
    s_add_u32 m0, s98, 105472
    s_nop 0
    buffer_load_dwordx4 v6, s[28:31], s53 offen lds
    v_mfma_f32_16x16x32_bf16 v[84:87], v[88:91], v[100:103], v[84:87]
    s_add_u32 m0, s98, 106496
    s_nop 0
    buffer_load_dwordx4 v7, s[28:31], s53 offen lds
    s_waitcnt vmcnt(12)
    s_waitcnt lgkmcnt(0)
    s_barrier
    ds_read_b64_tr_b16 v[112:113], v22 offset:20480
    ds_read_b64_tr_b16 v[114:115], v22 offset:21120
    ds_read_b64_tr_b16 v[116:117], v22 offset:25600
    ds_read_b64_tr_b16 v[118:119], v22 offset:26240
    ds_read_b128 v[32:35], v18 offset:8192
    ds_read_b128 v[40:43], v18 offset:40960
    ds_read_b128 v[36:39], v19 offset:8192
    ds_read_b128 v[44:47], v19 offset:40960
    s_mul_i32 s53, s62, s68
    s_add_u32 s53, s53, s67
    s_lshl_b32 s54, s69, 3
    s_add_u32 s53, s53, s54
    s_add_u32 m0, s98, 130048
    s_nop 0
    buffer_load_dwordx4 v3, s[28:31], s53 offen lds
    v_mfma_f32_16x16x32_bf16 v[176:179], v[48:51], v[104:107], v[176:179]
    s_add_u32 m0, s98, 131072
    s_nop 0
    buffer_load_dwordx4 v4, s[28:31], s53 offen lds
    v_mfma_f32_16x16x32_bf16 v[84:87], v[88:91], v[104:107], v[84:87]
    s_add_u32 m0, s98, 132096
    s_nop 0
    buffer_load_dwordx4 v5, s[28:31], s53 offen lds
    v_mfma_f32_16x16x32_bf16 v[176:179], v[52:55], v[108:111], v[176:179]
    s_add_u32 m0, s98, 133120
    s_nop 0
    buffer_load_dwordx4 v6, s[28:31], s53 offen lds
    v_mfma_f32_16x16x32_bf16 v[84:87], v[88:91], v[108:111], v[84:87]
    s_add_u32 m0, s98, 134144
    s_nop 0
    buffer_load_dwordx4 v7, s[28:31], s53 offen lds
    s_waitcnt vmcnt(12)
    s_waitcnt lgkmcnt(0)
    s_barrier
    ds_read_b64_tr_b16 v[120:121], v23 offset:0
    ds_read_b64_tr_b16 v[122:123], v23 offset:640
    ds_read_b64_tr_b16 v[124:125], v23 offset:5120
    ds_read_b64_tr_b16 v[126:127], v23 offset:5760
    ds_read_b128 v[48:51], v20 offset:8192
    ds_read_b128 v[56:59], v20 offset:40960
    ds_read_b128 v[52:55], v21 offset:8192
    ds_read_b128 v[60:63], v21 offset:40960
    s_mul_i32 s53, s63, s68
    s_add_u32 s53, s53, s67
    s_add_u32 m0, s98, 61440
    s_nop 0
    buffer_load_dwordx4 v3, s[28:31], s53 offen lds
    v_mfma_f32_16x16x32_bf16 v[176:179], v[32:35], v[112:115], v[176:179]
    s_add_u32 m0, s98, 62464
    s_nop 0
    buffer_load_dwordx4 v4, s[28:31], s53 offen lds
    v_mfma_f32_16x16x32_bf16 v[84:87], v[88:91], v[112:115], v[84:87]
    s_add_u32 m0, s98, 63488
    s_nop 0
    buffer_load_dwordx4 v5, s[28:31], s53 offen lds
    v_mfma_f32_16x16x32_bf16 v[80:83], v[40:43], v[96:99], 0
    s_add_u32 m0, s98, 64512
    s_nop 0
    buffer_load_dwordx4 v6, s[28:31], s53 offen lds
    v_mfma_f32_16x16x32_bf16 v[176:179], v[36:39], v[116:119], v[176:179]
    s_add_u32 m0, s98, 65536
    s_nop 0
    buffer_load_dwordx4 v7, s[28:31], s53 offen lds
    v_mfma_f32_16x16x32_bf16 v[84:87], v[88:91], v[116:119], v[84:87]
    v_mfma_f32_16x16x32_bf16 v[80:83], v[44:47], v[100:103], v[80:83]
    s_waitcnt vmcnt(10)
    s_waitcnt lgkmcnt(0)
    s_barrier
    ds_read_b64_tr_b16 v[128:129], v23 offset:20480
    ds_read_b64_tr_b16 v[130:131], v23 offset:21120
    ds_read_b64_tr_b16 v[132:133], v23 offset:25600
    ds_read_b64_tr_b16 v[134:135], v23 offset:26240
    ds_read_b128 v[32:35], v18 offset:16384
    ds_read_b128 v[40:43], v18 offset:49152
    ds_read_b128 v[36:39], v19 offset:16384
    ds_read_b128 v[44:47], v19 offset:49152
    s_mul_i32 s53, s63, s68
    s_add_u32 s53, s53, s67
    s_lshl_b32 s54, s69, 3
    s_add_u32 s53, s53, s54
    s_add_u32 m0, s98, 81920
    s_nop 0
    buffer_load_dwordx4 v3, s[28:31], s53 offen lds
    v_mfma_f32_16x16x32_bf16 v[176:179], v[48:51], v[120:123], v[176:179]
    s_add_u32 m0, s98, 82944
    s_nop 0
    buffer_load_dwordx4 v4, s[28:31], s53 offen lds
    v_mfma_f32_16x16x32_bf16 v[84:87], v[88:91], v[120:123], v[84:87]
    s_add_u32 m0, s98, 83968
    s_nop 0
    buffer_load_dwordx4 v5, s[28:31], s53 offen lds
    v_mfma_f32_16x16x32_bf16 v[80:83], v[56:59], v[104:107], v[80:83]
    s_add_u32 m0, s98, 84992
    s_nop 0
    buffer_load_dwordx4 v6, s[28:31], s53 offen lds
    v_mfma_f32_16x16x32_bf16 v[176:179], v[52:55], v[124:127], v[176:179]
    s_add_u32 m0, s98, 86016
    s_nop 0
    buffer_load_dwordx4 v7, s[28:31], s53 offen lds
    v_mfma_f32_16x16x32_bf16 v[84:87], v[88:91], v[124:127], v[84:87]
    v_mfma_f32_16x16x32_bf16 v[80:83], v[60:63], v[108:111], v[80:83]
    s_waitcnt vmcnt(10)
    s_waitcnt lgkmcnt(0)
    s_barrier
    ds_read_b64_tr_b16 v[136:137], v23 offset:48128
    ds_read_b64_tr_b16 v[138:139], v23 offset:48768
    ds_read_b64_tr_b16 v[140:141], v23 offset:53248
    ds_read_b64_tr_b16 v[142:143], v23 offset:53888
    ds_read_b128 v[48:51], v20 offset:16384
    ds_read_b128 v[56:59], v20 offset:49152
    ds_read_b128 v[52:55], v21 offset:16384
    ds_read_b128 v[60:63], v21 offset:49152
    s_mul_i32 s53, s64, s68
    s_add_u32 s53, s53, s67
    s_add_u32 m0, s98, 102400
    s_nop 0
    buffer_load_dwordx4 v3, s[28:31], s53 offen lds
    v_mfma_f32_16x16x32_bf16 v[176:179], v[32:35], v[128:131], v[176:179]
    s_add_u32 m0, s98, 103424
    s_nop 0
    buffer_load_dwordx4 v4, s[28:31], s53 offen lds
    v_mfma_f32_16x16x32_bf16 v[84:87], v[88:91], v[128:131], v[84:87]
    s_add_u32 m0, s98, 104448
    s_nop 0
    buffer_load_dwordx4 v5, s[28:31], s53 offen lds
    v_mfma_f32_16x16x32_bf16 v[80:83], v[40:43], v[112:115], v[80:83]
    s_add_u32 m0, s98, 105472
    s_nop 0
    buffer_load_dwordx4 v6, s[28:31], s53 offen lds
    v_mfma_f32_16x16x32_bf16 v[176:179], v[36:39], v[132:135], v[176:179]
    s_add_u32 m0, s98, 106496
    s_nop 0
    buffer_load_dwordx4 v7, s[28:31], s53 offen lds
    v_mfma_f32_16x16x32_bf16 v[84:87], v[88:91], v[132:135], v[84:87]
    v_mfma_f32_16x16x32_bf16 v[80:83], v[44:47], v[116:119], v[80:83]
    s_waitcnt vmcnt(10)
    s_waitcnt lgkmcnt(0)
    s_barrier
    ds_read_b64_tr_b16 v[144:145], v22 offset:20480
    ds_read_b64_tr_b16 v[146:147], v22 offset:21120
    ds_read_b64_tr_b16 v[148:149], v22 offset:25600
    ds_read_b64_tr_b16 v[150:151], v22 offset:26240
    ds_read_b128 v[32:35], v18 offset:24576
    ds_read_b128 v[36:39], v19 offset:24576
    s_mul_i32 s53, s64, s68
    s_add_u32 s53, s53, s67
    s_lshl_b32 s54, s69, 3
    s_add_u32 s53, s53, s54
    s_add_u32 m0, s98, 130048
    s_nop 0
    buffer_load_dwordx4 v3, s[28:31], s53 offen lds
    v_mfma_f32_16x16x32_bf16 v[176:179], v[48:51], v[136:139], v[176:179]
    s_add_u32 m0, s98, 131072
    s_nop 0
    buffer_load_dwordx4 v4, s[28:31], s53 offen lds
    v_mfma_f32_16x16x32_bf16 v[84:87], v[88:91], v[136:139], v[84:87]
    s_add_u32 m0, s98, 132096
    s_nop 0
    buffer_load_dwordx4 v5, s[28:31], s53 offen lds
    v_mfma_f32_16x16x32_bf16 v[80:83], v[56:59], v[120:123], v[80:83]
    s_add_u32 m0, s98, 133120
    s_nop 0
    buffer_load_dwordx4 v6, s[28:31], s53 offen lds
    v_mfma_f32_16x16x32_bf16 v[176:179], v[52:55], v[140:143], v[176:179]
    s_add_u32 m0, s98, 134144
    s_nop 0
    buffer_load_dwordx4 v7, s[28:31], s53 offen lds
    v_mfma_f32_16x16x32_bf16 v[84:87], v[88:91], v[140:143], v[84:87]
    v_mfma_f32_16x16x32_bf16 v[80:83], v[60:63], v[124:127], v[80:83]
    s_waitcnt vmcnt(10)
    s_waitcnt lgkmcnt(0)
    s_barrier
    ds_read_b64_tr_b16 v[152:153], v23 offset:0
    ds_read_b64_tr_b16 v[154:155], v23 offset:640
    ds_read_b64_tr_b16 v[156:157], v23 offset:5120
    ds_read_b64_tr_b16 v[158:159], v23 offset:5760
    ds_read_b128 v[48:51], v20 offset:24576
    ds_read_b128 v[52:55], v21 offset:24576
    s_add_u32 m0, s66, 57344
    s_add_u32 s53, s65, s62
    buffer_load_dwordx4 v1, s[24:27], s53 offen lds
    v_mfma_f32_16x16x32_bf16 v[176:179], v[32:35], v[144:147], v[176:179]
    s_add_u32 m0, s66, 61440
    s_nop 0
    buffer_load_dwordx4 v2, s[24:27], s53 offen lds
    v_mfma_f32_16x16x32_bf16 v[84:87], v[88:91], v[144:147], v[84:87]
    s_add_u32 m0, s66, 65536
    s_add_u32 s53, s65, s63
    buffer_load_dwordx4 v1, s[24:27], s53 offen lds
    v_mfma_f32_16x16x32_bf16 v[176:179], v[36:39], v[148:151], v[176:179]
    s_add_u32 m0, s66, 69632
    s_nop 0
    buffer_load_dwordx4 v2, s[24:27], s53 offen lds
    v_mfma_f32_16x16x32_bf16 v[84:87], v[88:91], v[148:151], v[84:87]
    s_add_u32 m0, s66, 73728
    s_add_u32 s53, s65, s64
    buffer_load_dwordx4 v1, s[24:27], s53 offen lds
    s_add_u32 m0, s66, 77824
    s_nop 0
    buffer_load_dwordx4 v2, s[24:27], s53 offen lds
    s_add_u32 s65, s65, 40960
    s_add_u32 s51, s51, 1
    s_cmp_ge_u32 s51, s46
    s_cselect_b32 s51, 0, s51
    s_cselect_b32 s65, s100, s65
    s_waitcnt vmcnt(11)
    s_waitcnt lgkmcnt(0)
    s_barrier
    ds_read_b64_tr_b16 v[160:161], v23 offset:20480
    ds_read_b64_tr_b16 v[162:163], v23 offset:21120
    ds_read_b64_tr_b16 v[164:165], v23 offset:25600
    ds_read_b64_tr_b16 v[166:167], v23 offset:26240
    ds_read_b128 v[32:35], v18 offset:32768
    ds_read_b128 v[36:39], v19 offset:32768
    s_add_u32 m0, s66, 81920
    s_add_u32 s53, s65, s60
    buffer_load_dwordx4 v1, s[24:27], s53 offen lds
    v_mfma_f32_16x16x32_bf16 v[176:179], v[48:51], v[152:155], v[176:179]
    s_add_u32 m0, s66, 86016
    s_nop 0
    buffer_load_dwordx4 v2, s[24:27], s53 offen lds
    v_mfma_f32_16x16x32_bf16 v[84:87], v[88:91], v[152:155], v[84:87]
    s_add_u32 m0, s66, 90112
    s_add_u32 s53, s65, s61
    buffer_load_dwordx4 v1, s[24:27], s53 offen lds
    v_mfma_f32_16x16x32_bf16 v[176:179], v[52:55], v[156:159], v[176:179]
    s_add_u32 m0, s66, 94208
    s_nop 0
    buffer_load_dwordx4 v2, s[24:27], s53 offen lds
    v_mfma_f32_16x16x32_bf16 v[84:87], v[88:91], v[156:159], v[84:87]
    s_add_u32 m0, s66, 98304
    s_add_u32 s53, s65, s62
    buffer_load_dwordx4 v1, s[24:27], s53 offen lds
    s_waitcnt vmcnt(11)
    s_waitcnt lgkmcnt(0)
    s_barrier
    ds_read_b64_tr_b16 v[168:169], v23 offset:48128
    ds_read_b64_tr_b16 v[170:171], v23 offset:48768
    ds_read_b64_tr_b16 v[172:173], v23 offset:53248
    ds_read_b64_tr_b16 v[174:175], v23 offset:53888
    ds_read_b128 v[48:51], v20 offset:32768
    ds_read_b128 v[52:55], v21 offset:32768
    s_add_u32 m0, s66, 102400
    s_add_u32 s53, s65, s62
    buffer_load_dwordx4 v2, s[24:27], s53 offen lds
    v_mfma_f32_16x16x32_bf16 v[176:179], v[32:35], v[160:163], v[176:179]
    s_add_u32 m0, s66, 106496
    s_add_u32 s53, s65, s63
    buffer_load_dwordx4 v1, s[24:27], s53 offen lds
    v_mfma_f32_16x16x32_bf16 v[84:87], v[88:91], v[160:163], v[84:87]
    s_add_u32 m0, s66, 110592
    s_nop 0
    buffer_load_dwordx4 v2, s[24:27], s53 offen lds
    v_mfma_f32_16x16x32_bf16 v[176:179], v[36:39], v[164:167], v[176:179]
    s_add_u32 m0, s66, 114688
    s_add_u32 s53, s65, s64
    buffer_load_dwordx4 v1, s[24:27], s53 offen lds
    v_mfma_f32_16x16x32_bf16 v[84:87], v[88:91], v[164:167], v[84:87]
    s_add_u32 m0, s66, 118784
    s_nop 0
    buffer_load_dwordx4 v2, s[24:27], s53 offen lds
    s_add_u32 s65, s65, 40960
    s_add_u32 s51, s51, 1
    s_cmp_ge_u32 s51, s46
    s_cselect_b32 s51, 0, s51
    s_cselect_b32 s65, s100, s65
    s_waitcnt vmcnt(10)
    s_waitcnt lgkmcnt(0)
    v_mfma_f32_16x16x32_bf16 v[176:179], v[48:51], v[168:171], v[176:179]
    v_mfma_f32_16x16x32_bf16 v[84:87], v[88:91], v[168:171], v[84:87]
    v_mfma_f32_16x16x32_bf16 v[176:179], v[52:55], v[172:175], v[176:179]
    v_mfma_f32_16x16x32_bf16 v[84:87], v[88:91], v[172:175], v[84:87]
    s_barrier
    s_lshl_b32 s58, s47, 9
    v_add_u32 v10, s58, v92
    ds_read2_b64 v[24:27], v10 offset1:2
    ds_read2_b64 v[28:31], v10 offset0:4 offset1:6
    s_and_b32 s53, s50, 1
    s_lshl_b32 s53, s53, 11
    v_add_u32 v11, s53, v93
    s_add_u32 s47, s47, 1
    s_cmp_ge_u32 s47, s46
    s_cselect_b32 s47, 0, s47
    s_waitcnt lgkmcnt(0)
    v_fma_f32 v12, v24, v84, v176
    v_fma_f32 v13, v26, v84, v177
    v_fma_f32 v14, v28, v84, v178
    v_fma_f32 v15, v30, v84, v179
    v_mul_f32 v12, v25, v12
    v_mul_f32 v13, v27, v13
    v_mul_f32 v14, v29, v14
    v_mul_f32 v15, v31, v15
    v_cvt_pk_bf16_f32 v12, v12, v13
    v_cvt_pk_bf16_f32 v13, v14, v15
    ds_write_b64 v11, v[12:13]
    s_add_u32 m0, s66, 0
    s_add_u32 s53, s65, s60
    buffer_load_dwordx4 v1, s[24:27], s53 offen lds
    s_add_u32 m0, s66, 4096
    s_nop 0
    buffer_load_dwordx4 v2, s[24:27], s53 offen lds
    s_add_u32 m0, s66, 8192
    s_add_u32 s53, s65, s61
    buffer_load_dwordx4 v1, s[24:27], s53 offen lds
    s_add_u32 m0, s66, 12288
    s_nop 0
    buffer_load_dwordx4 v2, s[24:27], s53 offen lds
    s_add_u32 m0, s66, 16384
    s_add_u32 s53, s65, s62
    buffer_load_dwordx4 v1, s[24:27], s53 offen lds
    s_add_u32 m0, s66, 20480
    s_nop 0
    buffer_load_dwordx4 v2, s[24:27], s53 offen lds
    s_add_u32 m0, s66, 24576
    s_add_u32 s53, s65, s63
    buffer_load_dwordx4 v1, s[24:27], s53 offen lds
    s_add_u32 m0, s66, 28672
    s_nop 0
    buffer_load_dwordx4 v2, s[24:27], s53 offen lds
    s_add_u32 m0, s66, 32768
    s_add_u32 s53, s65, s64
    buffer_load_dwordx4 v1, s[24:27], s53 offen lds
    s_add_u32 m0, s66, 36864
    s_nop 0
    buffer_load_dwordx4 v2, s[24:27], s53 offen lds
    s_add_u32 s65, s65, 40960
    s_add_u32 s51, s51, 1
    s_cmp_ge_u32 s51, s46
    s_cselect_b32 s51, 0, s51
    s_cselect_b32 s65, s100, s65
    v_add_u32 v18, 40960, v18
    v_add_u32 v19, 40960, v19
    v_add_u32 v20, 40960, v20
    v_add_u32 v21, 40960, v21
    ds_read_b128 v[64:67], v18 offset:16384
    ds_read_b128 v[68:71], v19 offset:16384
    ds_read_b128 v[72:75], v20 offset:16384
    ds_read_b128 v[76:79], v21 offset:16384
    s_waitcnt lgkmcnt(3)
    v_mfma_f32_16x16x32_bf16 v[80:83], v[64:67], v[128:131], v[80:83]
    ds_read_b128 v[64:67], v18 offset:24576
    s_waitcnt lgkmcnt(3)
    v_mfma_f32_16x16x32_bf16 v[80:83], v[68:71], v[132:135], v[80:83]
    ds_read_b128 v[68:71], v19 offset:24576
    s_waitcnt lgkmcnt(3)
    v_mfma_f32_16x16x32_bf16 v[80:83], v[72:75], v[136:139], v[80:83]
    ds_read_b128 v[72:75], v20 offset:24576
    s_waitcnt lgkmcnt(3)
    v_mfma_f32_16x16x32_bf16 v[80:83], v[76:79], v[140:143], v[80:83]
    ds_read_b128 v[76:79], v21 offset:24576
    s_waitcnt lgkmcnt(3)
    v_mfma_f32_16x16x32_bf16 v[80:83], v[64:67], v[144:147], v[80:83]
    ds_read_b128 v[64:67], v18 offset:32768
    s_waitcnt lgkmcnt(3)
    v_mfma_f32_16x16x32_bf16 v[80:83], v[68:71], v[148:151], v[80:83]
    ds_read_b128 v[68:71], v19 offset:32768
    s_waitcnt lgkmcnt(3)
    v_mfma_f32_16x16x32_bf16 v[80:83], v[72:75], v[152:155], v[80:83]
    ds_read_b128 v[72:75], v20 offset:32768
    s_waitcnt lgkmcnt(3)
    v_mfma_f32_16x16x32_bf16 v[80:83], v[76:79], v[156:159], v[80:83]
    ds_read_b128 v[76:79], v21 offset:32768
    s_waitcnt lgkmcnt(3)
    v_mfma_f32_16x16x32_bf16 v[80:83], v[64:67], v[160:163], v[80:83]
    s_waitcnt lgkmcnt(2)
    v_mfma_f32_16x16x32_bf16 v[80:83], v[68:71], v[164:167], v[80:83]
    s_waitcnt lgkmcnt(1)
    v_mfma_f32_16x16x32_bf16 v[80:83], v[72:75], v[168:171], v[80:83]
    s_waitcnt lgkmcnt(0)
    v_mfma_f32_16x16x32_bf16 v[80:83], v[76:79], v[172:175], v[80:83]
    s_mov_b32 s50, 1
    s_mov_b32 s67, 1
    s_add_u32 s98, s66, 40960
    s_mov_b32 s69, 40960
    s_waitcnt vmcnt(10)
    s_nop 3
k1_kernel_hk_loop:
    s_waitcnt lgkmcnt(0)
    s_barrier
    s_call_b64 s[4:5], k1_kernel_hk_epi
    s_add_u32 m0, s98, 0
    s_add_u32 s53, s65, s60
    buffer_load_dwordx4 v1, s[24:27], s53 offen lds
    s_add_u32 m0, s98, 4096
    s_nop 0
    buffer_load_dwordx4 v2, s[24:27], s53 offen lds
    s_add_u32 m0, s98, 8192
    s_add_u32 s53, s65, s61
    buffer_load_dwordx4 v1, s[24:27], s53 offen lds
    s_add_u32 m0, s98, 12288
    s_nop 0
    buffer_load_dwordx4 v2, s[24:27], s53 offen lds
    s_add_u32 m0, s98, 16384
    s_add_u32 s53, s65, s62
    buffer_load_dwordx4 v1, s[24:27], s53 offen lds
    s_add_u32 m0, s98, 20480
    s_nop 0
    buffer_load_dwordx4 v2, s[24:27], s53 offen lds
    s_add_u32 m0, s98, 24576
    s_add_u32 s53, s65, s63
    buffer_load_dwordx4 v1, s[24:27], s53 offen lds
    s_add_u32 m0, s98, 28672
    s_nop 0
    buffer_load_dwordx4 v2, s[24:27], s53 offen lds
    s_add_u32 m0, s98, 32768
    s_add_u32 s53, s65, s64
    buffer_load_dwordx4 v1, s[24:27], s53 offen lds
    s_add_u32 m0, s98, 36864
    s_nop 0
    buffer_load_dwordx4 v2, s[24:27], s53 offen lds
    s_add_u32 s65, s65, 40960
    s_add_u32 s51, s51, 1
    s_cmp_ge_u32 s51, s46
    s_cselect_b32 s51, 0, s51
    s_cselect_b32 s65, s100, s65
    s_add_u32 s98, s98, 40960
    s_cmp_ge_u32 s98, 122880
    s_cselect_b32 s98, s66, s98
    s_call_b64 s[4:5], k1_kernel_hk_tile
    s_waitcnt vmcnt(10)
    s_cmp_lt_u32 s50, 4
    s_cbranch_scc1 k1_kernel_hk_loop
    s_waitcnt lgkmcnt(0)
    s_barrier
    s_call_b64 s[4:5], k1_kernel_hk_epi
    s_cmp_lg_u32 s101, 0
    s_cbranch_scc1 k1_kernel_hk_p0
    v_lshlrev_b32 v43, 2, v9
    s_mov_b32 s53, 12821504
    buffer_load_dword v40, v43, s[32:35], s53 offen sc1
    s_mov_b32 s53, 12825600
    buffer_load_dword v41, v43, s[32:35], s53 offen sc1
    s_mov_b32 s53, 12829696
    buffer_load_dword v42, v43, s[32:35], s53 offen sc1
k1_kernel_hk_p0:
    s_add_u32 m0, s98, 0
    s_add_u32 s53, s65, s60
    buffer_load_dwordx4 v1, s[24:27], s53 offen lds
    s_add_u32 m0, s98, 4096
    s_nop 0
    buffer_load_dwordx4 v2, s[24:27], s53 offen lds
    s_add_u32 m0, s98, 8192
    s_add_u32 s53, s65, s61
    buffer_load_dwordx4 v1, s[24:27], s53 offen lds
    s_add_u32 m0, s98, 12288
    s_nop 0
    buffer_load_dwordx4 v2, s[24:27], s53 offen lds
    s_add_u32 m0, s98, 16384
    s_add_u32 s53, s65, s62
    buffer_load_dwordx4 v1, s[24:27], s53 offen lds
    s_add_u32 m0, s98, 20480
    s_nop 0
    buffer_load_dwordx4 v2, s[24:27], s53 offen lds
    s_add_u32 m0, s98, 24576
    s_add_u32 s53, s65, s63
    buffer_load_dwordx4 v1, s[24:27], s53 offen lds
    s_add_u32 m0, s98, 28672
    s_nop 0
    buffer_load_dwordx4 v2, s[24:27], s53 offen lds
    s_add_u32 m0, s98, 32768
    s_add_u32 s53, s65, s64
    buffer_load_dwordx4 v1, s[24:27], s53 offen lds
    s_add_u32 m0, s98, 36864
    s_nop 0
    buffer_load_dwordx4 v2, s[24:27], s53 offen lds
    s_add_u32 s98, s98, 40960
    s_cmp_ge_u32 s98, 122880
    s_cselect_b32 s98, s66, s98
    s_call_b64 s[4:5], k1_kernel_hk_tile
    s_waitcnt vmcnt(10)
    s_cmp_lg_u32 s101, 0
    s_cbranch_scc1 k1_kernel_hk_p1
    s_mov_b32 s54, 20000
k1_kernel_hk_w2:
    v_min3_u32 v40, v40, v41, v42
    v_cmp_eq_u32 vcc, 0, v40
    s_sub_u32 s54, s54, 1
    s_cbranch_scc1 k1_kernel_hk_w2x
    s_nop 0
    s_cbranch_vccz k1_kernel_hk_w2x
    s_sleep 4
    v_lshlrev_b32 v43, 2, v9
    s_mov_b32 s53, 12821504
    buffer_load_dword v40, v43, s[32:35], s53 offen sc1
    s_mov_b32 s53, 12825600
    buffer_load_dword v41, v43, s[32:35], s53 offen sc1
    s_mov_b32 s53, 12829696
    buffer_load_dword v42, v43, s[32:35], s53 offen sc1
    s_waitcnt vmcnt(0)
    s_branch k1_kernel_hk_w2
k1_kernel_hk_w2x:
k1_kernel_hk_p1:
    s_waitcnt lgkmcnt(0)
    s_barrier
    s_call_b64 s[4:5], k1_kernel_hk_epi
    s_and_b32 s53, s101, 1
    s_lshl_b32 s53, s53, 3
    s_lshr_b32 s54, s101, 1
    s_add_u32 s53, s53, s54
    s_add_u32 s53, s53, s10
    s_mul_i32 s55, s101, 9216
    s_add_u32 s55, s55, s98
    s_add_u32 s54, s53, 0xfffffff2
    s_cselect_b32 s56, 0, 54
    s_add_u32 s54, s54, s56
    s_mul_i32 s54, s54, 5120
    s_add_u32 s54, s54, s9
    s_add_u32 m0, s55, 0
    s_nop 0
    buffer_load_dwordx4 v9, s[32:35], s54 offen sc1 lds
    s_add_u32 s54, s54, 1024
    s_add_u32 m0, s55, 1024
    s_nop 0
    buffer_load_dwordx4 v9, s[32:35], s54 offen sc1 lds
    s_add_u32 s54, s54, 1024
    s_add_u32 m0, s55, 2048
    s_nop 0
    buffer_load_dwordx4 v9, s[32:35], s54 offen sc1 lds
    s_add_u32 s54, s54, 1024
    s_add_u32 m0, s55, 3072
    s_nop 0
    buffer_load_dwordx4 v9, s[32:35], s54 offen sc1 lds
    s_add_u32 s54, s54, 1024
    s_add_u32 m0, s55, 4096
    s_nop 0
    buffer_load_dwordx4 v9, s[32:35], s54 offen sc1 lds
    s_add_u32 s54, s53, 0xfffffff6
    s_cselect_b32 s56, 0, 54
    s_add_u32 s54, s54, s56
    s_mul_i32 s54, s54, 5120
    s_add_u32 s54, s54, s9
    s_add_u32 m0, s55, 5120
    s_nop 0
    buffer_load_dwordx4 v9, s[32:35], s54 offen sc1 lds
    s_add_u32 s54, s54, 1024
    s_add_u32 m0, s55, 6144
    s_nop 0
    buffer_load_dwordx4 v9, s[32:35], s54 offen sc1 lds
    s_add_u32 s54, s54, 1024
    s_add_u32 m0, s55, 7168
    s_nop 0
    buffer_load_dwordx4 v9, s[32:35], s54 offen sc1 lds
    s_add_u32 s54, s54, 1024
    s_add_u32 m0, s55, 8192
    s_nop 0
    buffer_load_dwordx4 v9, s[32:35], s54 offen sc1 lds
    s_add_u32 s54, s54, 1024
    s_add_u32 m0, s55, 9216
    s_nop 0
    buffer_load_dwordx4 v9, s[32:35], s54 offen sc1 lds
    s_add_u32 s98, s98, 40960
    s_cmp_ge_u32 s98, 122880
    s_cselect_b32 s98, s66, s98
    s_mul_i32 s53, s101, 25600
    s_add_u32 s53, s53, s9
    s_add_u32 s53, s53, 276480
    s_add_u32 s54, s53, 4096
    buffer_load_dwordx4 v[180:183], v9, s[32:35], s53 offen offset:0 sc1
    buffer_load_dwordx4 v[184:187], v9, s[32:35], s53 offen offset:1024 sc1
    buffer_load_dwordx4 v[188:191], v9, s[32:35], s53 offen offset:2048 sc1
    buffer_load_dwordx4 v[192:195], v9, s[32:35], s53 offen offset:3072 sc1
    buffer_load_dwordx4 v[196:199], v9, s[32:35], s54 offen offset:0 sc1
    s_call_b64 s[4:5], k1_kernel_hk_tile
    s_waitcnt vmcnt(15)
    s_waitcnt lgkmcnt(0)
    s_barrier
    s_call_b64 s[4:5], k1_kernel_hk_epi
    s_and_b32 s53, s101, 1
    s_lshl_b32 s53, s53, 3
    s_lshr_b32 s54, s101, 1
    s_add_u32 s53, s53, s54
    s_add_u32 s53, s53, s10
    s_mul_i32 s55, s101, 9216
    s_add_u32 s55, s55, s98
    s_add_u32 s54, s53, 0xfffffff4
    s_cselect_b32 s56, 0, 54
    s_add_u32 s54, s54, s56
    s_mul_i32 s54, s54, 5120
    s_add_u32 s54, s54, s9
    s_add_u32 m0, s55, 0
    s_nop 0
    buffer_load_dwordx4 v9, s[32:35], s54 offen sc1 lds
    s_add_u32 s54, s54, 1024
    s_add_u32 m0, s55, 1024
    s_nop 0
    buffer_load_dwordx4 v9, s[32:35], s54 offen sc1 lds
    s_add_u32 s54, s54, 1024
    s_add_u32 m0, s55, 2048
    s_nop 0
    buffer_load_dwordx4 v9, s[32:35], s54 offen sc1 lds
    s_add_u32 s54, s54, 1024
    s_add_u32 m0, s55, 3072
    s_nop 0
    buffer_load_dwordx4 v9, s[32:35], s54 offen sc1 lds
    s_add_u32 s54, s54, 1024
    s_add_u32 m0, s55, 4096
    s_nop 0
    buffer_load_dwordx4 v9, s[32:35], s54 offen sc1 lds
    s_add_u32 s54, s53, 0xfffffff8
    s_cselect_b32 s56, 0, 54
    s_add_u32 s54, s54, s56
    s_mul_i32 s54, s54, 5120
    s_add_u32 s54, s54, s9
    s_add_u32 m0, s55, 5120
    s_nop 0
    buffer_load_dwordx4 v9, s[32:35], s54 offen sc1 lds
    s_add_u32 s54, s54, 1024
    s_add_u32 m0, s55, 6144
    s_nop 0
    buffer_load_dwordx4 v9, s[32:35], s54 offen sc1 lds
    s_add_u32 s54, s54, 1024
    s_add_u32 m0, s55, 7168
    s_nop 0
    buffer_load_dwordx4 v9, s[32:35], s54 offen sc1 lds
    s_add_u32 s54, s54, 1024
    s_add_u32 m0, s55, 8192
    s_nop 0
    buffer_load_dwordx4 v9, s[32:35], s54 offen sc1 lds
    s_add_u32 s54, s54, 1024
    s_add_u32 m0, s55, 9216
    s_nop 0
    buffer_load_dwordx4 v9, s[32:35], s54 offen sc1 lds
    s_add_u32 s98, s98, 40960
    s_cmp_ge_u32 s98, 122880
    s_cselect_b32 s98, s66, s98
    s_mul_i32 s53, s101, 25600
    s_add_u32 s53, s53, s9
    s_add_u32 s53, s53, 281600
    s_add_u32 s54, s53, 4096
    buffer_load_dwordx4 v[200:203], v9, s[32:35], s53 offen offset:0 sc1
    buffer_load_dwordx4 v[204:207], v9, s[32:35], s53 offen offset:1024 sc1
    buffer_load_dwordx4 v[208:211], v9, s[32:35], s53 offen offset:2048 sc1
    buffer_load_dwordx4 v[212:215], v9, s[32:35], s53 offen offset:3072 sc1
    buffer_load_dwordx4 v[216:219], v9, s[32:35], s54 offen offset:0 sc1
    s_call_b64 s[4:5], k1_kernel_hk_tile
    s_waitcnt lgkmcnt(0)
    s_barrier
    s_call_b64 s[4:5], k1_kernel_hk_epi
    s_waitcnt lgkmcnt(0)
    s_barrier
    s_nop 3
    s_branch k1_kernel_s
k1_kernel_hk_epi:
    s_lshl_b32 s58, s47, 9
    v_add_u32 v10, s58, v92
    ds_read2_b64 v[24:27], v10 offset1:2
    ds_read2_b64 v[28:31], v10 offset0:4 offset1:6
    s_and_b32 s53, s50, 1
    s_lshl_b32 s53, s53, 11
    v_add_u32 v11, s53, v93
    s_add_u32 s47, s47, 1
    s_cmp_ge_u32 s47, s46
    s_cselect_b32 s47, 0, s47
    s_waitcnt lgkmcnt(0)
    v_fma_f32 v12, v24, v84, v80
    v_fma_f32 v13, v26, v84, v81
    v_fma_f32 v14, v28, v84, v82
    v_fma_f32 v15, v30, v84, v83
    v_mul_f32 v12, v25, v12
    v_mul_f32 v13, v27, v13
    v_mul_f32 v14, v29, v14
    v_mul_f32 v15, v31, v15
    v_cvt_pk_bf16_f32 v12, v12, v13
    v_cvt_pk_bf16_f32 v13, v14, v15
    ds_write_b64 v11, v[12:13]
    s_add_u32 s50, s50, 1
    s_setpc_b64 s[4:5]
k1_kernel_hk_tile:
    s_add_u32 s67, s67, 1
    s_cmp_eq_u32 s67, 3
    s_cselect_b32 s67, 0, s67
    s_cselect_b32 s53, 0xfffec000, s69
    v_add_u32 v18, s53, v18
    v_add_u32 v19, s53, v19
    v_add_u32 v20, s53, v20
    v_add_u32 v21, s53, v21
    ds_read_b128 v[64:67], v18 offset:0
    ds_read_b128 v[68:71], v19 offset:0
    ds_read_b128 v[72:75], v20 offset:0
    ds_read_b128 v[76:79], v21 offset:0
    s_waitcnt lgkmcnt(3)
    v_mfma_f32_16x16x32_bf16 v[80:83], v[64:67], v[96:99], 0
    ds_read_b128 v[64:67], v18 offset:8192
    s_waitcnt lgkmcnt(3)
    v_mfma_f32_16x16x32_bf16 v[80:83], v[68:71], v[100:103], v[80:83]
    ds_read_b128 v[68:71], v19 offset:8192
    s_waitcnt lgkmcnt(3)
    v_mfma_f32_16x16x32_bf16 v[80:83], v[72:75], v[104:107], v[80:83]
    ds_read_b128 v[72:75], v20 offset:8192
    s_waitcnt lgkmcnt(3)
    v_mfma_f32_16x16x32_bf16 v[80:83], v[76:79], v[108:111], v[80:83]
    ds_read_b128 v[76:79], v21 offset:8192
    s_waitcnt lgkmcnt(3)
    v_mfma_f32_16x16x32_bf16 v[80:83], v[64:67], v[112:115], v[80:83]
    ds_read_b128 v[64:67], v18 offset:16384
    s_waitcnt lgkmcnt(3)
    v_mfma_f32_16x16x32_bf16 v[80:83], v[68:71], v[116:119], v[80:83]
    ds_read_b128 v[68:71], v19 offset:16384
    s_waitcnt lgkmcnt(3)
    v_mfma_f32_16x16x32_bf16 v[80:83], v[72:75], v[120:123], v[80:83]
    ds_read_b128 v[72:75], v20 offset:16384
    s_waitcnt lgkmcnt(3)
    v_mfma_f32_16x16x32_bf16 v[80:83], v[76:79], v[124:127], v[80:83]
    ds_read_b128 v[76:79], v21 offset:16384
    s_waitcnt lgkmcnt(3)
    v_mfma_f32_16x16x32_bf16 v[80:83], v[64:67], v[128:131], v[80:83]
    ds_read_b128 v[64:67], v18 offset:24576
    s_waitcnt lgkmcnt(3)
    v_mfma_f32_16x16x32_bf16 v[80:83], v[68:71], v[132:135], v[80:83]
    ds_read_b128 v[68:71], v19 offset:24576
    s_waitcnt lgkmcnt(3)
    v_mfma_f32_16x16x32_bf16 v[80:83], v[72:75], v[136:139], v[80:83]
    ds_read_b128 v[72:75], v20 offset:24576
    s_waitcnt lgkmcnt(3)
    v_mfma_f32_16x16x32_bf16 v[80:83], v[76:79], v[140:143], v[80:83]
    ds_read_b128 v[76:79], v21 offset:24576
    s_waitcnt lgkmcnt(3)
    v_mfma_f32_16x16x32_bf16 v[80:83], v[64:67], v[144:147], v[80:83]
    ds_read_b128 v[64:67], v18 offset:32768
    s_waitcnt lgkmcnt(3)
    v_mfma_f32_16x16x32_bf16 v[80:83], v[68:71], v[148:151], v[80:83]
    ds_read_b128 v[68:71], v19 offset:32768
    s_waitcnt lgkmcnt(3)
    v_mfma_f32_16x16x32_bf16 v[80:83], v[72:75], v[152:155], v[80:83]
    ds_read_b128 v[72:75], v20 offset:32768
    s_waitcnt lgkmcnt(3)
    v_mfma_f32_16x16x32_bf16 v[80:83], v[76:79], v[156:159], v[80:83]
    ds_read_b128 v[76:79], v21 offset:32768
    s_waitcnt lgkmcnt(3)
    v_mfma_f32_16x16x32_bf16 v[80:83], v[64:67], v[160:163], v[80:83]
    s_waitcnt lgkmcnt(2)
    v_mfma_f32_16x16x32_bf16 v[80:83], v[68:71], v[164:167], v[80:83]
    s_waitcnt lgkmcnt(1)
    v_mfma_f32_16x16x32_bf16 v[80:83], v[72:75], v[168:171], v[80:83]
    s_waitcnt lgkmcnt(0)
    v_mfma_f32_16x16x32_bf16 v[80:83], v[76:79], v[172:175], v[80:83]
    s_nop 5
    s_setpc_b64 s[4:5]
k1_kernel_s:
    s_mov_b32 s36, s44
    v_mbcnt_lo_u32_b32 v1, -1, 0
    v_mbcnt_hi_u32_b32 v1, -1, v1
    v_lshlrev_b32 v9, 4, v1
    v_add_u32 v5, 4096, v9
    v_mov_b32 v7, 162816
    v_and_b32 v10, 15, v1
    v_lshrrev_b32 v11, 4, v1
    v_lshlrev_b32 v2, 4, v10
    v_lshl_add_u32 v2, v11, 9, v2
    v_add_u32 v3, 151552, v2
    v_and_b32 v6, 31, v1
    v_mov_b32 v22, s11
    v_mov_b32 v16, s12
    v_cmp_gt_u32 vcc, 32, v1
    s_nop 1
    v_cndmask_b32 v22, v16, v22, vcc
    v_lshl_add_u32 v6, v6, 6, v22
    v_add_u32 v6, 12821504, v6
    s_mov_b32 s44, 0x7ffffff
    s_mov_b32 s45, 0x7ffffff
    s_cmp_lg_u32 s36, 7
    s_cbranch_scc1 k1_kernel_gAo
    s_mov_b32 s100, 20000
    buffer_load_dwordx2 v[22:23], v6, s[32:35], 0 offen sc1
    s_waitcnt vmcnt(0)
    v_cmp_eq_u32 s[96:97], 0, v23
    s_mov_b64 exec, s[44:45]
    s_branch k1_kernel_gAj
    s_mov_b64 exec, s[44:45]
k1_kernel_gAi:
    buffer_load_dword v22, v6, s[32:35], 0 offen offset:0 sc1
    s_waitcnt vmcnt(0)
k1_kernel_gAj:
    v_cmp_gt_u32 vcc, 2, v22
    s_sub_u32 s100, s100, 1
    s_cbranch_scc1 k1_kernel_gAd
    s_and_b64 exec, exec, vcc
    s_cbranch_scc1 k1_kernel_gAi
k1_kernel_gAd:
    s_mov_b64 exec, -1
    v_mov_b32 v22, 1
    ds_write_b32 v7, v22
k1_kernel_gAo:
    s_setprio 3
    s_and_b32 s37, s36, 1
    s_lshr_b32 s39, s36, 2
    s_xor_b32 s39, s39, s37
    s_mul_i32 s38, s37, 20480
    s_bitcmp1_b32 s36, 1
    s_cselect_b32 s40, 122880, s7
    s_add_u32 s38, s38, s40
    s_sub_u32 s56, s36, 4
    v_min_u32 v20, 2, v11
    v_lshl_add_u32 v20, v20, 5, s38
    v_lshrrev_b32 v16, 2, v10
    v_add_u32 v17, v16, v10
    v_mul_u32_u24 v16, 400, v16
    v_add_u32 v16, 320, v16
    v_and_b32 v18, 3, v10
    v_mov_b32 v19, 1600
    v_cmp_gt_u32 vcc, 2, v18
    s_nop 1
    v_cndmask_b32 v16, v19, v16, vcc
    v_and_b32 v18, 1, v10
    v_mul_u32_u24 v18, 1664, v18
    v_add3_u32 v12, v16, v18, v20
    v_mul_u32_u24 v17, 80, v17
    v_add_u32 v10, v17, v20
    v_mov_b32 v11, v10
    v_mov_b32 v19, 1073741824
    s_mov_b32 s44, -1
    s_mov_b32 s45, 0xffff
    v_cndmask_b32 v2, v19, v2, s[44:45]
    v_cndmask_b32 v3, v19, v3, s[44:45]
    s_mov_b32 s45, 0
    s_mov_b32 s46, 0xffff0000
    s_mov_b32 s47, 0xffff
    s_mov_b32 s48, 0x55555555
    s_mov_b32 s49, 0x5555
    s_mov_b32 s50, 0x55555555
    s_mov_b32 s51, 0
    s_mov_b32 s52, 0xaaaa0000
    s_mov_b32 s53, 0xaaaa
    s_mov_b32 s54, 0xaaaaaaaa
    s_mov_b32 s55, 0xaaaa
    s_mul_i32 s57, s56, 10240
    s_add_u32 s57, s57, s8
    s_add_u32 s57, s57, 110592
    s_mul_i32 s61, s56, 25600
    s_add_u32 s61, s61, s9
    s_add_u32 s61, s61, 276480
    s_add_u32 s58, s57, 2560
    s_add_u32 s59, s57, 5120
    s_add_u32 s60, s57, 7680
    s_add_u32 s62, s61, 5120
    s_add_u32 s63, s61, 10240
    s_add_u32 s64, s61, 15360
    s_add_u32 s65, s61, 20480
    s_mov_b32 s66, 897988541
    s_mov_b32 s67, 897988541
    v_mov_b32 v16, 0
    v_mov_b32 v17, 0
    v_mov_b32 v18, 897988541
    v_mov_b32 v19, 897988541
    v_lshlrev_b32 v4, 6, v1
    v_add_u32 v4, 12833792, v4
    buffer_load_dwordx4 v[116:119], v9, s[32:35], s63 offen offset:0 sc1
    buffer_load_dwordx4 v[120:123], v9, s[32:35], s63 offen offset:1024 sc1
    buffer_load_dwordx4 v[124:127], v9, s[32:35], s63 offen offset:2048 sc1
    buffer_load_dwordx4 v[128:131], v9, s[32:35], s63 offen offset:3072 sc1
    buffer_load_dwordx4 v[132:135], v5, s[32:35], s63 offen offset:0 sc1
    s_waitcnt vmcnt(10)
    v_mov_b32 v22, 0x100
    s_mov_b64 exec, 1
    ds_add_u32 v7, v22 offset:4
    s_mov_b64 exec, -1
    s_cmp_lg_u32 s36, 7
    s_cbranch_scc1 k1_kernel_gFo
    s_cmp_eq_u32 s100, 19999
    s_cbranch_scc1 k1_kernel_gFn
k1_kernel_gFn:
    s_bcnt1_i32_b64 s40, s[96:97]
    s_mul_i32 s40, s40, 10
    s_lshr_b32 s40, s40, 3
k1_kernel_gFz:
    s_sleep 1
    s_sub_u32 s40, s40, 1
    s_cbranch_scc0 k1_kernel_gFz
    s_mov_b32 s41, 65536
k1_kernel_gFc:
    ds_read_b32 v22, v7 offset:4
    s_waitcnt lgkmcnt(0)
    v_readfirstlane_b32 s40, v22
    s_nop 0
    s_cmp_ge_u32 s40, 1028
    s_cbranch_scc1 k1_kernel_gFcx
    s_sleep 1
    s_sub_u32 s41, s41, 1
    s_cbranch_scc0 k1_kernel_gFc
k1_kernel_gFcx:
    s_mov_b64 s[98:99], -1
    s_mov_b32 s41, 20000
k1_kernel_gFi:
    s_mov_b64 exec, s[96:97]
    buffer_load_dword v22, v6, s[32:35], 0 offen offset:4 sc1
    s_mov_b64 exec, s[98:99]
    buffer_load_dword v21, v4, s[32:35], 0 offen offset:4 sc1
    s_mov_b64 exec, s[96:97]
    s_waitcnt vmcnt(1)
    v_cmp_eq_u32 s[96:97], 0, v22
    s_sub_u32 s41, s41, 1
    s_cbranch_scc1 k1_kernel_gFd
    s_mov_b64 exec, s[98:99]
    s_cmp_eq_u64 s[96:97], 0
    s_cbranch_scc1 k1_kernel_gFd
    s_waitcnt vmcnt(0)
    v_cmp_eq_u32 s[98:99], 0, v21
    s_bcnt1_i32_b64 s40, s[96:97]
    s_mul_i32 s40, s40, 4
    s_lshr_b32 s40, s40, 3
k1_kernel_gFy:
    s_sub_u32 s40, s40, 1
    s_cbranch_scc1 k1_kernel_gFi
    s_sleep 1
    s_branch k1_kernel_gFy
    s_branch k1_kernel_gFi
k1_kernel_gFd:
    s_mov_b64 exec, s[98:99]
    s_waitcnt vmcnt(0)
    v_cmp_eq_u32 s[98:99], 0, v21
    s_mov_b64 exec, -1
    s_nop 3
    s_cmp_eq_u64 s[98:99], 0
    s_cselect_b32 s43, 3, 2
    v_mov_b32 v22, s43
    ds_write_b32 v7, v22
    s_waitcnt lgkmcnt(0)
    s_branch k1_kernel_gFe
k1_kernel_gFo:
    s_mov_b32 s41, 65536
k1_kernel_gFs:
    ds_read_b32 v22, v7 offset:0
    s_waitcnt lgkmcnt(0)
    v_readfirstlane_b32 s40, v22
    s_nop 0
    s_cmp_ge_u32 s40, 2
    s_cbranch_scc1 k1_kernel_gFsx
    s_sleep 2
    s_sub_u32 s41, s41, 1
    s_cbranch_scc0 k1_kernel_gFs
k1_kernel_gFsx:
k1_kernel_gFe:
    buffer_load_dwordx4 v[24:27], v2, s[32:35], s57 offen offset:0 sc1
    buffer_load_dwordx4 v[28:31], v2, s[32:35], s57 offen offset:1024 sc1
    buffer_load_dwordx4 v[32:35], v2, s[32:35], s57 offen offset:256 sc1
    buffer_load_dwordx4 v[36:39], v2, s[32:35], s57 offen offset:1280 sc1
    buffer_load_dwordx4 v[40:43], v3, s[32:35], s57 offen offset:0 sc1
    buffer_load_dwordx4 v[44:47], v3, s[32:35], s57 offen offset:1024 sc1
    buffer_load_dwordx4 v[48:51], v3, s[32:35], s57 offen offset:256 sc1
    buffer_load_dwordx4 v[52:55], v3, s[32:35], s57 offen offset:1280 sc1
    buffer_load_dwordx4 v[56:59], v2, s[32:35], s58 offen offset:0 sc1
    buffer_load_dwordx4 v[60:63], v2, s[32:35], s58 offen offset:1024 sc1
    buffer_load_dwordx4 v[64:67], v2, s[32:35], s58 offen offset:256 sc1
    buffer_load_dwordx4 v[68:71], v2, s[32:35], s58 offen offset:1280 sc1
    s_cmp_lg_u32 s36, 7
    s_cbranch_scc1 k1_kernel_gKo
    s_cmp_eq_u32 s43, 3
    s_cbranch_scc1 k1_kernel_gKe
    s_mov_b32 s41, 20000
    s_mov_b64 exec, s[98:99]
k1_kernel_gKi:
    buffer_load_dword v21, v4, s[32:35], 0 offen offset:4 sc1
    s_waitcnt vmcnt(0)
    v_cmp_eq_u32 vcc, 0, v21
    s_sub_u32 s41, s41, 1
    s_cbranch_scc1 k1_kernel_gKd
    s_and_b64 exec, exec, vcc
    s_cbranch_scc1 k1_kernel_gKi
k1_kernel_gKd:
    s_mov_b64 exec, -1
    v_mov_b32 v22, 3
    ds_write_b32 v7, v22
    s_waitcnt lgkmcnt(0)
    s_branch k1_kernel_gKe
k1_kernel_gKo:
    s_mov_b32 s41, 65536
k1_kernel_gKs:
    ds_read_b32 v22, v7 offset:0
    s_waitcnt lgkmcnt(0)
    v_readfirstlane_b32 s40, v22
    s_nop 0
    s_cmp_ge_u32 s40, 3
    s_cbranch_scc1 k1_kernel_gKsx
    s_sleep 2
    s_sub_u32 s41, s41, 1
    s_cbranch_scc0 k1_kernel_gKs
k1_kernel_gKsx:
    v_mov_b32 v22, 1
    s_mov_b64 exec, 1
    ds_add_u32 v7, v22 offset:8
    s_mov_b64 exec, -1
    s_waitcnt lgkmcnt(0)
k1_kernel_gKe:
    v_add_u32 v4, s38, v9
    s_mul_i32 s42, s56, 13440
    s_add_u32 s42, s42, 12767232
    s_add_u32 m0, s38, 0
    s_nop 0
    buffer_load_dwordx4 v9, s[32:35], s42 offen sc1 lds
    s_add_u32 s42, s42, 1024
    s_add_u32 m0, s38, 1024
    s_nop 0
    buffer_load_dwordx4 v9, s[32:35], s42 offen sc1 lds
    s_add_u32 s42, s42, 1024
    s_add_u32 m0, s38, 2048
    s_nop 0
    buffer_load_dwordx4 v9, s[32:35], s42 offen sc1 lds
    s_add_u32 s42, s42, 1024
    s_add_u32 m0, s38, 3072
    s_nop 0
    buffer_load_dwordx4 v9, s[32:35], s42 offen sc1 lds
    s_add_u32 s42, s42, 1024
    s_add_u32 m0, s38, 4096
    s_nop 0
    buffer_load_dwordx4 v9, s[32:35], s42 offen sc1 lds
    s_add_u32 s42, s42, 1024
    s_add_u32 m0, s38, 5120
    s_nop 0
    buffer_load_dwordx4 v9, s[32:35], s42 offen sc1 lds
    s_add_u32 s42, s42, 1024
    s_add_u32 m0, s38, 6144
    s_nop 0
    buffer_load_dwordx4 v9, s[32:35], s42 offen sc1 lds
    s_add_u32 s42, s42, 1024
    s_add_u32 m0, s38, 7168
    s_nop 0
    buffer_load_dwordx4 v9, s[32:35], s42 offen sc1 lds
    s_add_u32 s42, s42, 1024
    s_add_u32 m0, s38, 8192
    s_nop 0
    buffer_load_dwordx4 v9, s[32:35], s42 offen sc1 lds
    s_add_u32 s42, s42, 1024
    s_add_u32 m0, s38, 9216
    s_nop 0
    buffer_load_dwordx4 v9, s[32:35], s42 offen sc1 lds
    s_add_u32 s42, s42, 1024
    s_add_u32 m0, s38, 10240
    s_nop 0
    buffer_load_dwordx4 v9, s[32:35], s42 offen sc1 lds
    s_add_u32 s42, s42, 1024
    s_add_u32 m0, s38, 11264
    s_nop 0
    buffer_load_dwordx4 v9, s[32:35], s42 offen sc1 lds
    s_add_u32 s42, s42, 1024
    s_add_u32 m0, s38, 12288
    s_nop 0
    buffer_load_dwordx4 v9, s[32:35], s42 offen sc1 lds
    s_add_u32 s42, s42, 1024
    s_add_u32 m0, s38, 13312
    s_mov_b64 exec, 0xfff
    buffer_load_dwordx4 v9, s[32:35], s42 offen sc1 lds
    s_mov_b64 exec, -1
    buffer_load_dwordx4 v[72:75], v3, s[32:35], s58 offen offset:0 sc1
    buffer_load_dwordx4 v[76:79], v3, s[32:35], s58 offen offset:1024 sc1
    buffer_load_dwordx4 v[80:83], v3, s[32:35], s58 offen offset:256 sc1
    buffer_load_dwordx4 v[84:87], v3, s[32:35], s58 offen offset:1280 sc1
    buffer_load_dwordx4 v[88:91], v2, s[32:35], s59 offen offset:0 sc1
    buffer_load_dwordx4 v[92:95], v2, s[32:35], s59 offen offset:1024 sc1
    buffer_load_dwordx4 v[96:99], v2, s[32:35], s59 offen offset:256 sc1
    buffer_load_dwordx4 v[100:103], v2, s[32:35], s59 offen offset:1280 sc1
    buffer_load_dwordx4 v[104:107], v3, s[32:35], s59 offen offset:0 sc1
    buffer_load_dwordx4 v[108:111], v3, s[32:35], s59 offen offset:1024 sc1
    buffer_load_dwordx4 v[112:115], v3, s[32:35], s59 offen offset:256 sc1
    s_waitcnt vmcnt(21)
    ds_read_b128 v[136:139], v10 offset:0
    ds_read_b128 v[140:143], v10 offset:16
    ds_read_b128 v[144:147], v11 offset:1664
    ds_read_b128 v[148:151], v11 offset:1680
    ds_read_b128 v[152:155], v12 offset:0
    ds_read_b128 v[156:159], v12 offset:16
    s_waitcnt lgkmcnt(5)
    v_cvt_pk_bf16_f32 v136, v136, v137
    v_cvt_pk_bf16_f32 v137, v138, v139
    s_waitcnt lgkmcnt(4)
    v_cvt_pk_bf16_f32 v138, v140, v141
    v_cvt_pk_bf16_f32 v139, v142, v143
    s_waitcnt lgkmcnt(3)
    v_cvt_pk_bf16_f32 v144, v144, v145
    v_cvt_pk_bf16_f32 v145, v146, v147
    s_waitcnt lgkmcnt(2)
    v_cvt_pk_bf16_f32 v146, v148, v149
    v_cvt_pk_bf16_f32 v147, v150, v151
    s_waitcnt lgkmcnt(1)
    v_cvt_pk_bf16_f32 v152, v152, v153
    v_cvt_pk_bf16_f32 v153, v154, v155
    s_waitcnt lgkmcnt(0)
    v_cvt_pk_bf16_f32 v154, v156, v157
    v_cvt_pk_bf16_f32 v155, v158, v159
    v_cndmask_b32 v138, 0, v138, s[44:45]
    v_cndmask_b32 v139, 0, v139, s[44:45]
    v_cndmask_b32 v144, 0, v144, s[46:47]
    v_cndmask_b32 v145, 0, v145, s[46:47]
    v_cndmask_b32 v156, 0, v152, s[52:53]
    v_cndmask_b32 v157, 0, v153, s[52:53]
    v_cndmask_b32 v158, 0, v154, s[54:55]
    v_cndmask_b32 v159, 0, v155, s[54:55]
    v_cndmask_b32 v152, 0, v152, s[48:49]
    v_cndmask_b32 v153, 0, v153, s[48:49]
    v_cndmask_b32 v154, 0, v154, s[50:51]
    v_cndmask_b32 v155, 0, v155, s[50:51]
    s_nop 1
    v_mfma_f32_16x16x32_bf16 v[160:163], v[152:155], v[24:27], v[16:19]
    v_mfma_f32_16x16x32_bf16 v[164:167], v[136:139], v[24:27], 0
    v_mfma_f32_16x16x32_bf16 v[168:171], v[144:147], v[28:31], 0
    v_mfma_f32_16x16x32_bf16 v[160:163], v[156:159], v[28:31], v[160:163]
    v_mfma_f32_16x16x32_bf16 v[172:175], v[152:155], v[32:35], v[16:19]
    v_mfma_f32_16x16x32_bf16 v[176:179], v[136:139], v[32:35], 0
    v_mfma_f32_16x16x32_bf16 v[220:223], v[144:147], v[36:39], 0
    s_nop 4
    v_rcp_f32 v162, v162
    v_rcp_f32 v163, v163
    v_mul_f32 v164, v164, v162
    v_mul_f32 v165, v165, v162
    v_mul_f32 v166, v166, v162
    v_mul_f32 v167, v167, v162
    v_mul_f32 v168, v168, v163
    v_cvt_pk_bf16_f32 v224, v164, v165
    v_mfma_f32_16x16x32_bf16 v[172:175], v[156:159], v[36:39], v[172:175]
    v_mul_f32 v169, v169, v163
    v_cvt_pk_bf16_f32 v225, v166, v167
    v_mul_f32 v170, v170, v163
    v_mul_f32 v171, v171, v163
    v_mul_f32 v160, v160, v162
    v_cvt_pk_bf16_f32 v226, v168, v169
    v_mul_f32 v161, v161, v163
    v_cvt_pk_bf16_f32 v227, v170, v171
    v_cvt_pk_bf16_f32 v228, v160, v161
    v_mfma_f32_16x16x32_bf16 v[232:235], v[152:155], v[40:43], v[16:19]
    v_mfma_f32_16x16x32_bf16 v[236:239], v[136:139], v[40:43], 0
    v_mfma_f32_16x16x32_bf16 v[240:243], v[144:147], v[44:47], 0
    v_rcp_f32 v174, v174
    v_rcp_f32 v175, v175
    v_mfma_f32_16x16x32_bf16 v[232:235], v[156:159], v[44:47], v[232:235]
    v_mul_f32 v176, v176, v174
    v_mul_f32 v177, v177, v174
    v_mfma_f32_16x16x32_bf16 v[244:247], v[180:183], v[224:227], 0
    v_mul_f32 v178, v178, v174
    v_mul_f32 v179, v179, v174
    v_mul_f32 v220, v220, v175
    v_mfma_f32_16x16x32_bf16 v[248:251], v[184:187], v[224:227], 0
    v_cvt_pk_bf16_f32 v252, v176, v177
    v_mul_f32 v221, v221, v175
    v_cvt_pk_bf16_f32 v253, v178, v179
    v_mul_f32 v222, v222, v175
    v_mfma_f32_16x16x32_bf16 v[140:143], v[188:191], v[224:227], 0
    v_mul_f32 v223, v223, v175
    v_mul_f32 v172, v172, v174
    v_cvt_pk_bf16_f32 v254, v220, v221
    v_mfma_f32_16x16x32_bf16 v[148:151], v[192:195], v[224:227], 0
    v_mul_f32 v173, v173, v175
    v_cvt_pk_bf16_f32 v255, v222, v223
    v_cvt_pk_bf16_f32 v24, v172, v173
    v_mfma_f32_16x16x32_bf16 v[28:31], v[196:199], v[224:227], 0
    s_waitcnt vmcnt(18)
    ds_read_b128 v[32:35], v10 offset:3360
    ds_read_b128 v[36:39], v10 offset:3376
    ds_read_b128 v[164:167], v11 offset:5024
    ds_read_b128 v[168:171], v11 offset:5040
    ds_read_b128 v[160:163], v12 offset:3360
    ds_read_b128 v[40:43], v12 offset:3376
    v_mfma_f32_16x16x32_bf16 v[44:47], v[152:155], v[48:51], v[16:19]
    v_rcp_f32 v234, v234
    v_rcp_f32 v235, v235
    v_mul_f32 v236, v236, v234
    v_mfma_f32_16x16x32_bf16 v[176:179], v[136:139], v[48:51], 0
    v_mul_f32 v237, v237, v234
    v_mul_f32 v238, v238, v234
    v_mul_f32 v239, v239, v234
    v_mul_f32 v240, v240, v235
    v_cvt_pk_bf16_f32 v220, v236, v237
    v_mfma_f32_16x16x32_bf16 v[172:175], v[144:147], v[52:55], 0
    v_mul_f32 v241, v241, v235
    v_cvt_pk_bf16_f32 v221, v238, v239
    v_mul_f32 v242, v242, v235
    v_mul_f32 v243, v243, v235
    v_mfma_f32_16x16x32_bf16 v[44:47], v[156:159], v[52:55], v[44:47]
    v_mul_f32 v232, v232, v234
    v_cvt_pk_bf16_f32 v222, v240, v241
    v_mul_f32 v233, v233, v235
    v_cvt_pk_bf16_f32 v223, v242, v243
    v_cvt_pk_bf16_f32 v224, v232, v233
    v_mfma_f32_16x16x32_bf16 v[152:155], v[180:183], v[252:255], 0
    s_waitcnt lgkmcnt(5)
    v_cvt_pk_bf16_f32 v32, v32, v33
    v_cvt_pk_bf16_f32 v33, v34, v35
    s_waitcnt lgkmcnt(4)
    v_cvt_pk_bf16_f32 v34, v36, v37
    v_cvt_pk_bf16_f32 v35, v38, v39
    s_waitcnt lgkmcnt(3)
    v_cvt_pk_bf16_f32 v164, v164, v165
    v_mfma_f32_16x16x32_bf16 v[48:51], v[184:187], v[252:255], 0
    v_cvt_pk_bf16_f32 v165, v166, v167
    s_waitcnt lgkmcnt(2)
    v_cvt_pk_bf16_f32 v166, v168, v169
    v_cvt_pk_bf16_f32 v167, v170, v171
    s_waitcnt lgkmcnt(1)
    v_cvt_pk_bf16_f32 v160, v160, v161
    v_cvt_pk_bf16_f32 v161, v162, v163
    v_mfma_f32_16x16x32_bf16 v[136:139], v[188:191], v[252:255], 0
    s_waitcnt lgkmcnt(0)
    v_cvt_pk_bf16_f32 v162, v40, v41
    v_cvt_pk_bf16_f32 v163, v42, v43
    v_cndmask_b32 v34, 0, v34, s[44:45]
    v_cndmask_b32 v35, 0, v35, s[44:45]
    v_mfma_f32_16x16x32_bf16 v[144:147], v[192:195], v[252:255], 0
    v_cndmask_b32 v164, 0, v164, s[46:47]
    v_cndmask_b32 v165, 0, v165, s[46:47]
    v_cndmask_b32 v40, 0, v160, s[52:53]
    v_cndmask_b32 v41, 0, v161, s[52:53]
    v_cndmask_b32 v42, 0, v162, s[54:55]
    v_mfma_f32_16x16x32_bf16 v[236:239], v[196:199], v[252:255], 0
    v_cndmask_b32 v43, 0, v163, s[54:55]
    v_cndmask_b32 v160, 0, v160, s[48:49]
    v_cndmask_b32 v161, 0, v161, s[48:49]
    v_cndmask_b32 v162, 0, v162, s[50:51]
    v_cndmask_b32 v163, 0, v163, s[50:51]
    s_nop 1
    v_mfma_f32_16x16x32_bf16 v[52:55], v[160:163], v[56:59], v[16:19]
    v_rcp_f32 v46, v46
    v_mfma_f32_16x16x32_bf16 v[156:159], v[32:35], v[56:59], 0
    v_rcp_f32 v47, v47
    v_mfma_f32_16x16x32_bf16 v[240:243], v[164:167], v[60:63], 0
    v_mul_f32 v176, v176, v46
    v_mul_f32 v177, v177, v46
    v_mfma_f32_16x16x32_bf16 v[52:55], v[40:43], v[60:63], v[52:55]
    v_mul_f32 v178, v178, v46
    v_mul_f32 v179, v179, v46
    v_mfma_f32_16x16x32_bf16 v[232:235], v[180:183], v[220:223], 0
    v_mul_f32 v172, v172, v47
    v_cvt_pk_bf16_f32 v36, v176, v177
    v_mul_f32 v173, v173, v47
    v_mfma_f32_16x16x32_bf16 v[168:171], v[184:187], v[220:223], 0
    v_cvt_pk_bf16_f32 v37, v178, v179
    v_mul_f32 v174, v174, v47
    v_mfma_f32_16x16x32_bf16 v[252:255], v[188:191], v[220:223], 0
    v_mul_f32 v175, v175, v47
    v_mul_f32 v44, v44, v46
    v_mfma_f32_16x16x32_bf16 v[56:59], v[192:195], v[220:223], 0
    v_cvt_pk_bf16_f32 v38, v172, v173
    v_mul_f32 v45, v45, v47
    v_mfma_f32_16x16x32_bf16 v[60:63], v[196:199], v[220:223], 0
    v_cvt_pk_bf16_f32 v39, v174, v175
    v_cvt_pk_bf16_f32 v176, v44, v45
    v_mfma_f32_16x16x32_bf16 v[220:223], v[160:163], v[64:67], v[16:19]
    v_rcp_f32 v54, v54
    v_mfma_f32_16x16x32_bf16 v[172:175], v[32:35], v[64:67], 0
    v_rcp_f32 v55, v55
    v_mfma_f32_16x16x32_bf16 v[44:47], v[164:167], v[68:71], 0
    v_mul_f32 v156, v156, v54
    v_mul_f32 v157, v157, v54
    v_mfma_f32_16x16x32_bf16 v[220:223], v[40:43], v[68:71], v[220:223]
    v_mul_f32 v158, v158, v54
    v_mul_f32 v159, v159, v54
    v_mfma_f32_16x16x32_bf16 v[64:67], v[180:183], v[36:39], 0
    v_mul_f32 v240, v240, v55
    v_cvt_pk_bf16_f32 v229, v156, v157
    v_mul_f32 v241, v241, v55
    v_mfma_f32_16x16x32_bf16 v[68:71], v[184:187], v[36:39], 0
    v_cvt_pk_bf16_f32 v230, v158, v159
    v_mul_f32 v242, v242, v55
    v_mfma_f32_16x16x32_bf16 v[180:183], v[188:191], v[36:39], 0
    v_mul_f32 v243, v243, v55
    v_mul_f32 v52, v52, v54
    v_mfma_f32_16x16x32_bf16 v[184:187], v[192:195], v[36:39], 0
    v_cvt_pk_bf16_f32 v231, v240, v241
    v_mul_f32 v53, v53, v55
    v_mfma_f32_16x16x32_bf16 v[156:159], v[196:199], v[36:39], 0
    v_cvt_pk_bf16_f32 v188, v242, v243
    v_cvt_pk_bf16_f32 v189, v52, v53
    s_waitcnt vmcnt(10)
    v_mfma_f32_16x16x32_bf16 v[192:195], v[160:163], v[72:75], v[16:19]
    v_rcp_f32 v222, v222
    v_mfma_f32_16x16x32_bf16 v[36:39], v[32:35], v[72:75], 0
    v_rcp_f32 v223, v223
    v_mul_f32 v172, v172, v222
    s_waitcnt vmcnt(9)
    v_mfma_f32_16x16x32_bf16 v[196:199], v[164:167], v[76:79], 0
    v_mul_f32 v173, v173, v222
    v_mul_f32 v174, v174, v222
    v_mfma_f32_16x16x32_bf16 v[192:195], v[40:43], v[76:79], v[192:195]
    v_mul_f32 v175, v175, v222
    v_mul_f32 v44, v44, v223
    v_cvt_pk_bf16_f32 v25, v172, v173
    v_mfma_f32_16x16x32_bf16 v[244:247], v[200:203], v[228:231], v[244:247]
    v_mul_f32 v45, v45, v223
    v_cvt_pk_bf16_f32 v26, v174, v175
    v_mfma_f32_16x16x32_bf16 v[248:251], v[204:207], v[228:231], v[248:251]
    v_mul_f32 v46, v46, v223
    v_mul_f32 v47, v47, v223
    v_mul_f32 v220, v220, v222
    v_mfma_f32_16x16x32_bf16 v[140:143], v[208:211], v[228:231], v[140:143]
    v_cvt_pk_bf16_f32 v27, v44, v45
    v_mul_f32 v221, v221, v223
    v_mfma_f32_16x16x32_bf16 v[148:151], v[212:215], v[228:231], v[148:151]
    v_cvt_pk_bf16_f32 v240, v46, v47
    v_cvt_pk_bf16_f32 v241, v220, v221
    ds_read_b128 v[52:55], v10 offset:6720
    v_mfma_f32_16x16x32_bf16 v[28:31], v[216:219], v[228:231], v[28:31]
    ds_read_b128 v[72:75], v10 offset:6736
    ds_read_b128 v[76:79], v11 offset:8384
    ds_read_b128 v[172:175], v11 offset:8400
    ds_read_b128 v[44:47], v12 offset:6720
    ds_read_b128 v[220:223], v12 offset:6736
    s_waitcnt vmcnt(8)
    v_mfma_f32_16x16x32_bf16 v[228:231], v[160:163], v[80:83], v[16:19]
    v_rcp_f32 v194, v194
    v_rcp_f32 v195, v195
    v_mul_f32 v36, v36, v194
    v_mfma_f32_16x16x32_bf16 v[160:163], v[32:35], v[80:83], 0
    v_mul_f32 v37, v37, v194
    v_mul_f32 v38, v38, v194
    buffer_load_dwordx4 v[32:35], v3, s[32:35], s59 offen offset:1280 sc1
    v_mul_f32 v39, v39, v194
    v_mul_f32 v196, v196, v195
    v_cvt_pk_bf16_f32 v225, v36, v37
    s_waitcnt vmcnt(8)
    v_mfma_f32_16x16x32_bf16 v[80:83], v[164:167], v[84:87], 0
    v_mul_f32 v197, v197, v195
    v_cvt_pk_bf16_f32 v226, v38, v39
    buffer_load_dwordx4 v[164:167], v2, s[32:35], s60 offen offset:0 sc1
    v_mul_f32 v198, v198, v195
    v_mul_f32 v199, v199, v195
    buffer_load_dwordx4 v[36:39], v2, s[32:35], s60 offen offset:1024 sc1
    v_mfma_f32_16x16x32_bf16 v[228:231], v[40:43], v[84:87], v[228:231]
    v_mul_f32 v192, v192, v194
    v_cvt_pk_bf16_f32 v227, v196, v197
    buffer_load_dwordx4 v[40:43], v2, s[32:35], s60 offen offset:256 sc1
    v_mul_f32 v193, v193, v195
    v_cvt_pk_bf16_f32 v84, v198, v199
    v_cvt_pk_bf16_f32 v85, v192, v193
    v_mfma_f32_16x16x32_bf16 v[152:155], v[200:203], v[24:27], v[152:155]
    buffer_load_dwordx4 v[196:199], v2, s[32:35], s60 offen offset:1280 sc1
    s_waitcnt lgkmcnt(5)
    v_cvt_pk_bf16_f32 v52, v52, v53
    buffer_load_dwordx4 v[192:195], v3, s[32:35], s60 offen offset:0 sc1
    v_cvt_pk_bf16_f32 v53, v54, v55
    s_waitcnt lgkmcnt(4)
    v_cvt_pk_bf16_f32 v54, v72, v73
    v_cvt_pk_bf16_f32 v55, v74, v75
    s_waitcnt lgkmcnt(3)
    v_cvt_pk_bf16_f32 v76, v76, v77
    v_mfma_f32_16x16x32_bf16 v[48:51], v[204:207], v[24:27], v[48:51]
    v_cvt_pk_bf16_f32 v77, v78, v79
    s_waitcnt lgkmcnt(2)
    v_cvt_pk_bf16_f32 v78, v172, v173
    v_cvt_pk_bf16_f32 v79, v174, v175
    s_waitcnt lgkmcnt(1)
    v_cvt_pk_bf16_f32 v44, v44, v45
    v_cvt_pk_bf16_f32 v45, v46, v47
    v_mfma_f32_16x16x32_bf16 v[136:139], v[208:211], v[24:27], v[136:139]
    s_waitcnt lgkmcnt(0)
    v_cvt_pk_bf16_f32 v46, v220, v221
    v_cvt_pk_bf16_f32 v47, v222, v223
    v_cndmask_b32 v54, 0, v54, s[44:45]
    v_cndmask_b32 v55, 0, v55, s[44:45]
    v_mfma_f32_16x16x32_bf16 v[144:147], v[212:215], v[24:27], v[144:147]
    v_cndmask_b32 v76, 0, v76, s[46:47]
    v_cndmask_b32 v77, 0, v77, s[46:47]
    v_cndmask_b32 v220, 0, v44, s[52:53]
    v_cndmask_b32 v221, 0, v45, s[52:53]
    v_cndmask_b32 v222, 0, v46, s[54:55]
    v_mfma_f32_16x16x32_bf16 v[236:239], v[216:219], v[24:27], v[236:239]
    v_cndmask_b32 v223, 0, v47, s[54:55]
    v_cndmask_b32 v44, 0, v44, s[48:49]
    v_cndmask_b32 v45, 0, v45, s[48:49]
    v_cndmask_b32 v46, 0, v46, s[50:51]
    v_cndmask_b32 v47, 0, v47, s[50:51]
    s_waitcnt vmcnt(12)
    s_nop 0
    v_mfma_f32_16x16x32_bf16 v[72:75], v[44:47], v[88:91], v[16:19]
    v_rcp_f32 v230, v230
    v_mfma_f32_16x16x32_bf16 v[172:175], v[52:55], v[88:91], 0
    v_rcp_f32 v231, v231
    s_waitcnt vmcnt(11)
    v_mfma_f32_16x16x32_bf16 v[24:27], v[76:79], v[92:95], 0
    buffer_load_dwordx4 v[88:91], v3, s[32:35], s60 offen offset:1024 sc1
    v_mul_f32 v160, v160, v230
    v_mul_f32 v161, v161, v230
    v_mfma_f32_16x16x32_bf16 v[72:75], v[220:223], v[92:95], v[72:75]
    v_mul_f32 v162, v162, v230
    v_mul_f32 v163, v163, v230
    buffer_load_dwordx4 v[92:95], v3, s[32:35], s60 offen offset:256 sc1
    v_mfma_f32_16x16x32_bf16 v[232:235], v[200:203], v[224:227], v[232:235]
    v_mul_f32 v80, v80, v231
    v_cvt_pk_bf16_f32 v177, v160, v161
    v_mul_f32 v81, v81, v231
    v_mfma_f32_16x16x32_bf16 v[168:171], v[204:207], v[224:227], v[168:171]
    v_cvt_pk_bf16_f32 v178, v162, v163
    v_mul_f32 v82, v82, v231
    v_mfma_f32_16x16x32_bf16 v[252:255], v[208:211], v[224:227], v[252:255]
    v_mul_f32 v83, v83, v231
    v_mul_f32 v228, v228, v230
    v_mfma_f32_16x16x32_bf16 v[56:59], v[212:215], v[224:227], v[56:59]
    v_cvt_pk_bf16_f32 v179, v80, v81
    v_mul_f32 v229, v229, v231
    v_mfma_f32_16x16x32_bf16 v[60:63], v[216:219], v[224:227], v[60:63]
    v_cvt_pk_bf16_f32 v160, v82, v83
    v_cvt_pk_bf16_f32 v161, v228, v229
    s_waitcnt vmcnt(12)
    v_mfma_f32_16x16x32_bf16 v[224:227], v[44:47], v[96:99], v[16:19]
    v_rcp_f32 v74, v74
    v_mfma_f32_16x16x32_bf16 v[80:83], v[52:55], v[96:99], 0
    v_rcp_f32 v75, v75
    s_waitcnt vmcnt(11)
    v_mfma_f32_16x16x32_bf16 v[228:231], v[76:79], v[100:103], 0
    buffer_load_dwordx4 v[96:99], v3, s[32:35], s60 offen offset:1280 sc1
    v_mul_f32 v172, v172, v74
    v_mul_f32 v173, v173, v74
    v_mfma_f32_16x16x32_bf16 v[224:227], v[220:223], v[100:103], v[224:227]
    v_mul_f32 v174, v174, v74
    v_mul_f32 v175, v175, v74
    buffer_load_dwordx4 v[100:103], v9, s[32:35], s64 offen offset:0 sc1
    v_mfma_f32_16x16x32_bf16 v[64:67], v[200:203], v[176:179], v[64:67]
    v_mul_f32 v24, v24, v75
    v_cvt_pk_bf16_f32 v190, v172, v173
    buffer_load_dwordx4 v[200:203], v9, s[32:35], s64 offen offset:1024 sc1
    v_mul_f32 v25, v25, v75
    v_mfma_f32_16x16x32_bf16 v[68:71], v[204:207], v[176:179], v[68:71]
    v_cvt_pk_bf16_f32 v191, v174, v175
    v_mul_f32 v26, v26, v75
    buffer_load_dwordx4 v[204:207], v9, s[32:35], s64 offen offset:2048 sc1
    v_mfma_f32_16x16x32_bf16 v[180:183], v[208:211], v[176:179], v[180:183]
    buffer_load_dwordx4 v[172:175], v9, s[32:35], s64 offen offset:3072 sc1
    v_mul_f32 v27, v27, v75
    v_mul_f32 v72, v72, v74
    v_mfma_f32_16x16x32_bf16 v[184:187], v[212:215], v[176:179], v[184:187]
    v_cvt_pk_bf16_f32 v208, v24, v25
    v_mul_f32 v73, v73, v75
    v_mfma_f32_16x16x32_bf16 v[156:159], v[216:219], v[176:179], v[156:159]
    v_cvt_pk_bf16_f32 v209, v26, v27
    v_cvt_pk_bf16_f32 v210, v72, v73
    s_waitcnt vmcnt(15)
    v_mfma_f32_16x16x32_bf16 v[212:215], v[44:47], v[104:107], v[16:19]
    v_rcp_f32 v226, v226
    v_mfma_f32_16x16x32_bf16 v[176:179], v[52:55], v[104:107], 0
    v_rcp_f32 v227, v227
    v_mul_f32 v80, v80, v226
    s_waitcnt vmcnt(14)
    v_mfma_f32_16x16x32_bf16 v[216:219], v[76:79], v[108:111], 0
    v_mul_f32 v81, v81, v226
    v_mul_f32 v82, v82, v226
    v_mfma_f32_16x16x32_bf16 v[212:215], v[220:223], v[108:111], v[212:215]
    v_mul_f32 v83, v83, v226
    v_mul_f32 v228, v228, v227
    v_cvt_pk_bf16_f32 v242, v80, v81
    v_mfma_f32_16x16x32_bf16 v[244:247], v[116:119], v[188:191], v[244:247]
    v_mul_f32 v229, v229, v227
    v_cvt_pk_bf16_f32 v243, v82, v83
    v_mfma_f32_16x16x32_bf16 v[248:251], v[120:123], v[188:191], v[248:251]
    v_mul_f32 v230, v230, v227
    v_mul_f32 v231, v231, v227
    v_mul_f32 v224, v224, v226
    v_mfma_f32_16x16x32_bf16 v[140:143], v[124:127], v[188:191], v[140:143]
    v_cvt_pk_bf16_f32 v24, v228, v229
    v_mul_f32 v225, v225, v227
    v_mfma_f32_16x16x32_bf16 v[148:151], v[128:131], v[188:191], v[148:151]
    v_cvt_pk_bf16_f32 v25, v230, v231
    v_cvt_pk_bf16_f32 v26, v224, v225
    ds_read_b128 v[72:75], v10 offset:10080
    v_mfma_f32_16x16x32_bf16 v[28:31], v[132:135], v[188:191], v[28:31]
    ds_read_b128 v[104:107], v10 offset:10096
    ds_read_b128 v[108:111], v11 offset:11744
    ds_read_b128 v[80:83], v11 offset:11760
    ds_read_b128 v[228:231], v12 offset:10080
    ds_read_b128 v[224:227], v12 offset:10096
    s_waitcnt vmcnt(13)
    v_mfma_f32_16x16x32_bf16 v[188:191], v[44:47], v[112:115], v[16:19]
    v_rcp_f32 v214, v214
    v_rcp_f32 v215, v215
    v_mul_f32 v176, v176, v214
    v_mfma_f32_16x16x32_bf16 v[44:47], v[52:55], v[112:115], 0
    v_mul_f32 v177, v177, v214
    v_mul_f32 v178, v178, v214
    buffer_load_dwordx4 v[52:55], v5, s[32:35], s64 offen offset:0 sc1
    v_mul_f32 v179, v179, v214
    v_mul_f32 v216, v216, v215
    v_cvt_pk_bf16_f32 v86, v176, v177
    s_waitcnt vmcnt(13)
    v_mfma_f32_16x16x32_bf16 v[112:115], v[76:79], v[32:35], 0
    v_mul_f32 v217, v217, v215
    v_cvt_pk_bf16_f32 v87, v178, v179
    buffer_load_dwordx4 v[76:79], v9, s[32:35], s65 offen offset:0 sc1
    v_mul_f32 v218, v218, v215
    v_mul_f32 v219, v219, v215
    v_mfma_f32_16x16x32_bf16 v[188:191], v[220:223], v[32:35], v[188:191]
    v_mul_f32 v212, v212, v214
    v_cvt_pk_bf16_f32 v176, v216, v217
    buffer_load_dwordx4 v[32:35], v9, s[32:35], s65 offen offset:1024 sc1
    buffer_load_dwordx4 v[220:223], v9, s[32:35], s65 offen offset:2048 sc1
    v_mul_f32 v213, v213, v215
    v_cvt_pk_bf16_f32 v177, v218, v219
    v_cvt_pk_bf16_f32 v178, v212, v213
    v_mfma_f32_16x16x32_bf16 v[152:155], v[116:119], v[240:243], v[152:155]
    buffer_load_dwordx4 v[216:219], v9, s[32:35], s65 offen offset:3072 sc1
    s_waitcnt lgkmcnt(5)
    v_cvt_pk_bf16_f32 v72, v72, v73
    buffer_load_dwordx4 v[212:215], v5, s[32:35], s65 offen offset:0 sc1
    v_cvt_pk_bf16_f32 v73, v74, v75
    s_waitcnt lgkmcnt(4)
    v_cvt_pk_bf16_f32 v74, v104, v105
    v_cvt_pk_bf16_f32 v75, v106, v107
    s_waitcnt lgkmcnt(3)
    v_cvt_pk_bf16_f32 v108, v108, v109
    v_mfma_f32_16x16x32_bf16 v[48:51], v[120:123], v[240:243], v[48:51]
    v_cvt_pk_bf16_f32 v109, v110, v111
    s_waitcnt lgkmcnt(2)
    v_cvt_pk_bf16_f32 v110, v80, v81
    v_cvt_pk_bf16_f32 v111, v82, v83
    s_waitcnt lgkmcnt(1)
    v_cvt_pk_bf16_f32 v228, v228, v229
    v_cvt_pk_bf16_f32 v229, v230, v231
    v_mfma_f32_16x16x32_bf16 v[136:139], v[124:127], v[240:243], v[136:139]
    s_waitcnt lgkmcnt(0)
    v_cvt_pk_bf16_f32 v230, v224, v225
    v_cvt_pk_bf16_f32 v231, v226, v227
    v_cndmask_b32 v74, 0, v74, s[44:45]
    v_cndmask_b32 v75, 0, v75, s[44:45]
    v_mfma_f32_16x16x32_bf16 v[144:147], v[128:131], v[240:243], v[144:147]
    v_cndmask_b32 v108, 0, v108, s[46:47]
    v_cndmask_b32 v109, 0, v109, s[46:47]
    v_cndmask_b32 v224, 0, v228, s[52:53]
    v_cndmask_b32 v225, 0, v229, s[52:53]
    v_cndmask_b32 v226, 0, v230, s[54:55]
    v_mfma_f32_16x16x32_bf16 v[236:239], v[132:135], v[240:243], v[236:239]
    v_cndmask_b32 v227, 0, v231, s[54:55]
    v_cndmask_b32 v228, 0, v228, s[48:49]
    v_cndmask_b32 v229, 0, v229, s[48:49]
    v_cndmask_b32 v230, 0, v230, s[50:51]
    v_cndmask_b32 v231, 0, v231, s[50:51]
    s_waitcnt vmcnt(17)
    s_nop 0
    v_mfma_f32_16x16x32_bf16 v[104:107], v[228:231], v[164:167], v[16:19]
    v_rcp_f32 v190, v190
    v_mfma_f32_16x16x32_bf16 v[80:83], v[72:75], v[164:167], 0
    v_rcp_f32 v191, v191
    s_waitcnt vmcnt(16)
    v_mfma_f32_16x16x32_bf16 v[240:243], v[108:111], v[36:39], 0
    v_mul_f32 v44, v44, v190
    v_mul_f32 v45, v45, v190
    v_mfma_f32_16x16x32_bf16 v[104:107], v[224:227], v[36:39], v[104:107]
    v_mul_f32 v46, v46, v190
    v_mul_f32 v47, v47, v190
    v_mfma_f32_16x16x32_bf16 v[232:235], v[116:119], v[84:87], v[232:235]
    v_mul_f32 v112, v112, v191
    v_cvt_pk_bf16_f32 v162, v44, v45
    v_mul_f32 v113, v113, v191
    v_mfma_f32_16x16x32_bf16 v[168:171], v[120:123], v[84:87], v[168:171]
    v_cvt_pk_bf16_f32 v163, v46, v47
    v_mul_f32 v114, v114, v191
    v_mfma_f32_16x16x32_bf16 v[252:255], v[124:127], v[84:87], v[252:255]
    v_mul_f32 v115, v115, v191
    v_mul_f32 v188, v188, v190
    v_mfma_f32_16x16x32_bf16 v[56:59], v[128:131], v[84:87], v[56:59]
    v_cvt_pk_bf16_f32 v164, v112, v113
    v_mul_f32 v189, v189, v191
    v_mfma_f32_16x16x32_bf16 v[60:63], v[132:135], v[84:87], v[60:63]
    v_cvt_pk_bf16_f32 v165, v114, v115
    v_cvt_pk_bf16_f32 v166, v188, v189
    s_waitcnt vmcnt(15)
    v_mfma_f32_16x16x32_bf16 v[36:39], v[228:231], v[40:43], v[16:19]
    v_rcp_f32 v106, v106
    v_mfma_f32_16x16x32_bf16 v[44:47], v[72:75], v[40:43], 0
    v_rcp_f32 v107, v107
    s_waitcnt vmcnt(14)
    v_mfma_f32_16x16x32_bf16 v[84:87], v[108:111], v[196:199], 0
    v_mul_f32 v80, v80, v106
    v_mul_f32 v81, v81, v106
    v_mfma_f32_16x16x32_bf16 v[36:39], v[224:227], v[196:199], v[36:39]
    v_mul_f32 v82, v82, v106
    v_mul_f32 v83, v83, v106
    v_mfma_f32_16x16x32_bf16 v[64:67], v[116:119], v[160:163], v[64:67]
    v_mul_f32 v240, v240, v107
    v_cvt_pk_bf16_f32 v211, v80, v81
    v_mul_f32 v241, v241, v107
    v_mfma_f32_16x16x32_bf16 v[68:71], v[120:123], v[160:163], v[68:71]
    v_cvt_pk_bf16_f32 v112, v82, v83
    v_mul_f32 v242, v242, v107
    v_mfma_f32_16x16x32_bf16 v[180:183], v[124:127], v[160:163], v[180:183]
    v_mul_f32 v243, v243, v107
    v_mul_f32 v104, v104, v106
    v_mfma_f32_16x16x32_bf16 v[184:187], v[128:131], v[160:163], v[184:187]
    v_cvt_pk_bf16_f32 v113, v240, v241
    v_mul_f32 v105, v105, v107
    v_mfma_f32_16x16x32_bf16 v[156:159], v[132:135], v[160:163], v[156:159]
    v_cvt_pk_bf16_f32 v114, v242, v243
    v_cvt_pk_bf16_f32 v115, v104, v105
    s_waitcnt vmcnt(13)
    v_mfma_f32_16x16x32_bf16 v[188:191], v[228:231], v[192:195], v[16:19]
    v_rcp_f32 v38, v38
    v_mfma_f32_16x16x32_bf16 v[40:43], v[72:75], v[192:195], 0
    s_waitcnt vmcnt(12)
    v_mfma_f32_16x16x32_bf16 v[196:199], v[108:111], v[88:91], 0
    v_rcp_f32 v39, v39
    v_mfma_f32_16x16x32_bf16 v[188:191], v[224:227], v[88:91], v[188:191]
    v_mul_f32 v44, v44, v38
    s_waitcnt vmcnt(9)
    v_mfma_f32_16x16x32_bf16 v[244:247], v[100:103], v[208:211], v[244:247]
    v_mul_f32 v45, v45, v38
    v_mul_f32 v46, v46, v38
    s_waitcnt vmcnt(8)
    v_mfma_f32_16x16x32_bf16 v[248:251], v[200:203], v[208:211], v[248:251]
    v_mul_f32 v47, v47, v38
    s_waitcnt vmcnt(7)
    v_mfma_f32_16x16x32_bf16 v[140:143], v[204:207], v[208:211], v[140:143]
    v_mul_f32 v84, v84, v39
    v_cvt_pk_bf16_f32 v27, v44, v45
    s_waitcnt vmcnt(6)
    v_mfma_f32_16x16x32_bf16 v[148:151], v[172:175], v[208:211], v[148:151]
    v_mul_f32 v85, v85, v39
    s_waitcnt vmcnt(5)
    v_mfma_f32_16x16x32_bf16 v[28:31], v[52:55], v[208:211], v[28:31]
    v_cvt_pk_bf16_f32 v116, v46, v47
    s_waitcnt vmcnt(4)
    v_mfma_f32_16x16x32_bf16 v[244:247], v[76:79], v[112:115], v[244:247]
    v_mul_f32 v86, v86, v39
    v_mul_f32 v87, v87, v39
    s_waitcnt vmcnt(3)
    v_mfma_f32_16x16x32_bf16 v[248:251], v[32:35], v[112:115], v[248:251]
    v_mul_f32 v36, v36, v38
    s_waitcnt vmcnt(2)
    v_mfma_f32_16x16x32_bf16 v[140:143], v[220:223], v[112:115], v[140:143]
    v_cvt_pk_bf16_f32 v117, v84, v85
    s_waitcnt vmcnt(1)
    v_mfma_f32_16x16x32_bf16 v[148:151], v[216:219], v[112:115], v[148:151]
    v_mul_f32 v37, v37, v39
    v_cvt_pk_bf16_f32 v118, v86, v87
    s_waitcnt vmcnt(0)
    v_mfma_f32_16x16x32_bf16 v[28:31], v[212:215], v[112:115], v[28:31]
    v_cvt_pk_bf16_f32 v119, v36, v37
    v_mfma_f32_16x16x32_bf16 v[120:123], v[228:231], v[92:95], v[16:19]
    v_rcp_f32 v190, v190
    v_mfma_f32_16x16x32_bf16 v[80:83], v[72:75], v[92:95], 0
    v_rcp_f32 v191, v191
    v_mfma_f32_16x16x32_bf16 v[124:127], v[108:111], v[96:99], 0
    v_mul_f32 v40, v40, v190
    v_mfma_f32_16x16x32_bf16 v[120:123], v[224:227], v[96:99], v[120:123]
    ds_write_b128 v4, v[244:247] offset:0
    v_mul_f32 v41, v41, v190
    v_mfma_f32_16x16x32_bf16 v[152:155], v[100:103], v[24:27], v[152:155]
    v_mul_f32 v42, v42, v190
    v_mfma_f32_16x16x32_bf16 v[48:51], v[200:203], v[24:27], v[48:51]
    v_mul_f32 v43, v43, v190
    ds_write_b128 v4, v[248:251] offset:1024
    v_mfma_f32_16x16x32_bf16 v[136:139], v[204:207], v[24:27], v[136:139]
    v_mul_f32 v196, v196, v191
    v_cvt_pk_bf16_f32 v179, v40, v41
    v_mfma_f32_16x16x32_bf16 v[144:147], v[172:175], v[24:27], v[144:147]
    v_mul_f32 v197, v197, v191
    s_mov_b32 s28, s18
    s_and_b32 s29, s19, 0xffff
    s_mov_b32 s30, 2621440
    s_mov_b32 s31, 0x20000
    v_and_b32 v10, 15, v1
    v_lshrrev_b32 v11, 4, v1
    s_lshr_b32 s40, s36, 1
    s_lshl_b32 s40, s40, 4
    s_lshl_b32 s41, s13, 6
    s_add_u32 s40, s40, s41
    v_add_u32 v10, s40, v10
    v_mul_u32_u24 v6, 1280, v10
    v_lshl_add_u32 v6, v11, 3, v6
    s_mul_i32 s41, s14, 160
    s_mul_i32 s40, s39, 96
    s_add_u32 s41, s41, s40
    v_add_u32 v6, s41, v6
    buffer_load_dwordx2 v[16:17], v6, s[24:27], 0 offen offset:0
    buffer_load_dwordx2 v[18:19], v6, s[24:27], 0 offen offset:32
    buffer_load_dwordx2 v[20:21], v6, s[24:27], 0 offen offset:64
    ds_write_b128 v4, v[140:143] offset:2048
    v_mfma_f32_16x16x32_bf16 v[236:239], v[52:55], v[24:27], v[236:239]
    v_cvt_pk_bf16_f32 v128, v42, v43
    v_mfma_f32_16x16x32_bf16 v[152:155], v[76:79], v[116:119], v[152:155]
    v_mul_f32 v198, v198, v191
    v_mul_f32 v199, v199, v191
    v_mfma_f32_16x16x32_bf16 v[48:51], v[32:35], v[116:119], v[48:51]
    ds_write_b128 v4, v[148:151] offset:3072
    v_mul_f32 v188, v188, v190
    v_mfma_f32_16x16x32_bf16 v[136:139], v[220:223], v[116:119], v[136:139]
    v_cvt_pk_bf16_f32 v129, v196, v197
    v_mfma_f32_16x16x32_bf16 v[144:147], v[216:219], v[116:119], v[144:147]
    v_mul_f32 v189, v189, v191
    ds_write_b128 v4, v[28:31] offset:4096
    v_mfma_f32_16x16x32_bf16 v[236:239], v[212:215], v[116:119], v[236:239]
    v_cvt_pk_bf16_f32 v130, v198, v199
    v_cvt_pk_bf16_f32 v131, v188, v189
    v_mfma_f32_16x16x32_bf16 v[232:235], v[100:103], v[176:179], v[232:235]
    v_rcp_f32 v122, v122
    v_mfma_f32_16x16x32_bf16 v[168:171], v[200:203], v[176:179], v[168:171]
    v_rcp_f32 v123, v123
    v_mfma_f32_16x16x32_bf16 v[252:255], v[204:207], v[176:179], v[252:255]
    v_mul_f32 v80, v80, v122
    ds_write_b128 v4, v[152:155] offset:5120
    v_mul_f32 v81, v81, v122
    v_mfma_f32_16x16x32_bf16 v[56:59], v[172:175], v[176:179], v[56:59]
    v_mul_f32 v82, v82, v122
    v_mul_f32 v83, v83, v122
    v_mfma_f32_16x16x32_bf16 v[60:63], v[52:55], v[176:179], v[60:63]
    ds_write_b128 v4, v[48:51] offset:6144
    v_mul_f32 v124, v124, v123
    v_cvt_pk_bf16_f32 v167, v80, v81
    v_mfma_f32_16x16x32_bf16 v[232:235], v[76:79], v[128:131], v[232:235]
    v_mul_f32 v125, v125, v123
    ds_write_b128 v4, v[136:139] offset:7168
    v_mfma_f32_16x16x32_bf16 v[168:171], v[32:35], v[128:131], v[168:171]
    v_cvt_pk_bf16_f32 v132, v82, v83
    v_mul_f32 v126, v126, v123
    v_mul_f32 v127, v127, v123
    v_mfma_f32_16x16x32_bf16 v[252:255], v[220:223], v[128:131], v[252:255]
    ds_write_b128 v4, v[144:147] offset:8192
    v_mul_f32 v120, v120, v122
    v_mfma_f32_16x16x32_bf16 v[56:59], v[216:219], v[128:131], v[56:59]
    v_cvt_pk_bf16_f32 v133, v124, v125
    v_mul_f32 v121, v121, v123
    ds_write_b128 v4, v[236:239] offset:9216
    v_mfma_f32_16x16x32_bf16 v[60:63], v[212:215], v[128:131], v[60:63]
    v_cvt_pk_bf16_f32 v134, v126, v127
    v_cvt_pk_bf16_f32 v135, v120, v121
    v_mfma_f32_16x16x32_bf16 v[64:67], v[100:103], v[164:167], v[64:67]
    ds_write_b128 v4, v[232:235] offset:10240
    v_mfma_f32_16x16x32_bf16 v[68:71], v[200:203], v[164:167], v[68:71]
    v_mfma_f32_16x16x32_bf16 v[180:183], v[204:207], v[164:167], v[180:183]
    ds_write_b128 v4, v[168:171] offset:11264
    v_mfma_f32_16x16x32_bf16 v[184:187], v[172:175], v[164:167], v[184:187]
    v_mfma_f32_16x16x32_bf16 v[156:159], v[52:55], v[164:167], v[156:159]
    ds_write_b128 v4, v[252:255] offset:12288
    v_mfma_f32_16x16x32_bf16 v[64:67], v[76:79], v[132:135], v[64:67]
    v_mfma_f32_16x16x32_bf16 v[68:71], v[32:35], v[132:135], v[68:71]
    ds_write_b128 v4, v[56:59] offset:13312
    v_mfma_f32_16x16x32_bf16 v[180:183], v[220:223], v[132:135], v[180:183]
    v_mfma_f32_16x16x32_bf16 v[184:187], v[216:219], v[132:135], v[184:187]
    ds_write_b128 v4, v[60:63] offset:14336
    v_mfma_f32_16x16x32_bf16 v[156:159], v[212:215], v[132:135], v[156:159]
    v_add_u32 v4, s38, v9
    s_lshr_b32 s40, s36, 1
    s_mul_i32 s40, s40, 5120
    s_mul_i32 s41, s39, 3072
    s_add_u32 s40, s40, s41
    v_add_u32 v14, s40, v9
    v_add_u32 v10, s16, v14
    v_add_u32 v11, s17, v14
    v_add_u32 v12, s7, v14
    v_add_u32 v13, 122880, v14
    s_mov_b32 s44, 3216550459
    s_mov_b32 s45, 3216550459
    s_mov_b32 s46, 1.0
    s_mov_b32 s47, 1.0
    s_mov_b32 s64, 0xffff0000
    ds_write_b128 v4, v[64:67] offset:15360
    ds_write_b128 v4, v[68:71] offset:16384
    ds_write_b128 v4, v[180:183] offset:17408
    ds_write_b128 v4, v[184:187] offset:18432
    s_cmp_lg_u32 s36, 7
    s_cbranch_scc1 k1_kernel_akx
    s_mov_b32 s41, 65536
k1_kernel_ak:
    ds_read_b32 v15, v7 offset:8
    s_waitcnt lgkmcnt(0)
    v_readfirstlane_b32 s40, v15
    s_nop 0
    s_cmp_ge_u32 s40, 7
    s_cbranch_scc1 k1_kernel_akx
    s_sleep 1
    s_sub_u32 s41, s41, 1
    s_cbranch_scc0 k1_kernel_ak
k1_kernel_akx:
    ds_write_b128 v4, v[156:159] offset:19456
    s_branch k1_kernel_red
k1_kernel_y:
    s_mov_b32 s36, s44
    v_mbcnt_lo_u32_b32 v1, -1, 0
    v_mbcnt_hi_u32_b32 v1, -1, v1
    v_lshlrev_b32 v9, 4, v1
    v_add_u32 v5, 4096, v9
    s_mov_b32 s48, s37
    s_add_u32 s40, s10, s36
    s_sub_u32 s41, s40, 54
    s_cselect_b32 s40, s40, s41
    s_mul_i32 s45, s40, 5120
    s_add_u32 s45, s45, s9
    s_lshl_b32 s44, s40, 11
    s_add_u32 s44, s44, s8
    s_add_u32 s47, s9, 276480
    s_add_u32 s46, s8, 110592
    buffer_load_dwordx4 v[24:27], v9, s[32:35], s45 offen offset:0 sc1
    buffer_load_dwordx4 v[28:31], v9, s[32:35], s45 offen offset:1024 sc1
    buffer_load_dwordx4 v[32:35], v9, s[32:35], s45 offen offset:2048 sc1
    buffer_load_dwordx4 v[36:39], v9, s[32:35], s45 offen offset:3072 sc1
    buffer_load_dwordx4 v[56:59], v5, s[32:35], s45 offen offset:0 sc1
    s_add_u32 s45, s45, 20480
    s_sub_u32 s40, s45, 276480
    s_cmp_ge_u32 s45, s47
    s_cselect_b32 s45, s40, s45
    buffer_load_dwordx4 v[60:63], v9, s[32:35], s45 offen offset:0 sc1
    buffer_load_dwordx4 v[64:67], v9, s[32:35], s45 offen offset:1024 sc1
    buffer_load_dwordx4 v[68:71], v9, s[32:35], s45 offen offset:2048 sc1
    buffer_load_dwordx4 v[72:75], v9, s[32:35], s45 offen offset:3072 sc1
    buffer_load_dwordx4 v[92:95], v5, s[32:35], s45 offen offset:0 sc1
    v_mov_b32 v7, 162816
    v_and_b32 v10, 15, v1
    v_lshrrev_b32 v11, 4, v1
    v_lshlrev_b32 v2, 4, v10
    v_lshl_add_u32 v2, v11, 9, v2
    v_add_u32 v3, 151552, v2
    s_and_b32 s37, s36, 1
    s_lshr_b32 s39, s36, 2
    s_xor_b32 s39, s39, s37
    s_mul_i32 s38, s37, 20480
    s_bitcmp1_b32 s36, 1
    s_cselect_b32 s40, s17, s16
    s_add_u32 s38, s38, s40
    v_add_u32 v4, s38, v9
    s_mov_b32 s28, s18
    s_and_b32 s29, s19, 0xffff
    s_mov_b32 s30, 2621440
    s_mov_b32 s31, 0x20000
    v_and_b32 v10, 15, v1
    v_lshrrev_b32 v11, 4, v1
    s_lshr_b32 s40, s36, 1
    s_lshl_b32 s40, s40, 4
    s_lshl_b32 s41, s13, 6
    s_add_u32 s40, s40, s41
    v_add_u32 v10, s40, v10
    v_mul_u32_u24 v6, 1280, v10
    v_lshl_add_u32 v6, v11, 3, v6
    s_mul_i32 s41, s14, 160
    s_mul_i32 s40, s39, 96
    s_add_u32 s41, s41, s40
    v_add_u32 v6, s41, v6
    s_waitcnt vmcnt(10)
    v_mov_b32 v10, 1
    s_mov_b64 exec, 1
    ds_add_rtn_u32 v11, v7, v10 offset:4
    s_waitcnt lgkmcnt(0)
    v_readfirstlane_b32 s40, v11
    s_nop 0
    s_and_b32 s40, s40, 0xff
    s_cmp_lg_u32 s40, 3
    s_cbranch_scc1 k1_kernel_nf
    buffer_store_dword v10, off, s[32:35], s15 offset:4 sc1
k1_kernel_nf:
    s_mov_b64 exec, -1
    s_add_u32 s45, s45, 20480
    s_sub_u32 s40, s45, 276480
    s_cmp_ge_u32 s45, s47
    s_cselect_b32 s45, s40, s45
    buffer_load_dwordx4 v[96:99], v9, s[32:35], s45 offen offset:0 sc1
    buffer_load_dwordx4 v[100:103], v9, s[32:35], s45 offen offset:1024 sc1
    buffer_load_dwordx4 v[104:107], v9, s[32:35], s45 offen offset:2048 sc1
    buffer_load_dwordx4 v[108:111], v9, s[32:35], s45 offen offset:3072 sc1
    buffer_load_dwordx4 v[128:131], v5, s[32:35], s45 offen offset:0 sc1
    s_mov_b32 s41, 65536
k1_kernel_yA:
    ds_read_b32 v10, v7 offset:0
    s_waitcnt lgkmcnt(0)
    v_readfirstlane_b32 s40, v10
    s_nop 0
    s_cmp_ge_u32 s40, 1
    s_cbranch_scc1 k1_kernel_yAx
    s_sleep 1
    s_sub_u32 s41, s41, 1
    s_cbranch_scc0 k1_kernel_yA
k1_kernel_yAx:
    buffer_load_dwordx4 v[40:43], v2, s[32:35], s44 offen offset:0 sc1
    buffer_load_dwordx4 v[44:47], v2, s[32:35], s44 offen offset:256 sc1
    buffer_load_dwordx4 v[48:51], v3, s[32:35], s44 offen offset:0 sc1
    buffer_load_dwordx4 v[52:55], v3, s[32:35], s44 offen offset:256 sc1
    s_add_u32 s44, s44, 8192
    s_sub_u32 s40, s44, 110592
    s_cmp_ge_u32 s44, s46
    s_cselect_b32 s44, s40, s44
    buffer_load_dwordx4 v[76:79], v2, s[32:35], s44 offen offset:0 sc1
    buffer_load_dwordx4 v[80:83], v2, s[32:35], s44 offen offset:256 sc1
    buffer_load_dwordx4 v[84:87], v3, s[32:35], s44 offen offset:0 sc1
    buffer_load_dwordx4 v[88:91], v3, s[32:35], s44 offen offset:256 sc1
    s_add_u32 s44, s44, 8192
    s_sub_u32 s40, s44, 110592
    s_cmp_ge_u32 s44, s46
    s_cselect_b32 s44, s40, s44
    buffer_load_dwordx4 v[112:115], v2, s[32:35], s44 offen offset:0 sc1
    buffer_load_dwordx4 v[116:119], v2, s[32:35], s44 offen offset:256 sc1
    buffer_load_dwordx4 v[120:123], v3, s[32:35], s44 offen offset:0 sc1
    buffer_load_dwordx4 v[124:127], v3, s[32:35], s44 offen offset:256 sc1
    s_add_u32 s45, s45, 20480
    s_sub_u32 s40, s45, 276480
    s_cmp_ge_u32 s45, s47
    s_cselect_b32 s45, s40, s45
    buffer_load_dwordx4 v[132:135], v9, s[32:35], s45 offen offset:0 sc1
    buffer_load_dwordx4 v[136:139], v9, s[32:35], s45 offen offset:1024 sc1
    buffer_load_dwordx4 v[140:143], v9, s[32:35], s45 offen offset:2048 sc1
    buffer_load_dwordx4 v[144:147], v9, s[32:35], s45 offen offset:3072 sc1
    s_waitcnt vmcnt(15)
    v_mfma_f32_16x16x32_bf16 v[148:151], v[24:27], v[40:43], 0
    s_waitcnt vmcnt(14)
    v_mfma_f32_16x16x32_bf16 v[152:155], v[24:27], v[44:47], 0
    s_waitcnt vmcnt(13)
    v_mfma_f32_16x16x32_bf16 v[156:159], v[24:27], v[48:51], 0
    s_waitcnt vmcnt(12)
    v_mfma_f32_16x16x32_bf16 v[160:163], v[24:27], v[52:55], 0
    v_mfma_f32_16x16x32_bf16 v[164:167], v[28:31], v[40:43], 0
    v_mfma_f32_16x16x32_bf16 v[168:171], v[28:31], v[44:47], 0
    v_mfma_f32_16x16x32_bf16 v[172:175], v[28:31], v[48:51], 0
    v_mfma_f32_16x16x32_bf16 v[176:179], v[28:31], v[52:55], 0
    v_mfma_f32_16x16x32_bf16 v[180:183], v[32:35], v[40:43], 0
    v_mfma_f32_16x16x32_bf16 v[184:187], v[32:35], v[44:47], 0
    v_mfma_f32_16x16x32_bf16 v[188:191], v[32:35], v[48:51], 0
    v_mfma_f32_16x16x32_bf16 v[192:195], v[32:35], v[52:55], 0
    v_mfma_f32_16x16x32_bf16 v[196:199], v[36:39], v[40:43], 0
    v_mfma_f32_16x16x32_bf16 v[200:203], v[36:39], v[44:47], 0
    v_mfma_f32_16x16x32_bf16 v[204:207], v[36:39], v[48:51], 0
    v_mfma_f32_16x16x32_bf16 v[208:211], v[36:39], v[52:55], 0
    v_mfma_f32_16x16x32_bf16 v[212:215], v[56:59], v[40:43], 0
    v_mfma_f32_16x16x32_bf16 v[216:219], v[56:59], v[44:47], 0
    v_mfma_f32_16x16x32_bf16 v[220:223], v[56:59], v[48:51], 0
    v_mfma_f32_16x16x32_bf16 v[224:227], v[56:59], v[52:55], 0
    buffer_load_dwordx4 v[228:231], v5, s[32:35], s45 offen offset:0 sc1
    s_waitcnt vmcnt(12)
    v_mfma_f32_16x16x32_bf16 v[148:151], v[60:63], v[76:79], v[148:151]
    s_add_u32 s44, s44, 8192
    s_sub_u32 s40, s44, 110592
    s_cmp_ge_u32 s44, s46
    s_cselect_b32 s44, s40, s44
    buffer_load_dwordx4 v[232:235], v2, s[32:35], s44 offen offset:0 sc1
    s_waitcnt vmcnt(12)
    v_mfma_f32_16x16x32_bf16 v[152:155], v[60:63], v[80:83], v[152:155]
    buffer_load_dwordx4 v[236:239], v2, s[32:35], s44 offen offset:256 sc1
    buffer_load_dwordx4 v[240:243], v3, s[32:35], s44 offen offset:0 sc1
    s_waitcnt vmcnt(13)
    v_mfma_f32_16x16x32_bf16 v[156:159], v[60:63], v[84:87], v[156:159]
    s_waitcnt vmcnt(12)
    v_mfma_f32_16x16x32_bf16 v[160:163], v[60:63], v[88:91], v[160:163]
    v_mfma_f32_16x16x32_bf16 v[164:167], v[64:67], v[76:79], v[164:167]
    v_mfma_f32_16x16x32_bf16 v[168:171], v[64:67], v[80:83], v[168:171]
    buffer_load_dwordx4 v[244:247], v3, s[32:35], s44 offen offset:256 sc1
    v_mfma_f32_16x16x32_bf16 v[172:175], v[64:67], v[84:87], v[172:175]
    v_mfma_f32_16x16x32_bf16 v[176:179], v[64:67], v[88:91], v[176:179]
    v_mfma_f32_16x16x32_bf16 v[180:183], v[68:71], v[76:79], v[180:183]
    v_mfma_f32_16x16x32_bf16 v[184:187], v[68:71], v[80:83], v[184:187]
    s_add_u32 s45, s45, 20480
    s_sub_u32 s40, s45, 276480
    s_cmp_ge_u32 s45, s47
    s_cselect_b32 s45, s40, s45
    buffer_load_dwordx4 v[248:251], v9, s[32:35], s45 offen offset:0 sc1
    v_mfma_f32_16x16x32_bf16 v[188:191], v[68:71], v[84:87], v[188:191]
    v_mfma_f32_16x16x32_bf16 v[192:195], v[68:71], v[88:91], v[192:195]
    v_mfma_f32_16x16x32_bf16 v[196:199], v[72:75], v[76:79], v[196:199]
    v_mfma_f32_16x16x32_bf16 v[200:203], v[72:75], v[80:83], v[200:203]
    buffer_load_dwordx4 v[252:255], v9, s[32:35], s45 offen offset:1024 sc1
    v_mfma_f32_16x16x32_bf16 v[204:207], v[72:75], v[84:87], v[204:207]
    v_mfma_f32_16x16x32_bf16 v[208:211], v[72:75], v[88:91], v[208:211]
    v_mfma_f32_16x16x32_bf16 v[212:215], v[92:95], v[76:79], v[212:215]
    v_mfma_f32_16x16x32_bf16 v[216:219], v[92:95], v[80:83], v[216:219]
    buffer_load_dwordx4 v[24:27], v9, s[32:35], s45 offen offset:2048 sc1
    v_mfma_f32_16x16x32_bf16 v[220:223], v[92:95], v[84:87], v[220:223]
    buffer_load_dwordx4 v[28:31], v9, s[32:35], s45 offen offset:3072 sc1
    v_mfma_f32_16x16x32_bf16 v[224:227], v[92:95], v[88:91], v[224:227]
    buffer_load_dwordx4 v[32:35], v5, s[32:35], s45 offen offset:0 sc1
    s_waitcnt vmcnt(17)
    v_mfma_f32_16x16x32_bf16 v[148:151], v[96:99], v[112:115], v[148:151]
    s_add_u32 s44, s44, 8192
    s_sub_u32 s40, s44, 110592
    s_cmp_ge_u32 s44, s46
    s_cselect_b32 s44, s40, s44
    buffer_load_dwordx4 v[36:39], v2, s[32:35], s44 offen offset:0 sc1
    s_waitcnt vmcnt(17)
    v_mfma_f32_16x16x32_bf16 v[152:155], v[96:99], v[116:119], v[152:155]
    buffer_load_dwordx4 v[40:43], v2, s[32:35], s44 offen offset:256 sc1
    buffer_load_dwordx4 v[44:47], v3, s[32:35], s44 offen offset:0 sc1
    s_waitcnt vmcnt(18)
    v_mfma_f32_16x16x32_bf16 v[156:159], v[96:99], v[120:123], v[156:159]
    s_waitcnt vmcnt(17)
    v_mfma_f32_16x16x32_bf16 v[160:163], v[96:99], v[124:127], v[160:163]
    v_mfma_f32_16x16x32_bf16 v[164:167], v[100:103], v[112:115], v[164:167]
    v_mfma_f32_16x16x32_bf16 v[168:171], v[100:103], v[116:119], v[168:171]
    buffer_load_dwordx4 v[48:51], v3, s[32:35], s44 offen offset:256 sc1
    v_mfma_f32_16x16x32_bf16 v[172:175], v[100:103], v[120:123], v[172:175]
    v_mfma_f32_16x16x32_bf16 v[176:179], v[100:103], v[124:127], v[176:179]
    v_mfma_f32_16x16x32_bf16 v[180:183], v[104:107], v[112:115], v[180:183]
    v_mfma_f32_16x16x32_bf16 v[184:187], v[104:107], v[116:119], v[184:187]
    s_add_u32 s45, s45, 20480
    s_sub_u32 s40, s45, 276480
    s_cmp_ge_u32 s45, s47
    s_cselect_b32 s45, s40, s45
    buffer_load_dwordx4 v[52:55], v9, s[32:35], s45 offen offset:0 sc1
    v_mfma_f32_16x16x32_bf16 v[188:191], v[104:107], v[120:123], v[188:191]
    v_mfma_f32_16x16x32_bf16 v[192:195], v[104:107], v[124:127], v[192:195]
    v_mfma_f32_16x16x32_bf16 v[196:199], v[108:111], v[112:115], v[196:199]
    v_mfma_f32_16x16x32_bf16 v[200:203], v[108:111], v[116:119], v[200:203]
    buffer_load_dwordx4 v[56:59], v9, s[32:35], s45 offen offset:1024 sc1
    v_mfma_f32_16x16x32_bf16 v[204:207], v[108:111], v[120:123], v[204:207]
    v_mfma_f32_16x16x32_bf16 v[208:211], v[108:111], v[124:127], v[208:211]
    v_mfma_f32_16x16x32_bf16 v[212:215], v[128:131], v[112:115], v[212:215]
    v_mfma_f32_16x16x32_bf16 v[216:219], v[128:131], v[116:119], v[216:219]
    buffer_load_dwordx4 v[60:63], v9, s[32:35], s45 offen offset:2048 sc1
    v_mfma_f32_16x16x32_bf16 v[220:223], v[128:131], v[120:123], v[220:223]
    buffer_load_dwordx4 v[64:67], v9, s[32:35], s45 offen offset:3072 sc1
    v_mfma_f32_16x16x32_bf16 v[224:227], v[128:131], v[124:127], v[224:227]
    buffer_load_dwordx4 v[68:71], v5, s[32:35], s45 offen offset:0 sc1
    s_waitcnt vmcnt(17)
    v_mfma_f32_16x16x32_bf16 v[148:151], v[132:135], v[232:235], v[148:151]
    s_add_u32 s44, s44, 8192
    s_sub_u32 s40, s44, 110592
    s_cmp_ge_u32 s44, s46
    s_cselect_b32 s44, s40, s44
    buffer_load_dwordx4 v[72:75], v2, s[32:35], s44 offen offset:0 sc1
    s_waitcnt vmcnt(17)
    v_mfma_f32_16x16x32_bf16 v[152:155], v[132:135], v[236:239], v[152:155]
    buffer_load_dwordx4 v[76:79], v2, s[32:35], s44 offen offset:256 sc1
    buffer_load_dwordx4 v[80:83], v3, s[32:35], s44 offen offset:0 sc1
    s_waitcnt vmcnt(18)
    v_mfma_f32_16x16x32_bf16 v[156:159], v[132:135], v[240:243], v[156:159]
    s_waitcnt vmcnt(17)
    v_mfma_f32_16x16x32_bf16 v[160:163], v[132:135], v[244:247], v[160:163]
    v_mfma_f32_16x16x32_bf16 v[164:167], v[136:139], v[232:235], v[164:167]
    v_mfma_f32_16x16x32_bf16 v[168:171], v[136:139], v[236:239], v[168:171]
    buffer_load_dwordx4 v[84:87], v3, s[32:35], s44 offen offset:256 sc1
    v_mfma_f32_16x16x32_bf16 v[172:175], v[136:139], v[240:243], v[172:175]
    v_mfma_f32_16x16x32_bf16 v[176:179], v[136:139], v[244:247], v[176:179]
    v_mfma_f32_16x16x32_bf16 v[180:183], v[140:143], v[232:235], v[180:183]
    v_mfma_f32_16x16x32_bf16 v[184:187], v[140:143], v[236:239], v[184:187]
    s_add_u32 s45, s45, 20480
    s_sub_u32 s40, s45, 276480
    s_cmp_ge_u32 s45, s47
    s_cselect_b32 s45, s40, s45
    buffer_load_dwordx4 v[88:91], v9, s[32:35], s45 offen offset:0 sc1
    v_mfma_f32_16x16x32_bf16 v[188:191], v[140:143], v[240:243], v[188:191]
    v_mfma_f32_16x16x32_bf16 v[192:195], v[140:143], v[244:247], v[192:195]
    v_mfma_f32_16x16x32_bf16 v[196:199], v[144:147], v[232:235], v[196:199]
    v_mfma_f32_16x16x32_bf16 v[200:203], v[144:147], v[236:239], v[200:203]
    buffer_load_dwordx4 v[92:95], v9, s[32:35], s45 offen offset:1024 sc1
    v_mfma_f32_16x16x32_bf16 v[204:207], v[144:147], v[240:243], v[204:207]
    v_mfma_f32_16x16x32_bf16 v[208:211], v[144:147], v[244:247], v[208:211]
    v_mfma_f32_16x16x32_bf16 v[212:215], v[228:231], v[232:235], v[212:215]
    v_mfma_f32_16x16x32_bf16 v[216:219], v[228:231], v[236:239], v[216:219]
    buffer_load_dwordx4 v[96:99], v9, s[32:35], s45 offen offset:2048 sc1
    v_mfma_f32_16x16x32_bf16 v[220:223], v[228:231], v[240:243], v[220:223]
    buffer_load_dwordx4 v[100:103], v9, s[32:35], s45 offen offset:3072 sc1
    v_mfma_f32_16x16x32_bf16 v[224:227], v[228:231], v[244:247], v[224:227]
    buffer_load_dwordx4 v[104:107], v5, s[32:35], s45 offen offset:0 sc1
    s_waitcnt vmcnt(17)
    v_mfma_f32_16x16x32_bf16 v[148:151], v[248:251], v[36:39], v[148:151]
    s_add_u32 s44, s44, 8192
    s_sub_u32 s40, s44, 110592
    s_cmp_ge_u32 s44, s46
    s_cselect_b32 s44, s40, s44
    buffer_load_dwordx4 v[108:111], v2, s[32:35], s44 offen offset:0 sc1
    s_waitcnt vmcnt(17)
    v_mfma_f32_16x16x32_bf16 v[152:155], v[248:251], v[40:43], v[152:155]
    buffer_load_dwordx4 v[112:115], v2, s[32:35], s44 offen offset:256 sc1
    buffer_load_dwordx4 v[116:119], v3, s[32:35], s44 offen offset:0 sc1
    s_waitcnt vmcnt(18)
    v_mfma_f32_16x16x32_bf16 v[156:159], v[248:251], v[44:47], v[156:159]
    s_waitcnt vmcnt(17)
    v_mfma_f32_16x16x32_bf16 v[160:163], v[248:251], v[48:51], v[160:163]
    v_mfma_f32_16x16x32_bf16 v[164:167], v[252:255], v[36:39], v[164:167]
    v_mfma_f32_16x16x32_bf16 v[168:171], v[252:255], v[40:43], v[168:171]
    buffer_load_dwordx4 v[120:123], v3, s[32:35], s44 offen offset:256 sc1
    v_mfma_f32_16x16x32_bf16 v[172:175], v[252:255], v[44:47], v[172:175]
    v_mfma_f32_16x16x32_bf16 v[176:179], v[252:255], v[48:51], v[176:179]
    v_mfma_f32_16x16x32_bf16 v[180:183], v[24:27], v[36:39], v[180:183]
    v_mfma_f32_16x16x32_bf16 v[184:187], v[24:27], v[40:43], v[184:187]
    s_add_u32 s45, s45, 20480
    s_sub_u32 s40, s45, 276480
    s_cmp_ge_u32 s45, s47
    s_cselect_b32 s45, s40, s45
    buffer_load_dwordx4 v[124:127], v9, s[32:35], s45 offen offset:0 sc1
    v_mfma_f32_16x16x32_bf16 v[188:191], v[24:27], v[44:47], v[188:191]
    v_mfma_f32_16x16x32_bf16 v[192:195], v[24:27], v[48:51], v[192:195]
    v_mfma_f32_16x16x32_bf16 v[196:199], v[28:31], v[36:39], v[196:199]
    v_mfma_f32_16x16x32_bf16 v[200:203], v[28:31], v[40:43], v[200:203]
    buffer_load_dwordx4 v[128:131], v9, s[32:35], s45 offen offset:1024 sc1
    v_mfma_f32_16x16x32_bf16 v[204:207], v[28:31], v[44:47], v[204:207]
    v_mfma_f32_16x16x32_bf16 v[208:211], v[28:31], v[48:51], v[208:211]
    v_mfma_f32_16x16x32_bf16 v[212:215], v[32:35], v[36:39], v[212:215]
    v_mfma_f32_16x16x32_bf16 v[216:219], v[32:35], v[40:43], v[216:219]
    buffer_load_dwordx4 v[132:135], v9, s[32:35], s45 offen offset:2048 sc1
    v_mfma_f32_16x16x32_bf16 v[220:223], v[32:35], v[44:47], v[220:223]
    buffer_load_dwordx4 v[136:139], v9, s[32:35], s45 offen offset:3072 sc1
    v_mfma_f32_16x16x32_bf16 v[224:227], v[32:35], v[48:51], v[224:227]
    buffer_load_dwordx4 v[140:143], v5, s[32:35], s45 offen offset:0 sc1
    s_waitcnt vmcnt(17)
    v_mfma_f32_16x16x32_bf16 v[148:151], v[52:55], v[72:75], v[148:151]
    s_add_u32 s44, s44, 8192
    s_sub_u32 s40, s44, 110592
    s_cmp_ge_u32 s44, s46
    s_cselect_b32 s44, s40, s44
    buffer_load_dwordx4 v[144:147], v2, s[32:35], s44 offen offset:0 sc1
    s_waitcnt vmcnt(17)
    v_mfma_f32_16x16x32_bf16 v[152:155], v[52:55], v[76:79], v[152:155]
    buffer_load_dwordx4 v[232:235], v2, s[32:35], s44 offen offset:256 sc1
    buffer_load_dwordx4 v[236:239], v3, s[32:35], s44 offen offset:0 sc1
    s_waitcnt vmcnt(18)
    v_mfma_f32_16x16x32_bf16 v[156:159], v[52:55], v[80:83], v[156:159]
    s_waitcnt vmcnt(17)
    v_mfma_f32_16x16x32_bf16 v[160:163], v[52:55], v[84:87], v[160:163]
    v_mfma_f32_16x16x32_bf16 v[164:167], v[56:59], v[72:75], v[164:167]
    v_mfma_f32_16x16x32_bf16 v[168:171], v[56:59], v[76:79], v[168:171]
    buffer_load_dwordx4 v[240:243], v3, s[32:35], s44 offen offset:256 sc1
    v_mfma_f32_16x16x32_bf16 v[172:175], v[56:59], v[80:83], v[172:175]
    v_mfma_f32_16x16x32_bf16 v[176:179], v[56:59], v[84:87], v[176:179]
    v_mfma_f32_16x16x32_bf16 v[180:183], v[60:63], v[72:75], v[180:183]
    v_mfma_f32_16x16x32_bf16 v[184:187], v[60:63], v[76:79], v[184:187]
    s_add_u32 s45, s45, 20480
    s_sub_u32 s40, s45, 276480
    s_cmp_ge_u32 s45, s47
    s_cselect_b32 s45, s40, s45
    buffer_load_dwordx4 v[228:231], v9, s[32:35], s45 offen offset:0 sc1
    v_mfma_f32_16x16x32_bf16 v[188:191], v[60:63], v[80:83], v[188:191]
    v_mfma_f32_16x16x32_bf16 v[192:195], v[60:63], v[84:87], v[192:195]
    v_mfma_f32_16x16x32_bf16 v[196:199], v[64:67], v[72:75], v[196:199]
    v_mfma_f32_16x16x32_bf16 v[200:203], v[64:67], v[76:79], v[200:203]
    buffer_load_dwordx4 v[244:247], v9, s[32:35], s45 offen offset:1024 sc1
    v_mfma_f32_16x16x32_bf16 v[204:207], v[64:67], v[80:83], v[204:207]
    v_mfma_f32_16x16x32_bf16 v[208:211], v[64:67], v[84:87], v[208:211]
    v_mfma_f32_16x16x32_bf16 v[212:215], v[68:71], v[72:75], v[212:215]
    v_mfma_f32_16x16x32_bf16 v[216:219], v[68:71], v[76:79], v[216:219]
    buffer_load_dwordx4 v[248:251], v9, s[32:35], s45 offen offset:2048 sc1
    v_mfma_f32_16x16x32_bf16 v[220:223], v[68:71], v[80:83], v[220:223]
    buffer_load_dwordx4 v[252:255], v9, s[32:35], s45 offen offset:3072 sc1
    v_mfma_f32_16x16x32_bf16 v[224:227], v[68:71], v[84:87], v[224:227]
    buffer_load_dwordx4 v[24:27], v5, s[32:35], s45 offen offset:0 sc1
    s_waitcnt vmcnt(17)
    v_mfma_f32_16x16x32_bf16 v[148:151], v[88:91], v[108:111], v[148:151]
    s_add_u32 s45, s45, 20480
    s_sub_u32 s40, s45, 276480
    s_cmp_ge_u32 s45, s47
    s_cselect_b32 s45, s40, s45
    buffer_load_dwordx4 v[28:31], v9, s[32:35], s45 offen offset:0 sc1
    s_waitcnt vmcnt(17)
    v_mfma_f32_16x16x32_bf16 v[152:155], v[88:91], v[112:115], v[152:155]
    buffer_load_dwordx4 v[36:39], v9, s[32:35], s45 offen offset:1024 sc1
    buffer_load_dwordx4 v[40:43], v9, s[32:35], s45 offen offset:2048 sc1
    s_waitcnt vmcnt(18)
    v_mfma_f32_16x16x32_bf16 v[156:159], v[88:91], v[116:119], v[156:159]
    s_waitcnt vmcnt(17)
    v_mfma_f32_16x16x32_bf16 v[160:163], v[88:91], v[120:123], v[160:163]
    v_mfma_f32_16x16x32_bf16 v[164:167], v[92:95], v[108:111], v[164:167]
    v_mfma_f32_16x16x32_bf16 v[168:171], v[92:95], v[112:115], v[168:171]
    buffer_load_dwordx4 v[44:47], v9, s[32:35], s45 offen offset:3072 sc1
    v_mfma_f32_16x16x32_bf16 v[172:175], v[92:95], v[116:119], v[172:175]
    v_mfma_f32_16x16x32_bf16 v[176:179], v[92:95], v[120:123], v[176:179]
    v_mfma_f32_16x16x32_bf16 v[180:183], v[96:99], v[108:111], v[180:183]
    v_mfma_f32_16x16x32_bf16 v[184:187], v[96:99], v[112:115], v[184:187]
    buffer_load_dwordx4 v[32:35], v5, s[32:35], s45 offen offset:0 sc1
    v_mfma_f32_16x16x32_bf16 v[188:191], v[96:99], v[116:119], v[188:191]
    v_mfma_f32_16x16x32_bf16 v[192:195], v[96:99], v[120:123], v[192:195]
    v_mfma_f32_16x16x32_bf16 v[196:199], v[100:103], v[108:111], v[196:199]
    v_mfma_f32_16x16x32_bf16 v[200:203], v[100:103], v[112:115], v[200:203]
    s_mov_b32 s41, 65536
k1_kernel_yF:
    ds_read_b32 v10, v7 offset:0
    s_waitcnt lgkmcnt(0)
    v_readfirstlane_b32 s40, v10
    s_nop 0
    s_cmp_ge_u32 s40, 2
    s_cbranch_scc1 k1_kernel_yFx
    s_sleep 1
    s_sub_u32 s41, s41, 1
    s_cbranch_scc0 k1_kernel_yF
k1_kernel_yFx:
    v_mov_b32 v10, 1
    s_mov_b64 exec, 1
    ds_add_u32 v7, v10 offset:8
    s_mov_b64 exec, -1
    s_waitcnt lgkmcnt(0)
    s_add_u32 s44, s44, 8192
    s_sub_u32 s40, s44, 110592
    s_cmp_ge_u32 s44, s46
    s_cselect_b32 s44, s40, s44
    buffer_load_dwordx4 v[48:51], v2, s[32:35], s44 offen offset:0 sc1
    v_mfma_f32_16x16x32_bf16 v[204:207], v[100:103], v[116:119], v[204:207]
    v_mfma_f32_16x16x32_bf16 v[208:211], v[100:103], v[120:123], v[208:211]
    v_mfma_f32_16x16x32_bf16 v[212:215], v[104:107], v[108:111], v[212:215]
    v_mfma_f32_16x16x32_bf16 v[216:219], v[104:107], v[112:115], v[216:219]
    buffer_load_dwordx4 v[52:55], v2, s[32:35], s44 offen offset:256 sc1
    v_mfma_f32_16x16x32_bf16 v[220:223], v[104:107], v[116:119], v[220:223]
    buffer_load_dwordx4 v[56:59], v3, s[32:35], s44 offen offset:0 sc1
    v_mfma_f32_16x16x32_bf16 v[224:227], v[104:107], v[120:123], v[224:227]
    buffer_load_dwordx4 v[60:63], v3, s[32:35], s44 offen offset:256 sc1
    s_waitcnt vmcnt(17)
    v_mfma_f32_16x16x32_bf16 v[148:151], v[124:127], v[144:147], v[148:151]
    s_add_u32 s44, s44, 8192
    s_sub_u32 s40, s44, 110592
    s_cmp_ge_u32 s44, s46
    s_cselect_b32 s44, s40, s44
    buffer_load_dwordx4 v[64:67], v2, s[32:35], s44 offen offset:0 sc1
    s_waitcnt vmcnt(17)
    v_mfma_f32_16x16x32_bf16 v[152:155], v[124:127], v[232:235], v[152:155]
    buffer_load_dwordx4 v[72:75], v2, s[32:35], s44 offen offset:256 sc1
    buffer_load_dwordx4 v[76:79], v3, s[32:35], s44 offen offset:0 sc1
    s_waitcnt vmcnt(18)
    v_mfma_f32_16x16x32_bf16 v[156:159], v[124:127], v[236:239], v[156:159]
    s_waitcnt vmcnt(17)
    v_mfma_f32_16x16x32_bf16 v[160:163], v[124:127], v[240:243], v[160:163]
    v_mfma_f32_16x16x32_bf16 v[164:167], v[128:131], v[144:147], v[164:167]
    v_mfma_f32_16x16x32_bf16 v[168:171], v[128:131], v[232:235], v[168:171]
    buffer_load_dwordx4 v[80:83], v3, s[32:35], s44 offen offset:256 sc1
    v_mfma_f32_16x16x32_bf16 v[172:175], v[128:131], v[236:239], v[172:175]
    v_mfma_f32_16x16x32_bf16 v[176:179], v[128:131], v[240:243], v[176:179]
    v_mfma_f32_16x16x32_bf16 v[180:183], v[132:135], v[144:147], v[180:183]
    v_mfma_f32_16x16x32_bf16 v[184:187], v[132:135], v[232:235], v[184:187]
    s_add_u32 s44, s44, 8192
    s_sub_u32 s40, s44, 110592
    s_cmp_ge_u32 s44, s46
    s_cselect_b32 s44, s40, s44
    buffer_load_dwordx4 v[68:71], v2, s[32:35], s44 offen offset:0 sc1
    v_mfma_f32_16x16x32_bf16 v[188:191], v[132:135], v[236:239], v[188:191]
    v_mfma_f32_16x16x32_bf16 v[192:195], v[132:135], v[240:243], v[192:195]
    v_mfma_f32_16x16x32_bf16 v[196:199], v[136:139], v[144:147], v[196:199]
    v_mfma_f32_16x16x32_bf16 v[200:203], v[136:139], v[232:235], v[200:203]
    buffer_load_dwordx4 v[84:87], v2, s[32:35], s44 offen offset:256 sc1
    v_mfma_f32_16x16x32_bf16 v[204:207], v[136:139], v[236:239], v[204:207]
    v_mfma_f32_16x16x32_bf16 v[208:211], v[136:139], v[240:243], v[208:211]
    v_mfma_f32_16x16x32_bf16 v[212:215], v[140:143], v[144:147], v[212:215]
    v_mfma_f32_16x16x32_bf16 v[216:219], v[140:143], v[232:235], v[216:219]
    buffer_load_dwordx4 v[88:91], v3, s[32:35], s44 offen offset:0 sc1
    v_mfma_f32_16x16x32_bf16 v[220:223], v[140:143], v[236:239], v[220:223]
    buffer_load_dwordx4 v[92:95], v3, s[32:35], s44 offen offset:256 sc1
    v_mfma_f32_16x16x32_bf16 v[224:227], v[140:143], v[240:243], v[224:227]
    s_add_u32 s44, s44, 8192
    s_sub_u32 s40, s44, 110592
    s_cmp_ge_u32 s44, s46
    s_cselect_b32 s44, s40, s44
    buffer_load_dwordx4 v[96:99], v2, s[32:35], s44 offen offset:0 sc1
    s_waitcnt vmcnt(12)
    v_mfma_f32_16x16x32_bf16 v[148:151], v[228:231], v[48:51], v[148:151]
    buffer_load_dwordx4 v[100:103], v2, s[32:35], s44 offen offset:256 sc1
    s_waitcnt vmcnt(12)
    v_mfma_f32_16x16x32_bf16 v[152:155], v[228:231], v[52:55], v[152:155]
    buffer_load_dwordx4 v[108:111], v3, s[32:35], s44 offen offset:0 sc1
    buffer_load_dwordx4 v[112:115], v3, s[32:35], s44 offen offset:256 sc1
    s_waitcnt vmcnt(13)
    v_mfma_f32_16x16x32_bf16 v[156:159], v[228:231], v[56:59], v[156:159]
    s_waitcnt vmcnt(12)
    v_mfma_f32_16x16x32_bf16 v[160:163], v[228:231], v[60:63], v[160:163]
    v_mfma_f32_16x16x32_bf16 v[164:167], v[244:247], v[48:51], v[164:167]
    v_mfma_f32_16x16x32_bf16 v[168:171], v[244:247], v[52:55], v[168:171]
    s_add_u32 s44, s44, 8192
    s_sub_u32 s40, s44, 110592
    s_cmp_ge_u32 s44, s46
    s_cselect_b32 s44, s40, s44
    buffer_load_dwordx4 v[116:119], v2, s[32:35], s44 offen offset:0 sc1
    v_mfma_f32_16x16x32_bf16 v[172:175], v[244:247], v[56:59], v[172:175]
    v_mfma_f32_16x16x32_bf16 v[176:179], v[244:247], v[60:63], v[176:179]
    v_mfma_f32_16x16x32_bf16 v[180:183], v[248:251], v[48:51], v[180:183]
    v_mfma_f32_16x16x32_bf16 v[184:187], v[248:251], v[52:55], v[184:187]
    buffer_load_dwordx4 v[104:107], v2, s[32:35], s44 offen offset:256 sc1
    v_mfma_f32_16x16x32_bf16 v[188:191], v[248:251], v[56:59], v[188:191]
    v_mfma_f32_16x16x32_bf16 v[192:195], v[248:251], v[60:63], v[192:195]
    v_mfma_f32_16x16x32_bf16 v[196:199], v[252:255], v[48:51], v[196:199]
    v_mfma_f32_16x16x32_bf16 v[200:203], v[252:255], v[52:55], v[200:203]
    buffer_load_dwordx4 v[120:123], v3, s[32:35], s44 offen offset:0 sc1
    v_mfma_f32_16x16x32_bf16 v[204:207], v[252:255], v[56:59], v[204:207]
    v_mfma_f32_16x16x32_bf16 v[208:211], v[252:255], v[60:63], v[208:211]
    v_mfma_f32_16x16x32_bf16 v[212:215], v[24:27], v[48:51], v[212:215]
    v_mfma_f32_16x16x32_bf16 v[216:219], v[24:27], v[52:55], v[216:219]
    buffer_load_dwordx4 v[124:127], v3, s[32:35], s44 offen offset:256 sc1
    v_mfma_f32_16x16x32_bf16 v[220:223], v[24:27], v[56:59], v[220:223]
    s_add_u32 s44, s44, 8192
    s_sub_u32 s40, s44, 110592
    s_cmp_ge_u32 s44, s46
    s_cselect_b32 s44, s40, s44
    s_cmp_ge_u32 s36, 2
    s_cselect_b32 s44, 1073741824, s44
    buffer_load_dwordx4 v[128:131], v2, s[32:35], s44 offen offset:0 sc1
    v_mfma_f32_16x16x32_bf16 v[224:227], v[24:27], v[60:63], v[224:227]
    buffer_load_dwordx4 v[132:135], v2, s[32:35], s44 offen offset:256 sc1
    s_waitcnt vmcnt(17)
    v_mfma_f32_16x16x32_bf16 v[148:151], v[28:31], v[64:67], v[148:151]
    buffer_load_dwordx4 v[136:139], v3, s[32:35], s44 offen offset:0 sc1
    s_waitcnt vmcnt(17)
    v_mfma_f32_16x16x32_bf16 v[152:155], v[28:31], v[72:75], v[152:155]
    buffer_load_dwordx4 v[144:147], v3, s[32:35], s44 offen offset:256 sc1
    buffer_load_dwordx2 v[16:17], v6, s[24:27], 0 offen offset:0
    buffer_load_dwordx2 v[18:19], v6, s[24:27], 0 offen offset:32
    buffer_load_dwordx2 v[20:21], v6, s[24:27], 0 offen offset:64
    s_waitcnt vmcnt(20)
    v_mfma_f32_16x16x32_bf16 v[156:159], v[28:31], v[76:79], v[156:159]
    s_waitcnt vmcnt(19)
    v_mfma_f32_16x16x32_bf16 v[160:163], v[28:31], v[80:83], v[160:163]
    ds_read_b128 v[232:235], v4 offset:0
    v_mfma_f32_16x16x32_bf16 v[164:167], v[36:39], v[64:67], v[164:167]
    v_mfma_f32_16x16x32_bf16 v[168:171], v[36:39], v[72:75], v[168:171]
    v_mfma_f32_16x16x32_bf16 v[172:175], v[36:39], v[76:79], v[172:175]
    v_mfma_f32_16x16x32_bf16 v[176:179], v[36:39], v[80:83], v[176:179]
    ds_read_b128 v[236:239], v4 offset:1024
    v_mfma_f32_16x16x32_bf16 v[180:183], v[40:43], v[64:67], v[180:183]
    v_mfma_f32_16x16x32_bf16 v[184:187], v[40:43], v[72:75], v[184:187]
    v_mfma_f32_16x16x32_bf16 v[188:191], v[40:43], v[76:79], v[188:191]
    v_mfma_f32_16x16x32_bf16 v[192:195], v[40:43], v[80:83], v[192:195]
    ds_read_b128 v[140:143], v4 offset:2048
    v_mfma_f32_16x16x32_bf16 v[196:199], v[44:47], v[64:67], v[196:199]
    v_mfma_f32_16x16x32_bf16 v[200:203], v[44:47], v[72:75], v[200:203]
    v_mfma_f32_16x16x32_bf16 v[204:207], v[44:47], v[76:79], v[204:207]
    v_mfma_f32_16x16x32_bf16 v[208:211], v[44:47], v[80:83], v[208:211]
    ds_read_b128 v[240:243], v4 offset:3072
    v_mfma_f32_16x16x32_bf16 v[212:215], v[32:35], v[64:67], v[212:215]
    v_mfma_f32_16x16x32_bf16 v[216:219], v[32:35], v[72:75], v[216:219]
    v_mfma_f32_16x16x32_bf16 v[220:223], v[32:35], v[76:79], v[220:223]
    v_mfma_f32_16x16x32_bf16 v[224:227], v[32:35], v[80:83], v[224:227]
    ds_read_b128 v[228:231], v4 offset:4096
    s_waitcnt vmcnt(18)
    s_waitcnt lgkmcnt(4)
    v_mfma_f32_16x16x32_bf16 v[148:151], v[232:235], v[68:71], v[148:151]
    s_waitcnt vmcnt(17)
    v_mfma_f32_16x16x32_bf16 v[152:155], v[232:235], v[84:87], v[152:155]
    s_waitcnt vmcnt(16)
    v_mfma_f32_16x16x32_bf16 v[156:159], v[232:235], v[88:91], v[156:159]
    s_waitcnt vmcnt(15)
    v_mfma_f32_16x16x32_bf16 v[160:163], v[232:235], v[92:95], v[160:163]
    ds_read_b128 v[244:247], v4 offset:5120
    s_waitcnt lgkmcnt(4)
    v_mfma_f32_16x16x32_bf16 v[164:167], v[236:239], v[68:71], v[164:167]
    v_mfma_f32_16x16x32_bf16 v[168:171], v[236:239], v[84:87], v[168:171]
    v_mfma_f32_16x16x32_bf16 v[172:175], v[236:239], v[88:91], v[172:175]
    v_mfma_f32_16x16x32_bf16 v[176:179], v[236:239], v[92:95], v[176:179]
    ds_read_b128 v[248:251], v4 offset:6144
    s_waitcnt lgkmcnt(4)
    v_mfma_f32_16x16x32_bf16 v[180:183], v[140:143], v[68:71], v[180:183]
    v_mfma_f32_16x16x32_bf16 v[184:187], v[140:143], v[84:87], v[184:187]
    v_mfma_f32_16x16x32_bf16 v[188:191], v[140:143], v[88:91], v[188:191]
    v_mfma_f32_16x16x32_bf16 v[192:195], v[140:143], v[92:95], v[192:195]
    ds_read_b128 v[252:255], v4 offset:7168
    s_waitcnt lgkmcnt(4)
    v_mfma_f32_16x16x32_bf16 v[196:199], v[240:243], v[68:71], v[196:199]
    v_mfma_f32_16x16x32_bf16 v[200:203], v[240:243], v[84:87], v[200:203]
    v_mfma_f32_16x16x32_bf16 v[204:207], v[240:243], v[88:91], v[204:207]
    v_mfma_f32_16x16x32_bf16 v[208:211], v[240:243], v[92:95], v[208:211]
    ds_read_b128 v[48:51], v4 offset:8192
    s_waitcnt lgkmcnt(4)
    v_mfma_f32_16x16x32_bf16 v[212:215], v[228:231], v[68:71], v[212:215]
    v_mfma_f32_16x16x32_bf16 v[216:219], v[228:231], v[84:87], v[216:219]
    v_mfma_f32_16x16x32_bf16 v[220:223], v[228:231], v[88:91], v[220:223]
    v_mfma_f32_16x16x32_bf16 v[224:227], v[228:231], v[92:95], v[224:227]
    ds_read_b128 v[52:55], v4 offset:9216
    s_waitcnt vmcnt(14)
    s_waitcnt lgkmcnt(4)
    v_mfma_f32_16x16x32_bf16 v[148:151], v[244:247], v[96:99], v[148:151]
    s_waitcnt vmcnt(13)
    v_mfma_f32_16x16x32_bf16 v[152:155], v[244:247], v[100:103], v[152:155]
    s_waitcnt vmcnt(12)
    v_mfma_f32_16x16x32_bf16 v[156:159], v[244:247], v[108:111], v[156:159]
    s_waitcnt vmcnt(11)
    v_mfma_f32_16x16x32_bf16 v[160:163], v[244:247], v[112:115], v[160:163]
    ds_read_b128 v[56:59], v4 offset:10240
    ds_read_b128 v[24:27], v4 offset:15360
    s_waitcnt lgkmcnt(5)
    v_mfma_f32_16x16x32_bf16 v[164:167], v[248:251], v[96:99], v[164:167]
    v_mfma_f32_16x16x32_bf16 v[168:171], v[248:251], v[100:103], v[168:171]
    v_mfma_f32_16x16x32_bf16 v[172:175], v[248:251], v[108:111], v[172:175]
    v_mfma_f32_16x16x32_bf16 v[176:179], v[248:251], v[112:115], v[176:179]
    ds_read_b128 v[60:63], v4 offset:11264
    ds_read_b128 v[28:31], v4 offset:16384
    s_waitcnt lgkmcnt(6)
    v_mfma_f32_16x16x32_bf16 v[180:183], v[252:255], v[96:99], v[180:183]
    v_mfma_f32_16x16x32_bf16 v[184:187], v[252:255], v[100:103], v[184:187]
    v_mfma_f32_16x16x32_bf16 v[188:191], v[252:255], v[108:111], v[188:191]
    v_mfma_f32_16x16x32_bf16 v[192:195], v[252:255], v[112:115], v[192:195]
    ds_read_b128 v[36:39], v4 offset:12288
    ds_read_b128 v[40:43], v4 offset:17408
    s_waitcnt lgkmcnt(7)
    v_mfma_f32_16x16x32_bf16 v[196:199], v[48:51], v[96:99], v[196:199]
    v_mfma_f32_16x16x32_bf16 v[200:203], v[48:51], v[100:103], v[200:203]
    v_mfma_f32_16x16x32_bf16 v[204:207], v[48:51], v[108:111], v[204:207]
    v_mfma_f32_16x16x32_bf16 v[208:211], v[48:51], v[112:115], v[208:211]
    ds_read_b128 v[44:47], v4 offset:13312
    ds_read_b128 v[64:67], v4 offset:18432
    s_waitcnt lgkmcnt(8)
    v_mfma_f32_16x16x32_bf16 v[212:215], v[52:55], v[96:99], v[212:215]
    v_mfma_f32_16x16x32_bf16 v[216:219], v[52:55], v[100:103], v[216:219]
    v_mfma_f32_16x16x32_bf16 v[220:223], v[52:55], v[108:111], v[220:223]
    v_mfma_f32_16x16x32_bf16 v[224:227], v[52:55], v[112:115], v[224:227]
    ds_read_b128 v[72:75], v4 offset:14336
    ds_read_b128 v[76:79], v4 offset:19456
    s_waitcnt vmcnt(10)
    s_waitcnt lgkmcnt(9)
    v_mfma_f32_16x16x32_bf16 v[148:151], v[56:59], v[116:119], v[148:151]
    s_waitcnt vmcnt(9)
    v_mfma_f32_16x16x32_bf16 v[152:155], v[56:59], v[104:107], v[152:155]
    s_waitcnt vmcnt(8)
    v_mfma_f32_16x16x32_bf16 v[156:159], v[56:59], v[120:123], v[156:159]
    s_waitcnt vmcnt(7)
    v_mfma_f32_16x16x32_bf16 v[160:163], v[56:59], v[124:127], v[160:163]
    s_waitcnt vmcnt(6)
    s_waitcnt lgkmcnt(8)
    v_mfma_f32_16x16x32_bf16 v[148:151], v[24:27], v[128:131], v[148:151]
    s_waitcnt vmcnt(5)
    v_mfma_f32_16x16x32_bf16 v[152:155], v[24:27], v[132:135], v[152:155]
    s_waitcnt vmcnt(4)
    v_mfma_f32_16x16x32_bf16 v[156:159], v[24:27], v[136:139], v[156:159]
    s_waitcnt vmcnt(3)
    v_mfma_f32_16x16x32_bf16 v[160:163], v[24:27], v[144:147], v[160:163]
    s_waitcnt lgkmcnt(7)
    v_mfma_f32_16x16x32_bf16 v[164:167], v[60:63], v[116:119], v[164:167]
    v_mfma_f32_16x16x32_bf16 v[168:171], v[60:63], v[104:107], v[168:171]
    v_mfma_f32_16x16x32_bf16 v[172:175], v[60:63], v[120:123], v[172:175]
    v_mfma_f32_16x16x32_bf16 v[176:179], v[60:63], v[124:127], v[176:179]
    s_waitcnt lgkmcnt(6)
    v_mfma_f32_16x16x32_bf16 v[164:167], v[28:31], v[128:131], v[164:167]
    ds_write_b128 v4, v[148:151] offset:0
    v_mfma_f32_16x16x32_bf16 v[168:171], v[28:31], v[132:135], v[168:171]
    ds_write_b128 v4, v[152:155] offset:5120
    v_mfma_f32_16x16x32_bf16 v[172:175], v[28:31], v[136:139], v[172:175]
    ds_write_b128 v4, v[156:159] offset:10240
    v_mfma_f32_16x16x32_bf16 v[176:179], v[28:31], v[144:147], v[176:179]
    ds_write_b128 v4, v[160:163] offset:15360
    s_waitcnt lgkmcnt(9)
    v_mfma_f32_16x16x32_bf16 v[180:183], v[36:39], v[116:119], v[180:183]
    v_mfma_f32_16x16x32_bf16 v[184:187], v[36:39], v[104:107], v[184:187]
    v_mfma_f32_16x16x32_bf16 v[188:191], v[36:39], v[120:123], v[188:191]
    v_mfma_f32_16x16x32_bf16 v[192:195], v[36:39], v[124:127], v[192:195]
    s_waitcnt lgkmcnt(8)
    v_mfma_f32_16x16x32_bf16 v[180:183], v[40:43], v[128:131], v[180:183]
    ds_write_b128 v4, v[164:167] offset:1024
    v_mfma_f32_16x16x32_bf16 v[184:187], v[40:43], v[132:135], v[184:187]
    ds_write_b128 v4, v[168:171] offset:6144
    v_mfma_f32_16x16x32_bf16 v[188:191], v[40:43], v[136:139], v[188:191]
    ds_write_b128 v4, v[172:175] offset:11264
    v_mfma_f32_16x16x32_bf16 v[192:195], v[40:43], v[144:147], v[192:195]
    ds_write_b128 v4, v[176:179] offset:16384
    s_waitcnt lgkmcnt(11)
    v_mfma_f32_16x16x32_bf16 v[196:199], v[44:47], v[116:119], v[196:199]
    v_mfma_f32_16x16x32_bf16 v[200:203], v[44:47], v[104:107], v[200:203]
    v_mfma_f32_16x16x32_bf16 v[204:207], v[44:47], v[120:123], v[204:207]
    v_mfma_f32_16x16x32_bf16 v[208:211], v[44:47], v[124:127], v[208:211]
    s_waitcnt lgkmcnt(10)
    v_mfma_f32_16x16x32_bf16 v[196:199], v[64:67], v[128:131], v[196:199]
    ds_write_b128 v4, v[180:183] offset:2048
    v_mfma_f32_16x16x32_bf16 v[200:203], v[64:67], v[132:135], v[200:203]
    ds_write_b128 v4, v[184:187] offset:7168
    v_mfma_f32_16x16x32_bf16 v[204:207], v[64:67], v[136:139], v[204:207]
    ds_write_b128 v4, v[188:191] offset:12288
    v_mfma_f32_16x16x32_bf16 v[208:211], v[64:67], v[144:147], v[208:211]
    ds_write_b128 v4, v[192:195] offset:17408
    s_waitcnt lgkmcnt(13)
    v_mfma_f32_16x16x32_bf16 v[212:215], v[72:75], v[116:119], v[212:215]
    v_mfma_f32_16x16x32_bf16 v[216:219], v[72:75], v[104:107], v[216:219]
    v_mfma_f32_16x16x32_bf16 v[220:223], v[72:75], v[120:123], v[220:223]
    v_mfma_f32_16x16x32_bf16 v[224:227], v[72:75], v[124:127], v[224:227]
    s_waitcnt lgkmcnt(12)
    v_mfma_f32_16x16x32_bf16 v[212:215], v[76:79], v[128:131], v[212:215]
    ds_write_b128 v4, v[196:199] offset:3072
    v_mfma_f32_16x16x32_bf16 v[216:219], v[76:79], v[132:135], v[216:219]
    ds_write_b128 v4, v[200:203] offset:8192
    v_mfma_f32_16x16x32_bf16 v[220:223], v[76:79], v[136:139], v[220:223]
    ds_write_b128 v4, v[204:207] offset:13312
    v_mfma_f32_16x16x32_bf16 v[224:227], v[76:79], v[144:147], v[224:227]
    ds_write_b128 v4, v[208:211] offset:18432
k1_kernel_yd:
    v_add_u32 v4, s38, v9
    s_lshr_b32 s40, s36, 1
    s_mul_i32 s40, s40, 5120
    s_mul_i32 s41, s39, 3072
    s_add_u32 s40, s40, s41
    v_add_u32 v14, s40, v9
    v_add_u32 v10, s16, v14
    v_add_u32 v11, s17, v14
    v_add_u32 v12, s7, v14
    v_add_u32 v13, 122880, v14
    s_mov_b32 s44, 3216550459
    s_mov_b32 s45, 3216550459
    s_mov_b32 s46, 1.0
    s_mov_b32 s47, 1.0
    s_mov_b32 s64, 0xffff0000
    ds_write_b128 v4, v[212:215] offset:4096
    ds_write_b128 v4, v[216:219] offset:9216
    ds_write_b128 v4, v[220:223] offset:14336
    ds_write_b128 v4, v[224:227] offset:19456
k1_kernel_red:
    s_waitcnt lgkmcnt(0)
    s_barrier
    s_cmp_lg_u32 s39, 0
    s_cbranch_scc1 k1_kernel_ex2
    ds_read_b128 v[32:35], v10 offset:0
    ds_read_b128 v[36:39], v10 offset:20480
    ds_read_b128 v[40:43], v11 offset:0
    ds_read_b128 v[44:47], v11 offset:20480
    ds_read_b128 v[48:51], v12 offset:0
    ds_read_b128 v[52:55], v12 offset:20480
    ds_read_b128 v[56:59], v13 offset:0
    ds_read_b128 v[60:63], v13 offset:20480
    ds_read_b128 v[64:67], v10 offset:1024
    ds_read_b128 v[68:71], v10 offset:21504
    ds_read_b128 v[72:75], v11 offset:1024
    ds_read_b128 v[76:79], v11 offset:21504
    ds_read_b128 v[80:83], v12 offset:1024
    ds_read_b128 v[84:87], v12 offset:21504
    ds_read_b128 v[88:91], v13 offset:1024
    ds_read_b128 v[92:95], v13 offset:21504
    ds_read_b128 v[96:99], v10 offset:2048
    ds_read_b128 v[100:103], v10 offset:22528
    ds_read_b128 v[104:107], v11 offset:2048
    ds_read_b128 v[108:111], v11 offset:22528
    ds_read_b128 v[112:115], v12 offset:2048
    ds_read_b128 v[116:119], v12 offset:22528
    ds_read_b128 v[120:123], v13 offset:2048
    ds_read_b128 v[124:127], v13 offset:22528
    s_waitcnt vmcnt(0)
    v_lshlrev_b32 v128, 16, v16
    v_and_b32 v129, s64, v16
    v_lshlrev_b32 v130, 16, v17
    v_and_b32 v131, s64, v17
    v_lshlrev_b32 v132, 16, v18
    v_and_b32 v133, s64, v18
    v_lshlrev_b32 v134, 16, v19
    v_and_b32 v135, s64, v19
    v_lshlrev_b32 v136, 16, v20
    v_and_b32 v137, s64, v20
    v_lshlrev_b32 v138, 16, v21
    v_and_b32 v139, s64, v21
    s_waitcnt lgkmcnt(15)
    v_pk_add_f32 v[32:33], v[32:33], v[36:37]
    v_pk_add_f32 v[34:35], v[34:35], v[38:39]
    s_waitcnt lgkmcnt(15)
    v_pk_add_f32 v[40:41], v[40:41], v[44:45]
    v_pk_add_f32 v[42:43], v[42:43], v[46:47]
    v_pk_add_f32 v[32:33], v[32:33], v[40:41]
    v_pk_add_f32 v[34:35], v[34:35], v[42:43]
    v_pk_mul_f32 v[36:37], v[32:33], s[44:45]
    v_pk_mul_f32 v[38:39], v[34:35], s[44:45]
    v_exp_f32 v36, v36
    v_exp_f32 v37, v37
    v_exp_f32 v38, v38
    v_exp_f32 v39, v39
    s_waitcnt lgkmcnt(15)
    v_pk_add_f32 v[48:49], v[48:49], v[52:53]
    v_pk_add_f32 v[50:51], v[50:51], v[54:55]
    s_waitcnt lgkmcnt(15)
    v_pk_add_f32 v[56:57], v[56:57], v[60:61]
    v_pk_add_f32 v[58:59], v[58:59], v[62:63]
    v_pk_add_f32 v[36:37], v[36:37], s[46:47]
    v_pk_add_f32 v[38:39], v[38:39], s[46:47]
    v_rcp_f32 v36, v36
    v_rcp_f32 v37, v37
    v_rcp_f32 v38, v38
    v_rcp_f32 v39, v39
    v_pk_add_f32 v[48:49], v[48:49], v[56:57]
    v_pk_add_f32 v[50:51], v[50:51], v[58:59]
    v_pk_mul_f32 v[32:33], v[32:33], v[48:49]
    v_pk_mul_f32 v[34:35], v[34:35], v[50:51]
    v_pk_fma_f32 v[128:129], v[32:33], v[36:37], v[128:129]
    v_pk_fma_f32 v[130:131], v[34:35], v[38:39], v[130:131]
    v_cvt_pk_bf16_f32 v16, v128, v129
    v_cvt_pk_bf16_f32 v17, v130, v131
    buffer_store_dwordx2 v[16:17], v6, s[28:31], 0 offen offset:0
    s_waitcnt lgkmcnt(14)
    v_pk_add_f32 v[64:65], v[64:65], v[68:69]
    v_pk_add_f32 v[66:67], v[66:67], v[70:71]
    s_waitcnt lgkmcnt(12)
    v_pk_add_f32 v[72:73], v[72:73], v[76:77]
    v_pk_add_f32 v[74:75], v[74:75], v[78:79]
    v_pk_add_f32 v[64:65], v[64:65], v[72:73]
    v_pk_add_f32 v[66:67], v[66:67], v[74:75]
    v_pk_mul_f32 v[68:69], v[64:65], s[44:45]
    v_pk_mul_f32 v[70:71], v[66:67], s[44:45]
    v_exp_f32 v68, v68
    v_exp_f32 v69, v69
    v_exp_f32 v70, v70
    v_exp_f32 v71, v71
    s_waitcnt lgkmcnt(10)
    v_pk_add_f32 v[80:81], v[80:81], v[84:85]
    v_pk_add_f32 v[82:83], v[82:83], v[86:87]
    s_waitcnt lgkmcnt(8)
    v_pk_add_f32 v[88:89], v[88:89], v[92:93]
    v_pk_add_f32 v[90:91], v[90:91], v[94:95]
    v_pk_add_f32 v[68:69], v[68:69], s[46:47]
    v_pk_add_f32 v[70:71], v[70:71], s[46:47]
    v_rcp_f32 v68, v68
    v_rcp_f32 v69, v69
    v_rcp_f32 v70, v70
    v_rcp_f32 v71, v71
    v_pk_add_f32 v[80:81], v[80:81], v[88:89]
    v_pk_add_f32 v[82:83], v[82:83], v[90:91]
    v_pk_mul_f32 v[64:65], v[64:65], v[80:81]
    v_pk_mul_f32 v[66:67], v[66:67], v[82:83]
    v_pk_fma_f32 v[132:133], v[64:65], v[68:69], v[132:133]
    v_pk_fma_f32 v[134:135], v[66:67], v[70:71], v[134:135]
    v_cvt_pk_bf16_f32 v18, v132, v133
    v_cvt_pk_bf16_f32 v19, v134, v135
    buffer_store_dwordx2 v[18:19], v6, s[28:31], 0 offen offset:32
    s_waitcnt lgkmcnt(6)
    v_pk_add_f32 v[96:97], v[96:97], v[100:101]
    v_pk_add_f32 v[98:99], v[98:99], v[102:103]
    s_waitcnt lgkmcnt(4)
    v_pk_add_f32 v[104:105], v[104:105], v[108:109]
    v_pk_add_f32 v[106:107], v[106:107], v[110:111]
    v_pk_add_f32 v[96:97], v[96:97], v[104:105]
    v_pk_add_f32 v[98:99], v[98:99], v[106:107]
    v_pk_mul_f32 v[100:101], v[96:97], s[44:45]
    v_pk_mul_f32 v[102:103], v[98:99], s[44:45]
    v_exp_f32 v100, v100
    v_exp_f32 v101, v101
    v_exp_f32 v102, v102
    v_exp_f32 v103, v103
    s_waitcnt lgkmcnt(2)
    v_pk_add_f32 v[112:113], v[112:113], v[116:117]
    v_pk_add_f32 v[114:115], v[114:115], v[118:119]
    s_waitcnt lgkmcnt(0)
    v_pk_add_f32 v[120:121], v[120:121], v[124:125]
    v_pk_add_f32 v[122:123], v[122:123], v[126:127]
    v_pk_add_f32 v[100:101], v[100:101], s[46:47]
    v_pk_add_f32 v[102:103], v[102:103], s[46:47]
    v_rcp_f32 v100, v100
    v_rcp_f32 v101, v101
    v_rcp_f32 v102, v102
    v_rcp_f32 v103, v103
    v_pk_add_f32 v[112:113], v[112:113], v[120:121]
    v_pk_add_f32 v[114:115], v[114:115], v[122:123]
    v_pk_mul_f32 v[96:97], v[96:97], v[112:113]
    v_pk_mul_f32 v[98:99], v[98:99], v[114:115]
    v_pk_fma_f32 v[136:137], v[96:97], v[100:101], v[136:137]
    v_pk_fma_f32 v[138:139], v[98:99], v[102:103], v[138:139]
    v_cvt_pk_bf16_f32 v20, v136, v137
    v_cvt_pk_bf16_f32 v21, v138, v139
    buffer_store_dwordx2 v[20:21], v6, s[28:31], 0 offen offset:64
    s_endpgm
k1_kernel_ex2:
    ds_read_b128 v[32:35], v10 offset:0
    ds_read_b128 v[36:39], v10 offset:20480
    ds_read_b128 v[40:43], v11 offset:0
    ds_read_b128 v[44:47], v11 offset:20480
    ds_read_b128 v[48:51], v12 offset:0
    ds_read_b128 v[52:55], v12 offset:20480
    ds_read_b128 v[56:59], v13 offset:0
    ds_read_b128 v[60:63], v13 offset:20480
    ds_read_b128 v[64:67], v10 offset:1024
    ds_read_b128 v[68:71], v10 offset:21504
    ds_read_b128 v[72:75], v11 offset:1024
    ds_read_b128 v[76:79], v11 offset:21504
    ds_read_b128 v[80:83], v12 offset:1024
    ds_read_b128 v[84:87], v12 offset:21504
    ds_read_b128 v[88:91], v13 offset:1024
    ds_read_b128 v[92:95], v13 offset:21504
    s_waitcnt vmcnt(0)
    v_lshlrev_b32 v128, 16, v16
    v_and_b32 v129, s64, v16
    v_lshlrev_b32 v130, 16, v17
    v_and_b32 v131, s64, v17
    v_lshlrev_b32 v132, 16, v18
    v_and_b32 v133, s64, v18
    v_lshlrev_b32 v134, 16, v19
    v_and_b32 v135, s64, v19
    s_waitcnt lgkmcnt(14)
    v_pk_add_f32 v[32:33], v[32:33], v[36:37]
    v_pk_add_f32 v[34:35], v[34:35], v[38:39]
    s_waitcnt lgkmcnt(12)
    v_pk_add_f32 v[40:41], v[40:41], v[44:45]
    v_pk_add_f32 v[42:43], v[42:43], v[46:47]
    v_pk_add_f32 v[32:33], v[32:33], v[40:41]
    v_pk_add_f32 v[34:35], v[34:35], v[42:43]
    v_pk_mul_f32 v[36:37], v[32:33], s[44:45]
    v_pk_mul_f32 v[38:39], v[34:35], s[44:45]
    v_exp_f32 v36, v36
    v_exp_f32 v37, v37
    v_exp_f32 v38, v38
    v_exp_f32 v39, v39
    s_waitcnt lgkmcnt(10)
    v_pk_add_f32 v[48:49], v[48:49], v[52:53]
    v_pk_add_f32 v[50:51], v[50:51], v[54:55]
    s_waitcnt lgkmcnt(8)
    v_pk_add_f32 v[56:57], v[56:57], v[60:61]
    v_pk_add_f32 v[58:59], v[58:59], v[62:63]
    v_pk_add_f32 v[36:37], v[36:37], s[46:47]
    v_pk_add_f32 v[38:39], v[38:39], s[46:47]
    v_rcp_f32 v36, v36
    v_rcp_f32 v37, v37
    v_rcp_f32 v38, v38
    v_rcp_f32 v39, v39
    v_pk_add_f32 v[48:49], v[48:49], v[56:57]
    v_pk_add_f32 v[50:51], v[50:51], v[58:59]
    v_pk_mul_f32 v[32:33], v[32:33], v[48:49]
    v_pk_mul_f32 v[34:35], v[34:35], v[50:51]
    v_pk_fma_f32 v[128:129], v[32:33], v[36:37], v[128:129]
    v_pk_fma_f32 v[130:131], v[34:35], v[38:39], v[130:131]
    v_cvt_pk_bf16_f32 v16, v128, v129
    v_cvt_pk_bf16_f32 v17, v130, v131
    buffer_store_dwordx2 v[16:17], v6, s[28:31], 0 offen offset:0
    s_waitcnt lgkmcnt(6)
    v_pk_add_f32 v[64:65], v[64:65], v[68:69]
    v_pk_add_f32 v[66:67], v[66:67], v[70:71]
    s_waitcnt lgkmcnt(4)
    v_pk_add_f32 v[72:73], v[72:73], v[76:77]
    v_pk_add_f32 v[74:75], v[74:75], v[78:79]
    v_pk_add_f32 v[64:65], v[64:65], v[72:73]
    v_pk_add_f32 v[66:67], v[66:67], v[74:75]
    v_pk_mul_f32 v[68:69], v[64:65], s[44:45]
    v_pk_mul_f32 v[70:71], v[66:67], s[44:45]
    v_exp_f32 v68, v68
    v_exp_f32 v69, v69
    v_exp_f32 v70, v70
    v_exp_f32 v71, v71
    s_waitcnt lgkmcnt(2)
    v_pk_add_f32 v[80:81], v[80:81], v[84:85]
    v_pk_add_f32 v[82:83], v[82:83], v[86:87]
    s_waitcnt lgkmcnt(0)
    v_pk_add_f32 v[88:89], v[88:89], v[92:93]
    v_pk_add_f32 v[90:91], v[90:91], v[94:95]
    v_pk_add_f32 v[68:69], v[68:69], s[46:47]
    v_pk_add_f32 v[70:71], v[70:71], s[46:47]
    v_rcp_f32 v68, v68
    v_rcp_f32 v69, v69
    v_rcp_f32 v70, v70
    v_rcp_f32 v71, v71
    v_pk_add_f32 v[80:81], v[80:81], v[88:89]
    v_pk_add_f32 v[82:83], v[82:83], v[90:91]
    v_pk_mul_f32 v[64:65], v[64:65], v[80:81]
    v_pk_mul_f32 v[66:67], v[66:67], v[82:83]
    v_pk_fma_f32 v[132:133], v[64:65], v[68:69], v[132:133]
    v_pk_fma_f32 v[134:135], v[66:67], v[70:71], v[134:135]
    v_cvt_pk_bf16_f32 v18, v132, v133
    v_cvt_pk_bf16_f32 v19, v134, v135
    buffer_store_dwordx2 v[18:19], v6, s[28:31], 0 offen offset:32
k1_kernel_end:
    s_endpgm
.section .rodata,"a"
.p2align 6
.amdhsa_kernel k1_kernel
  .amdhsa_next_free_vgpr 256
  .amdhsa_next_free_sgpr 102
  .amdhsa_accum_offset 256
  .amdhsa_group_segment_fixed_size 0
  .amdhsa_kernarg_size 80
  .amdhsa_user_sgpr_count 2
  .amdhsa_user_sgpr_kernarg_segment_ptr 1
  .amdhsa_system_sgpr_workgroup_id_x 1
.end_amdhsa_kernel
```
